```python
import torch

def _softmax(x, axis=-1):
    return torch.softmax(x, dim=axis)
def _gelu(x):
    return torch.nn.functional.gelu(x, approximate="tanh")
def _silu(x):
    return torch.nn.functional.silu(x)
def _sigmoid(x):
    return torch.sigmoid(x)
def _layernorm(x, axis=-1, eps=1e-5):
    m = x.mean(dim=axis, keepdim=True)
    v = x.var(dim=axis, keepdim=True, unbiased=False)
    return (x - m) / torch.sqrt(v + eps)
def _scatter_add(tgt, idx, src, axis=0):
    return tgt.clone().index_add_(axis, idx, src)
def _segment_sum(src, seg, n):
    out = torch.zeros((n,) + src.shape[1:], dtype=src.dtype)
    return out.index_add_(0, seg, src)
def _pad(x, pw):
    flat = tuple(v for pair in reversed(pw) for v in pair)
    return torch.nn.functional.pad(x, flat)

kernel_name = 'gated_mix__mha_block__ssm_conv_s5__prompt'

def setup_inputs():

    _w = (lambda a: (lambda t: t.to(torch.bfloat16) if t.is_floating_point() else t)(torch.as_tensor(a)))
    def _A_setup():
        B, S, D, H = 1, 2048, 576, 32
        return {
            "x": _w((lambda *s: torch.randn(*s, dtype=torch.bfloat16) * 0.05)(B, S, D)),
            "wqkv": _w((lambda *s: torch.randn(*s, dtype=torch.bfloat16) * 0.8)(D, 3 * D)),
            "wo": _w((lambda *s: torch.randn(*s, dtype=torch.bfloat16) * 0.05)(D, D)),
        }
    _A_in = _A_setup()

    def _B_setup():
        B, S, D = 1, 2048, 576
        P = D
        Lambda_re = -0.5 * (lambda _x: torch.exp(torch.as_tensor(_x)))((lambda *s: torch.randn(*s, dtype=torch.bfloat16) * 0.4)(P))
        Lambda_im = (lambda *s: torch.randn(*s, dtype=torch.bfloat16) * 0.8)(P) * 1.0
        B_re = (lambda *s: torch.randn(*s, dtype=torch.bfloat16) * 0.8)(P, D) * (D ** -0.5)
        B_im = (lambda *s: torch.randn(*s, dtype=torch.bfloat16) * 0.8)(P, D) * (D ** -0.5)
        C_re = (lambda *s: torch.randn(*s, dtype=torch.bfloat16) * 0.8)(D, P) * (P ** -0.5)
        C_im = (lambda *s: torch.randn(*s, dtype=torch.bfloat16) * 0.8)(D, P) * (P ** -0.5)
        log_dt = (lambda *s: torch.randn(*s, dtype=torch.bfloat16) * 0.4)(P) * 0.3 - 2.0
        Dskip = (lambda *s: torch.randn(*s, dtype=torch.bfloat16) * 0.1)(D)
        return {
            "x": _w((lambda *s: torch.randn(*s, dtype=torch.bfloat16) * 0.05)(B, S, D)),
            "Lambda_re": _w(Lambda_re),
            "Lambda_im": _w(Lambda_im),
            "B_re": _w(B_re),
            "B_im": _w(B_im),
            "C_re": _w(C_re),
            "C_im": _w(C_im),
            "log_dt": _w(log_dt),
            "Dskip": _w(Dskip),
        }
    _B_in = _B_setup()

    return {
        "A_x": _A_in["x"],
        "A_wqkv": _A_in["wqkv"],
        "A_wo": _A_in["wo"],
        "B_x": _B_in["x"],
        "B_Lambda_re": _B_in["Lambda_re"],
        "B_Lambda_im": _B_in["Lambda_im"],
        "B_B_re": _B_in["B_re"],
        "B_B_im": _B_in["B_im"],
        "B_C_re": _B_in["C_re"],
        "B_C_im": _B_in["C_im"],
        "B_log_dt": _B_in["log_dt"],
        "B_Dskip": _B_in["Dskip"],
        "gate_w": _w((lambda *s: torch.randn(*s, dtype=torch.bfloat16) * 0.05)(576) * 16.0),
    }

def reference(A_x, A_wqkv, A_wo, B_x, B_Lambda_re, B_Lambda_im, B_B_re, B_B_im, B_C_re, B_C_im, B_log_dt, B_Dskip, gate_w):
    def _A_ref(x, wqkv, wo):
        B, S, D = x.shape
        H = 32
        Dh = D // H
        qkv = (lambda x, *d: x.permute(*d))((x @ wqkv).reshape(B, S, 3, H, Dh), 2, 0, 3, 1, 4)
        q, k, v = qkv[0], qkv[1], qkv[2]
        scores = torch.einsum("bhqd,bhkd->bhqk", q, k) * (Dh ** -0.5)
        p = _softmax(scores, axis=-1)
        o = torch.einsum("bhqk,bhkd->bhqd", p, v)
        return (lambda x, *d: x.permute(*d))(o, 0, 2, 1, 3).reshape(B, S, D) @ wo

    def _B_ref(x, Lambda_re, Lambda_im, B_re, B_im, C_re, C_im, log_dt, Dskip):
        Bsz, L, H = x.shape
        Lam = Lambda_re + 1j * Lambda_im
        Bmat = B_re + 1j * B_im
        Cmat = C_re + 1j * C_im
        dt = torch.exp(log_dt)
        Lam_bar = torch.exp(dt * Lam)
        B_bar = ((Lam_bar - 1.0) / Lam)[:, None] * Bmat
        Bu = torch.einsum("bld,pd->blp", x + 0j, B_bar)
        h = torch.zeros_like(Bu[:, 0, :])
        hs = []
        for t in range(L):
            h = Lam_bar[None, :] * h + Bu[:, t, :]
            hs.append(h)
        hseq = torch.stack(hs, 1)
        y = 2.0 * torch.einsum("blp,dp->bld", hseq, Cmat).real + x * Dskip[None, None, :]
        return y

    x = A_x
    g = _sigmoid((x * gate_w).sum(-1, keepdims=True))
    a = _A_ref(x, A_wqkv, A_wo)
    b = _B_ref(x, B_Lambda_re, B_Lambda_im, B_B_re, B_B_im, B_C_re, B_C_im, B_log_dt, B_Dskip)
    return g * a + (1 - g) * b
```

```asm
; @launch grid=(256,1,1) block=(512,1,1) lds=163840
.amdgcn_target "amdgcn-amd-amdhsa--gfx950"
.text
.globl gated_mix__mha_block__ssm_conv_s5__prompt_kernel
.p2align 8
.type gated_mix__mha_block__ssm_conv_s5__prompt_kernel,@function
gated_mix__mha_block__ssm_conv_s5__prompt_kernel:
    s_cmp_ge_u32 s2, 256
    s_cbranch_scc1 L_end
    s_load_dwordx16 s[16:31], s[0:1], 0
    s_load_dwordx16 s[32:47], s[0:1], 64
    s_bfe_u32 s3, s2, 0x30003
    s_cmp_lg_u32 s3, 0
    s_cbranch_scc1 L_nopf
    s_getpc_b64 s[10:11]
L_pfbase:
    v_lshlrev_b32 v1, 7, v0
    v_min_u32 v1, L_codeend-L_pfbase, v1
    v_mov_b32 v5, s11
    v_add_co_u32 v4, vcc, s10, v1
    s_nop 1
    v_addc_co_u32 v5, vcc, 0, v5, vcc
    global_load_dword v255, v[4:5], off
L_nopf:
    v_lshrrev_b32 v1, 6, v0
    v_and_b32 v0, 63, v0
    v_readfirstlane_b32 s4, v1
    s_and_b32 s10, s2, 7
    s_lshr_b32 s11, s2, 3
    s_and_b32 s15, s11, 3
    s_lshr_b32 s8, s11, 2
    s_lshl_b32 s12, s10, 2
    s_add_u32 s7, s12, s15
    s_lshr_b32 s12, s10, 1
    s_lshl_b32 s12, s12, 2
    s_add_u32 s5, s12, s15
    s_and_b32 s13, s10, 1
    s_mul_i32 s12, s13, 7
    s_add_u32 s6, s12, s8
    s_mul_i32 s12, s13, 6
    s_add_u32 s14, s8, 1
    s_and_b32 s14, s14, 7
    s_add_u32 s84, s12, s14
    s_cmp_lt_u32 s14, 6
    s_cselect_b32 s90, 2, 0
    s_cmp_lt_u32 s8, 7
    s_cselect_b32 s12, 1, 4
    s_or_b32 s90, s90, s12
    s_and_b32 s80, s4, 1
    s_bfe_u32 s81, s4, 0x10001
    s_mov_b32 s91, 0
    s_mov_b32 s99, 2147418112
    s_cmp_eq_u32 s15, 3
    s_cselect_b32 s12, 0, s15
    s_mul_i32 s83, s12, 3
    v_and_b32 v2, 31, v0
    v_lshrrev_b32 v3, 5, v0
    v_mov_b32 v118, 2147418112
    v_mov_b32 v119, 2147418112
    s_cmp_lt_u32 s4, 4
    s_cbranch_scc1 L_compute
L_loader:
    s_sub_u32 s3, s4, 4
    s_lshl_b32 s10, s3, 5
    s_lshl_b32 s11, s5, 7
    s_add_u32 s10, s10, s11
    v_lshrrev_b32 v4, 3, v0
    v_and_b32 v5, 7, v0
    v_lshrrev_b32 v8, 1, v4
    v_xor_b32 v8, v8, v5
    v_add_u32 v6, s10, v4
    v_mul_u32_u24 v6, 1152, v6
    v_lshl_add_u32 v16, v8, 4, v6
    v_xor_b32 v17, 64, v16
    v_add_u32 v18, 18432, v16
    v_add_u32 v17, 9216, v17
    v_add_u32 v19, 18432, v17
    s_mul_i32 s12, s3, 3
    s_mul_i32 s15, s84, 48
    s_lshl_b32 s13, s80, 6
    s_add_u32 s14, s12, 0
    s_lshr_b32 s14, s14, 1
    s_lshl_b32 s14, s14, 3
    s_add_u32 s14, s14, s15
    v_add_u32 v6, s14, v4
    v_mul_u32_u24 v6, 1152, v6
    v_lshl_add_u32 v6, v8, 4, v6
    v_xor_b32 v24, s13, v6
    s_xor_b32 s13, s13, 64
    s_add_u32 s14, s12, 1
    s_lshr_b32 s14, s14, 1
    s_lshl_b32 s14, s14, 3
    s_add_u32 s14, s14, s15
    v_add_u32 v6, s14, v4
    v_mul_u32_u24 v6, 1152, v6
    v_lshl_add_u32 v6, v8, 4, v6
    v_xor_b32 v25, s13, v6
    s_xor_b32 s13, s13, 64
    s_add_u32 s14, s12, 2
    s_lshr_b32 s14, s14, 1
    s_lshl_b32 s14, s14, 3
    s_add_u32 s14, s14, s15
    v_add_u32 v6, s14, v4
    v_mul_u32_u24 v6, 1152, v6
    v_lshl_add_u32 v6, v8, 4, v6
    v_xor_b32 v26, s13, v6
    s_xor_b32 s13, s13, 64
    v_lshrrev_b32 v4, 4, v0
    v_and_b32 v5, 15, v0
    v_lshlrev_b32 v6, 2, v4
    v_xor_b32 v5, v5, v6
    s_lshl_b32 s14, s3, 4
    v_add_u32 v4, s14, v4
    v_mul_u32_u24 v4, 3456, v4
    s_lshl_b32 s15, s6, 4
    v_add_u32 v5, s15, v5
    v_cmp_gt_u32 vcc, 216, v5
    v_lshl_add_u32 v4, v5, 4, v4
    v_mov_b32 v6, s99
    v_cndmask_b32 v20, v6, v4, vcc
    s_waitcnt lgkmcnt(0)
    s_load_dword s9, s[46:47], 0
    s_mov_b32 s48, s16
    s_and_b32 s49, s17, 0xffff
    s_mov_b32 s50, 2359296
    s_mov_b32 s51, 0x20000
    s_mov_b32 s52, s18
    s_and_b32 s53, s19, 0xffff
    s_mov_b32 s54, 1990656
    s_mov_b32 s55, 0x20000
    s_bitcmp1_b32 s4, 0
    s_cselect_b32 s16, s30, s28
    s_cselect_b32 s17, s31, s29
    s_cselect_b32 s56, s28, s30
    s_cselect_b32 s57, s29, s31
    s_and_b32 s17, s17, 0xffff
    s_and_b32 s57, s57, 0xffff
    s_mov_b32 s18, 663552
    s_mov_b32 s58, 663552
    s_mov_b32 s19, 0x20000
    s_mov_b32 s59, 0x20000
    s_lshl_b32 s40, s3, 12
    s_mul_i32 s41, s3, 3072
    s_add_u32 s12, s83, 0
    s_cmp_ge_u32 s12, 9
    s_cselect_b32 s11, 9, 0
    s_sub_u32 s12, s12, s11
    s_lshl_b32 s11, s12, 7
    s_mul_i32 s12, s12, 221184
    s_add_u32 m0, s40, 0
    s_add_u32 s10, s11, 0
    buffer_load_dwordx4 v16, s[48:51], s10 offen lds
    s_add_u32 m0, s40, 1024
    s_add_u32 s10, s11, 0
    buffer_load_dwordx4 v17, s[48:51], s10 offen lds
    s_add_u32 m0, s40, 2048
    s_add_u32 s10, s11, 0
    buffer_load_dwordx4 v18, s[48:51], s10 offen lds
    s_add_u32 m0, s40, 3072
    s_add_u32 s10, s11, 0
    buffer_load_dwordx4 v19, s[48:51], s10 offen lds
    s_bitcmp1_b32 s90, 0
    s_cbranch_scc0 L_ty_1
    s_add_u32 m0, s40, 16384
    s_add_u32 s10, s12, 0
    buffer_load_dwordx4 v20, s[52:55], s10 offen lds
    s_add_u32 m0, s40, 17408
    s_add_u32 s10, s12, 13824
    buffer_load_dwordx4 v20, s[52:55], s10 offen lds
    s_add_u32 m0, s40, 18432
    s_add_u32 s10, s12, 27648
    buffer_load_dwordx4 v20, s[52:55], s10 offen lds
    s_add_u32 m0, s40, 19456
    s_add_u32 s10, s12, 41472
    buffer_load_dwordx4 v20, s[52:55], s10 offen lds
L_ty_1:
    s_bitcmp1_b32 s90, 1
    s_cbranch_scc0 L_ty_2
    s_add_u32 m0, s41, 32768
    s_add_u32 s10, s11, 0
    buffer_load_dwordx4 v24, s[16:19], s10 offen lds
    s_add_u32 m0, s41, 33792
    s_add_u32 s10, s11, 0
    buffer_load_dwordx4 v25, s[56:59], s10 offen lds
    s_add_u32 m0, s41, 34816
    s_add_u32 s10, s11, 0
    buffer_load_dwordx4 v26, s[16:19], s10 offen lds
L_ty_2:
    s_cmp_ge_u32 s4, 6
    s_cbranch_scc0 L_pair0
    s_sub_u32 s40, s40, 8192
    s_sub_u32 s41, s41, 6144
    v_subrev_u32 v20, 110592, v20
    v_subrev_u32 v16, 73728, v16
    v_subrev_u32 v17, 73728, v17
    v_subrev_u32 v18, 73728, v18
    v_subrev_u32 v19, 73728, v19
    v_subrev_u32 v24, 27648, v24
    v_subrev_u32 v25, 27648, v25
    v_subrev_u32 v26, 27648, v26
    s_add_u32 s12, s83, 1
    s_cmp_ge_u32 s12, 9
    s_cselect_b32 s11, 9, 0
    s_sub_u32 s12, s12, s11
    s_lshl_b32 s11, s12, 7
    s_mul_i32 s12, s12, 221184
    s_add_u32 m0, s40, 45056
    s_add_u32 s10, s11, 0
    buffer_load_dwordx4 v16, s[48:51], s10 offen lds
    s_add_u32 m0, s40, 46080
    s_add_u32 s10, s11, 0
    buffer_load_dwordx4 v17, s[48:51], s10 offen lds
    s_add_u32 m0, s40, 47104
    s_add_u32 s10, s11, 0
    buffer_load_dwordx4 v18, s[48:51], s10 offen lds
    s_add_u32 m0, s40, 48128
    s_add_u32 s10, s11, 0
    buffer_load_dwordx4 v19, s[48:51], s10 offen lds
    s_add_u32 m0, s40, 53248
    s_add_u32 s10, s11, 73728
    buffer_load_dwordx4 v16, s[48:51], s10 offen lds
    s_add_u32 m0, s40, 54272
    s_add_u32 s10, s11, 73728
    buffer_load_dwordx4 v17, s[48:51], s10 offen lds
    s_add_u32 m0, s40, 55296
    s_add_u32 s10, s11, 73728
    buffer_load_dwordx4 v18, s[48:51], s10 offen lds
    s_add_u32 m0, s40, 56320
    s_add_u32 s10, s11, 73728
    buffer_load_dwordx4 v19, s[48:51], s10 offen lds
    s_bitcmp1_b32 s90, 0
    s_cbranch_scc0 L_ty_3
    s_add_u32 m0, s40, 61440
    s_add_u32 s10, s12, 0
    buffer_load_dwordx4 v20, s[52:55], s10 offen lds
    s_add_u32 m0, s40, 62464
    s_add_u32 s10, s12, 13824
    buffer_load_dwordx4 v20, s[52:55], s10 offen lds
    s_add_u32 m0, s40, 63488
    s_add_u32 s10, s12, 27648
    buffer_load_dwordx4 v20, s[52:55], s10 offen lds
    s_add_u32 m0, s40, 64512
    s_add_u32 s10, s12, 41472
    buffer_load_dwordx4 v20, s[52:55], s10 offen lds
    s_add_u32 m0, s40, 69632
    s_add_u32 s10, s12, 110592
    buffer_load_dwordx4 v20, s[52:55], s10 offen lds
    s_add_u32 m0, s40, 70656
    s_add_u32 s10, s12, 124416
    buffer_load_dwordx4 v20, s[52:55], s10 offen lds
    s_add_u32 m0, s40, 71680
    s_add_u32 s10, s12, 138240
    buffer_load_dwordx4 v20, s[52:55], s10 offen lds
    s_add_u32 m0, s40, 72704
    s_add_u32 s10, s12, 152064
    buffer_load_dwordx4 v20, s[52:55], s10 offen lds
L_ty_3:
    s_bitcmp1_b32 s90, 1
    s_cbranch_scc0 L_ty_4
    s_add_u32 m0, s41, 77824
    s_add_u32 s10, s11, 0
    buffer_load_dwordx4 v24, s[16:19], s10 offen lds
    s_add_u32 m0, s41, 78848
    s_add_u32 s10, s11, 0
    buffer_load_dwordx4 v25, s[56:59], s10 offen lds
    s_add_u32 m0, s41, 79872
    s_add_u32 s10, s11, 0
    buffer_load_dwordx4 v26, s[16:19], s10 offen lds
    s_add_u32 m0, s41, 83968
    s_add_u32 s10, s11, 27648
    buffer_load_dwordx4 v24, s[16:19], s10 offen lds
    s_add_u32 m0, s41, 84992
    s_add_u32 s10, s11, 27648
    buffer_load_dwordx4 v25, s[56:59], s10 offen lds
    s_add_u32 m0, s41, 86016
    s_add_u32 s10, s11, 27648
    buffer_load_dwordx4 v26, s[16:19], s10 offen lds
L_ty_4:
    s_and_b32 s10, s90, 3
    s_cmp_eq_u32 s10, 3
    s_cbranch_scc1 L_c1_5
    s_cmp_eq_u32 s10, 1
    s_cbranch_scc1 L_c1_6
    s_waitcnt vmcnt(14)
L_c1_6:
    s_waitcnt vmcnt(16)
L_c1_5:
    s_waitcnt vmcnt(22)
    s_branch L_early
L_back1:
    s_waitcnt lgkmcnt(0)
    s_barrier
    s_mul_i32 s9, s9, 0x9E3779B1
    s_add_u32 s9, s9, 0x7F4A7C15
    s_waitcnt vmcnt(0)
    s_barrier
    s_add_u32 s12, s83, 3
    s_cmp_ge_u32 s12, 9
    s_cselect_b32 s11, 9, 0
    s_sub_u32 s12, s12, s11
    s_lshl_b32 s11, s12, 7
    s_mul_i32 s12, s12, 221184
    s_add_u32 m0, s40, 0
    s_add_u32 s10, s11, 0
    buffer_load_dwordx4 v16, s[48:51], s10 offen lds
    s_add_u32 m0, s40, 1024
    s_add_u32 s10, s11, 0
    buffer_load_dwordx4 v17, s[48:51], s10 offen lds
    s_add_u32 m0, s40, 2048
    s_add_u32 s10, s11, 0
    buffer_load_dwordx4 v18, s[48:51], s10 offen lds
    s_add_u32 m0, s40, 3072
    s_add_u32 s10, s11, 0
    buffer_load_dwordx4 v19, s[48:51], s10 offen lds
    s_add_u32 m0, s40, 8192
    s_add_u32 s10, s11, 73728
    buffer_load_dwordx4 v16, s[48:51], s10 offen lds
    s_add_u32 m0, s40, 9216
    s_add_u32 s10, s11, 73728
    buffer_load_dwordx4 v17, s[48:51], s10 offen lds
    s_add_u32 m0, s40, 10240
    s_add_u32 s10, s11, 73728
    buffer_load_dwordx4 v18, s[48:51], s10 offen lds
    s_add_u32 m0, s40, 11264
    s_add_u32 s10, s11, 73728
    buffer_load_dwordx4 v19, s[48:51], s10 offen lds
    s_bitcmp1_b32 s90, 0
    s_cbranch_scc0 L_ty_7
    s_add_u32 m0, s40, 16384
    s_add_u32 s10, s12, 0
    buffer_load_dwordx4 v20, s[52:55], s10 offen lds
    s_add_u32 m0, s40, 17408
    s_add_u32 s10, s12, 13824
    buffer_load_dwordx4 v20, s[52:55], s10 offen lds
    s_add_u32 m0, s40, 18432
    s_add_u32 s10, s12, 27648
    buffer_load_dwordx4 v20, s[52:55], s10 offen lds
    s_add_u32 m0, s40, 19456
    s_add_u32 s10, s12, 41472
    buffer_load_dwordx4 v20, s[52:55], s10 offen lds
    s_add_u32 m0, s40, 24576
    s_add_u32 s10, s12, 110592
    buffer_load_dwordx4 v20, s[52:55], s10 offen lds
    s_add_u32 m0, s40, 25600
    s_add_u32 s10, s12, 124416
    buffer_load_dwordx4 v20, s[52:55], s10 offen lds
    s_add_u32 m0, s40, 26624
    s_add_u32 s10, s12, 138240
    buffer_load_dwordx4 v20, s[52:55], s10 offen lds
    s_add_u32 m0, s40, 27648
    s_add_u32 s10, s12, 152064
    buffer_load_dwordx4 v20, s[52:55], s10 offen lds
L_ty_7:
    s_bitcmp1_b32 s90, 1
    s_cbranch_scc0 L_ty_8
    s_add_u32 m0, s41, 32768
    s_add_u32 s10, s11, 0
    buffer_load_dwordx4 v24, s[16:19], s10 offen lds
    s_add_u32 m0, s41, 33792
    s_add_u32 s10, s11, 0
    buffer_load_dwordx4 v25, s[56:59], s10 offen lds
    s_add_u32 m0, s41, 34816
    s_add_u32 s10, s11, 0
    buffer_load_dwordx4 v26, s[16:19], s10 offen lds
    s_add_u32 m0, s41, 38912
    s_add_u32 s10, s11, 27648
    buffer_load_dwordx4 v24, s[16:19], s10 offen lds
    s_add_u32 m0, s41, 39936
    s_add_u32 s10, s11, 27648
    buffer_load_dwordx4 v25, s[56:59], s10 offen lds
    s_add_u32 m0, s41, 40960
    s_add_u32 s10, s11, 27648
    buffer_load_dwordx4 v26, s[16:19], s10 offen lds
L_ty_8:
    s_barrier
    s_cmp_eq_u32 s91, 1
    s_cbranch_scc1 L_lt_9
    s_mul_i32 s15, s84, 48
    s_min_u32 s15, s15, 528
    v_and_b32 v10, 7, v0
    v_bfe_u32 v11, v0, 4, 1
    v_lshl_add_u32 v10, v11, 3, v10
    v_add_lshl_u32 v10, v10, s15, 1
    global_load_ushort v154, v10, s[24:25] offset:0
    global_load_ushort v157, v10, s[26:27] offset:0
    global_load_ushort v160, v10, s[36:37] offset:0
    global_load_ushort v155, v10, s[24:25] offset:32
    global_load_ushort v158, v10, s[26:27] offset:32
    global_load_ushort v161, v10, s[36:37] offset:32
    global_load_ushort v156, v10, s[24:25] offset:64
    global_load_ushort v159, v10, s[26:27] offset:64
    global_load_ushort v162, v10, s[36:37] offset:64
    s_mov_b32 s60, s46
    s_and_b32 s61, s47, 0xffff
    s_mov_b32 s62, 19922944
    s_mov_b32 s63, 0x20000
    v_lshlrev_b32 v221, 4, v0
    v_lshlrev_b32 v205, 3, v0
    v_mul_u32_u24 v4, 5120, v3
    v_lshl_add_u32 v4, v2, 3, v4
    v_add_u32 v206, 1024, v4
    v_mov_b32 v209, 0xdddd
    v_and_b32 v4, 0x13, v2
    v_bfe_u32 v5, v2, 2, 1
    v_lshl_or_b32 v4, v5, 3, v4
    v_bfe_u32 v5, v2, 3, 1
    v_lshl_or_b32 v4, v5, 2, v4
    v_mul_u32_u24 v5, 288, v3
    v_lshl_add_u32 v4, v4, 4, v5
    v_add_u32 v4, 1280, v4
    v_add_u32 v5, 576, v4
    v_and_b32 v6, 27, v2
    v_cmp_eq_u32 vcc, 18, v6
    v_mov_b32 v6, 2496
    v_mov_b32 v7, 2432
    v_cndmask_b32 v6, v7, v6, vcc
    v_cmp_gt_u32 vcc, 18, v2
    s_lshr_b32 s10, s7, 1
    s_mul_i32 s11, s10, 9
    v_cndmask_b32 v207, v6, v4, vcc
    v_cndmask_b32 v208, v6, v5, vcc
    s_mul_i32 s93, s4, 2560
    s_and_b32 s12, s7, 1
    s_mul_i32 s13, s12, 5
    s_add_u32 s13, s13, s11
    s_lshl_b32 s44, s13, 8
    s_add_u32 s14, s44, 4194304
    v_add_u32 v210, s14, v221
    s_add_u32 s11, s11, 4
    s_lshl_b32 s45, s11, 8
    s_add_u32 s14, s45, 4194304
    v_add_u32 v4, s14, v221
    s_mul_i32 s15, s7, 288
    s_add_u32 s15, s15, 7340032
    s_mov_b32 s3, 3641
    v_add_u32 v5, 4294967280, v0
    v_and_b32 v5, 0x7f, v5
    v_mul_u32_u24 v6, s3, v5
    v_lshrrev_b32 v6, 16, v6
    v_mul_u32_u24 v7, 8928, v6
    v_lshl_add_u32 v7, v5, 4, v7
    v_add_u32 v211, s15, v7
    v_add_u32 v5, 48, v0
    v_and_b32 v5, 0x7f, v5
    v_mul_u32_u24 v6, s3, v5
    v_lshrrev_b32 v6, 16, v6
    v_mul_u32_u24 v7, 8928, v6
    v_lshl_add_u32 v7, v5, 4, v7
    v_add_u32 v212, s15, v7
    v_cmp_gt_u32 vcc, 16, v0
    s_mul_i32 s14, s10, 36
    v_bfe_u32 v5, v0, 4, 1
    v_cndmask_b32 v211, v211, v4, vcc
    v_mul_u32_u24 v5, 35, v5
    v_mul_u32_u24 v7, 576, v3
    v_add3_u32 v4, v5, v7, s14
    v_add_u32 v4, 576, v4
    v_lshrrev_b32 v4, 7, v4
    v_and_b32 v8, 15, v0
    v_lshl_add_u32 v4, v4, 4, v8
    s_and_b32 s3, s4, 3
    s_cmp_eq_u32 s3, 0
    s_cselect_b32 s3, 4096, s99
    v_lshl_add_u32 v222, v4, 7, s3
    v_cmp_gt_u32 s[100:101], 4, v8
    v_bfe_u32 v4, v0, 1, 1
    v_mul_u32_u24 v4, 35, v4
    v_add_u32 v4, s14, v4
    v_lshrrev_b32 v4, 7, v4
    v_cmp_gt_u32 vcc, 4, v0
    v_and_b32 v8, 1, v0
    s_lshl_b32 s12, s8, 1
    v_bfe_u32 v7, v0, 1, 1
    v_add_u32 v7, 14, v7
    v_cndmask_b32 v7, v7, v4, vcc
    v_add_u32 v8, s12, v8
    v_lshl_add_u32 v7, v7, 4, v8
    v_lshl_add_u32 v223, v7, 7, s3
    v_cmp_gt_u32 vcc, 12, v0
    v_add_u32 v4, 16, v0
    s_and_b32 s12, s7, 1
    s_add_u32 s12, s12, 14
    v_mov_b32 v5, s12
    v_cndmask_b32 v4, v5, v4, vcc
    v_lshl_add_u32 v4, v4, 4, s10
    v_lshl_add_u32 v224, v4, 7, s3
    s_lshr_b32 s10, s7, 2
    s_lshl_b32 s10, s10, 12
    s_add_u32 s10, s10, 65536
    s_cmp_eq_u32 s4, 4
    s_cselect_b32 s10, s10, s99
    v_lshl_add_u32 v225, v2, 7, s10
L_lt_9:
    s_cmp_eq_u32 s91, 0
    s_cbranch_scc1 L_ew_10
    s_waitcnt vmcnt(0)
L_ew_10:
    s_waitcnt vmcnt(9)
    s_barrier
    s_add_u32 s12, s83, 5
    s_cmp_ge_u32 s12, 9
    s_cselect_b32 s11, 9, 0
    s_sub_u32 s12, s12, s11
    s_lshl_b32 s11, s12, 7
    s_mul_i32 s12, s12, 221184
    s_add_u32 m0, s40, 90112
    s_add_u32 s10, s11, 0
    buffer_load_dwordx4 v16, s[48:51], s10 offen lds
    s_add_u32 m0, s40, 91136
    s_add_u32 s10, s11, 0
    buffer_load_dwordx4 v17, s[48:51], s10 offen lds
    s_add_u32 m0, s40, 92160
    s_add_u32 s10, s11, 0
    buffer_load_dwordx4 v18, s[48:51], s10 offen lds
    s_add_u32 m0, s40, 93184
    s_add_u32 s10, s11, 0
    buffer_load_dwordx4 v19, s[48:51], s10 offen lds
    s_add_u32 m0, s40, 98304
    s_add_u32 s10, s11, 73728
    buffer_load_dwordx4 v16, s[48:51], s10 offen lds
    s_add_u32 m0, s40, 99328
    s_add_u32 s10, s11, 73728
    buffer_load_dwordx4 v17, s[48:51], s10 offen lds
    s_add_u32 m0, s40, 100352
    s_add_u32 s10, s11, 73728
    buffer_load_dwordx4 v18, s[48:51], s10 offen lds
    s_add_u32 m0, s40, 101376
    s_add_u32 s10, s11, 73728
    buffer_load_dwordx4 v19, s[48:51], s10 offen lds
    s_bitcmp1_b32 s90, 0
    s_cbranch_scc0 L_ty_11
    s_add_u32 m0, s40, 106496
    s_add_u32 s10, s12, 0
    buffer_load_dwordx4 v20, s[52:55], s10 offen lds
    s_add_u32 m0, s40, 107520
    s_add_u32 s10, s12, 13824
    buffer_load_dwordx4 v20, s[52:55], s10 offen lds
    s_add_u32 m0, s40, 108544
    s_add_u32 s10, s12, 27648
    buffer_load_dwordx4 v20, s[52:55], s10 offen lds
    s_add_u32 m0, s40, 109568
    s_add_u32 s10, s12, 41472
    buffer_load_dwordx4 v20, s[52:55], s10 offen lds
    s_add_u32 m0, s40, 114688
    s_add_u32 s10, s12, 110592
    buffer_load_dwordx4 v20, s[52:55], s10 offen lds
    s_add_u32 m0, s40, 115712
    s_add_u32 s10, s12, 124416
    buffer_load_dwordx4 v20, s[52:55], s10 offen lds
    s_add_u32 m0, s40, 116736
    s_add_u32 s10, s12, 138240
    buffer_load_dwordx4 v20, s[52:55], s10 offen lds
    s_add_u32 m0, s40, 117760
    s_add_u32 s10, s12, 152064
    buffer_load_dwordx4 v20, s[52:55], s10 offen lds
L_ty_11:
    s_bitcmp1_b32 s90, 1
    s_cbranch_scc0 L_ty_12
    s_add_u32 m0, s41, 122880
    s_add_u32 s10, s11, 0
    buffer_load_dwordx4 v24, s[16:19], s10 offen lds
    s_add_u32 m0, s41, 123904
    s_add_u32 s10, s11, 0
    buffer_load_dwordx4 v25, s[56:59], s10 offen lds
    s_add_u32 m0, s41, 124928
    s_add_u32 s10, s11, 0
    buffer_load_dwordx4 v26, s[16:19], s10 offen lds
    s_add_u32 m0, s41, 129024
    s_add_u32 s10, s11, 27648
    buffer_load_dwordx4 v24, s[16:19], s10 offen lds
    s_add_u32 m0, s41, 130048
    s_add_u32 s10, s11, 27648
    buffer_load_dwordx4 v25, s[56:59], s10 offen lds
    s_add_u32 m0, s41, 131072
    s_add_u32 s10, s11, 27648
    buffer_load_dwordx4 v26, s[16:19], s10 offen lds
L_ty_12:
    s_barrier
    s_cmp_eq_u32 s91, 1
    s_cbranch_scc1 L_lt_13
    s_mov_b32 s64, s32
    s_and_b32 s65, s33, 0xffff
    s_mov_b32 s66, 663552
    s_mov_b32 s67, 0x20000
    s_mov_b32 s68, s34
    s_and_b32 s69, s35, 0xffff
    s_mov_b32 s70, 663552
    s_mov_b32 s71, 0x20000
    s_mov_b32 s76, s20
    s_and_b32 s77, s21, 0xffff
    s_mov_b32 s78, 663552
    s_mov_b32 s79, 0x20000
    s_and_b32 s22, s4, 1
    s_lshr_b32 s23, s4, 1
    s_cmp_ge_u32 s4, 6
    s_cselect_b32 s10, 6, 0
    s_sub_u32 s10, s4, s10
    s_cmp_ge_u32 s10, 3
    s_cselect_b32 s72, s34, s32
    s_cselect_b32 s73, s35, s33
    s_cselect_b32 s12, 3, 0
    s_cselect_b32 s96, 27648, 0
    s_and_b32 s73, s73, 0xffff
    s_mov_b32 s74, 663552
    s_mov_b32 s75, 0x20000
    s_sub_u32 s10, s10, s12
    s_lshl_b32 s12, s10, 10
    s_add_u32 s96, s96, s12
    s_add_u32 s96, s96, 24576
    s_lshl_b32 s10, s10, 6
    s_mul_i32 s14, s8, 72
    s_lshl_b32 s15, s4, 3
    s_add_u32 s15, s15, s14
    s_add_u32 s14, s14, 64
    s_mov_b32 s3, 2731
    s_lshl_b32 s12, s22, 2
    v_add_u32 v4, 0, v0
    v_mul_u32_u24 v5, s3, v4
    v_lshrrev_b32 v5, 16, v5
    v_mul_u32_u24 v6, 24, v5
    v_sub_u32 v6, v4, v6
    v_lshrrev_b32 v7, 1, v5
    v_xor_b32 v7, s12, v7
    v_xor_b32 v6, v6, v7
    v_add_u32 v5, s15, v5
    v_mul_u32_u24 v5, 1152, v5
    v_lshl_add_u32 v213, v6, 4, v5
    v_add_u32 v4, 64, v0
    v_mul_u32_u24 v5, s3, v4
    v_lshrrev_b32 v5, 16, v5
    v_mul_u32_u24 v6, 24, v5
    v_sub_u32 v6, v4, v6
    v_lshrrev_b32 v7, 1, v5
    v_xor_b32 v7, s12, v7
    v_xor_b32 v6, v6, v7
    v_add_u32 v5, s15, v5
    v_mul_u32_u24 v5, 1152, v5
    v_lshl_add_u32 v214, v6, 4, v5
    v_add_u32 v4, 128, v0
    v_mul_u32_u24 v5, s3, v4
    v_lshrrev_b32 v5, 16, v5
    v_mul_u32_u24 v6, 24, v5
    v_sub_u32 v6, v4, v6
    v_lshrrev_b32 v7, 1, v5
    v_xor_b32 v7, s12, v7
    v_xor_b32 v6, v6, v7
    v_add_u32 v5, s15, v5
    v_mul_u32_u24 v5, 1152, v5
    v_lshl_add_u32 v215, v6, 4, v5
    v_add_u32 v4, s10, v0
    v_mul_u32_u24 v5, s3, v4
    v_lshrrev_b32 v5, 16, v5
    v_mul_u32_u24 v6, 24, v5
    v_sub_u32 v6, v4, v6
    v_lshrrev_b32 v7, 1, v5
    v_xor_b32 v6, v6, v7
    v_add_u32 v5, s14, v5
    v_mul_u32_u24 v5, 1152, v5
    v_lshl_add_u32 v216, v6, 4, v5
    s_bitcmp1_b32 s90, 1
    s_cbranch_scc0 L_ty_14
    v_bfe_u32 v4, v0, 3, 1
    v_cmp_eq_u32 vcc, 1, v4
    s_lshl_b32 s10, s4, 1
    s_sub_u32 s10, s10, 8
    v_add_u32 v92, s10, v3
    v_cndmask_b32 v14, 1.0, -1.0, vcc
    v_lshlrev_b32 v13, 4, v92
    v_cvt_f32_u32 v13, v13
    s_mov_b32 s15, 0x41800000
    s_mov_b32 s13, 0x3fb8aa3b
    v_lshlrev_b32 v4, 16, v160
    v_mul_f32 v4, s13, v4
    v_exp_f32 v4, v4
    v_lshlrev_b32 v8, 16, v154
    v_lshlrev_b32 v9, 16, v157
    v_cvt_pk_bf16_f32 v4, v4, v4
    v_lshlrev_b32 v4, 16, v4
    v_mul_f32 v5, v4, v8
    v_mul_f32 v6, v4, v9
    v_mul_f32 v154, s13, v5
    v_mul_f32 v157, 0.15915494, v6
    v_exp_f32 v4, v154
    v_fract_f32 v5, v157
    v_cos_f32 v6, v5
    v_sin_f32 v5, v5
    v_mul_f32 v163, v4, v6
    v_mul_f32 v5, v4, v5
    v_mul_f32 v169, v14, v5
    v_sub_f32 v166, 0, v169
    v_subrev_f32 v4, 1.0, v163
    v_mul_f32 v6, v8, v8
    v_fmac_f32 v6, v9, v9
    v_rcp_f32 v6, v6
    v_mul_f32 v7, v4, v8
    v_fmac_f32 v7, v5, v9
    v_mul_f32 v10, v5, v8
    v_fma_f32 v10, -v4, v9, v10
    v_add_f32 v6, v6, v6
    v_mul_f32 v7, v7, v6
    v_mul_f32 v10, v10, v6
    v_mul_f32 v172, v14, v7
    v_sub_f32 v175, 0, v10
    v_mul_f32 v4, s15, v154
    v_mul_f32 v5, s15, v157
    v_exp_f32 v4, v4
    v_fract_f32 v5, v5
    v_cos_f32 v6, v5
    v_sin_f32 v5, v5
    v_mul_f32 v178, v4, v6
    v_mul_f32 v5, v4, v5
    v_mul_f32 v181, v14, v5
    v_mul_f32 v4, v13, v154
    v_mul_f32 v5, v13, v157
    v_exp_f32 v4, v4
    v_fract_f32 v5, v5
    v_cos_f32 v6, v5
    v_sin_f32 v5, v5
    v_mul_f32 v184, v4, v6
    v_mul_f32 v5, v4, v5
    v_mul_f32 v187, v14, v5
L_ty_14:
L_lt_13:
    s_waitcnt vmcnt(0)
    s_barrier
    s_add_u32 s12, s83, 7
    s_cmp_ge_u32 s12, 9
    s_cselect_b32 s11, 9, 0
    s_sub_u32 s12, s12, s11
    s_lshl_b32 s11, s12, 7
    s_mul_i32 s12, s12, 221184
    s_add_u32 m0, s40, 45056
    s_add_u32 s10, s11, 0
    buffer_load_dwordx4 v16, s[48:51], s10 offen lds
    s_add_u32 m0, s40, 46080
    s_add_u32 s10, s11, 0
    buffer_load_dwordx4 v17, s[48:51], s10 offen lds
    s_add_u32 m0, s40, 47104
    s_add_u32 s10, s11, 0
    buffer_load_dwordx4 v18, s[48:51], s10 offen lds
    s_add_u32 m0, s40, 48128
    s_add_u32 s10, s11, 0
    buffer_load_dwordx4 v19, s[48:51], s10 offen lds
    s_add_u32 m0, s40, 53248
    s_add_u32 s10, s11, 73728
    buffer_load_dwordx4 v16, s[48:51], s10 offen lds
    s_add_u32 m0, s40, 54272
    s_add_u32 s10, s11, 73728
    buffer_load_dwordx4 v17, s[48:51], s10 offen lds
    s_add_u32 m0, s40, 55296
    s_add_u32 s10, s11, 73728
    buffer_load_dwordx4 v18, s[48:51], s10 offen lds
    s_add_u32 m0, s40, 56320
    s_add_u32 s10, s11, 73728
    buffer_load_dwordx4 v19, s[48:51], s10 offen lds
    s_bitcmp1_b32 s90, 0
    s_cbranch_scc0 L_ty_15
    s_add_u32 m0, s40, 61440
    s_add_u32 s10, s12, 0
    buffer_load_dwordx4 v20, s[52:55], s10 offen lds
    s_add_u32 m0, s40, 62464
    s_add_u32 s10, s12, 13824
    buffer_load_dwordx4 v20, s[52:55], s10 offen lds
    s_add_u32 m0, s40, 63488
    s_add_u32 s10, s12, 27648
    buffer_load_dwordx4 v20, s[52:55], s10 offen lds
    s_add_u32 m0, s40, 64512
    s_add_u32 s10, s12, 41472
    buffer_load_dwordx4 v20, s[52:55], s10 offen lds
    s_add_u32 m0, s40, 69632
    s_add_u32 s10, s12, 110592
    buffer_load_dwordx4 v20, s[52:55], s10 offen lds
    s_add_u32 m0, s40, 70656
    s_add_u32 s10, s12, 124416
    buffer_load_dwordx4 v20, s[52:55], s10 offen lds
    s_add_u32 m0, s40, 71680
    s_add_u32 s10, s12, 138240
    buffer_load_dwordx4 v20, s[52:55], s10 offen lds
    s_add_u32 m0, s40, 72704
    s_add_u32 s10, s12, 152064
    buffer_load_dwordx4 v20, s[52:55], s10 offen lds
L_ty_15:
    s_bitcmp1_b32 s90, 1
    s_cbranch_scc0 L_ty_16
    s_add_u32 m0, s41, 77824
    s_add_u32 s10, s11, 0
    buffer_load_dwordx4 v24, s[16:19], s10 offen lds
    s_add_u32 m0, s41, 78848
    s_add_u32 s10, s11, 0
    buffer_load_dwordx4 v25, s[56:59], s10 offen lds
    s_add_u32 m0, s41, 79872
    s_add_u32 s10, s11, 0
    buffer_load_dwordx4 v26, s[16:19], s10 offen lds
    s_add_u32 m0, s41, 83968
    s_add_u32 s10, s11, 27648
    buffer_load_dwordx4 v24, s[16:19], s10 offen lds
    s_add_u32 m0, s41, 84992
    s_add_u32 s10, s11, 27648
    buffer_load_dwordx4 v25, s[56:59], s10 offen lds
    s_add_u32 m0, s41, 86016
    s_add_u32 s10, s11, 27648
    buffer_load_dwordx4 v26, s[16:19], s10 offen lds
L_ty_16:
    s_barrier
    s_cmp_eq_u32 s91, 1
    s_cbranch_scc1 L_lt_17
    s_mul_i32 s14, s8, 144
    v_lshrrev_b32 v4, 3, v0
    v_and_b32 v5, 7, v0
    v_bfe_u32 v6, v4, 1, 1
    v_lshlrev_b32 v6, 2, v6
    v_xor_b32 v5, v5, v6
    v_lshl_add_u32 v5, v5, 4, s14
    v_mul_u32_u24 v6, 1152, v4
    v_add_u32 v217, v5, v6
    v_lshrrev_b32 v6, 1, v4
    v_mul_u32_u24 v6, 18, v6
    v_and_b32 v7, 1, v4
    v_add3_u32 v6, v6, v7, 16
    v_mul_u32_u24 v6, 1152, v6
    v_add_u32 v219, v5, v6
    s_add_u32 s14, s14, 128
    v_lshrrev_b32 v4, 4, v0
    v_mul_u32_u24 v4, 18, v4
    v_and_b32 v5, 15, v0
    v_add_u32 v4, v4, v5
    v_mul_u32_u24 v4, 1152, v4
    v_add_u32 v218, s14, v4
    v_bfe_u32 v4, v0, 1, 2
    v_mul_u32_u24 v4, 18, v4
    v_and_b32 v5, 1, v0
    v_add3_u32 v4, v4, v5, 16
    v_mul_u32_u24 v4, 1152, v4
    v_add_u32 v220, s14, v4
    s_lshl_b32 s10, s7, 1
    s_add_u32 s10, s10, s22
    s_mul_i32 s95, s10, 73728
    s_add_u32 s95, s95, 10485760
    s_lshl_b32 s10, s23, 3
    s_lshl_b32 s12, s22, 1
    s_add_u32 s10, s10, s12
    s_mul_i32 s97, s10, 20736
    s_lshl_b32 s10, s23, 2
    s_add_u32 s10, s10, s12
    s_lshl_b32 s98, s10, 11
    v_bfe_u32 v6, v2, 1, 3
    v_mul_u32_u24 v7, 27648, v3
    v_mul_u32_u24 v8, 384, v2
    v_add_u32 v7, v7, v8
    v_add_u32 v7, 61440, v7
    s_mul_i32 s10, s23, 6
    s_add_u32 s12, s10, 0
    v_xor_b32 v8, s12, v6
    v_lshl_add_u32 v229, v8, 4, v7
    s_add_u32 s12, s10, 1
    v_xor_b32 v8, s12, v6
    v_lshl_add_u32 v230, v8, 4, v7
    s_add_u32 s12, s10, 2
    v_xor_b32 v8, s12, v6
    v_lshl_add_u32 v231, v8, 4, v7
    s_add_u32 s12, s10, 3
    v_xor_b32 v8, s12, v6
    v_lshl_add_u32 v232, v8, 4, v7
    s_add_u32 s12, s10, 4
    v_xor_b32 v8, s12, v6
    v_lshl_add_u32 v233, v8, 4, v7
    s_add_u32 s12, s10, 5
    v_xor_b32 v8, s12, v6
    v_lshl_add_u32 v234, v8, 4, v7
    v_and_b32 v4, 3, v0
    v_bfe_u32 v5, v0, 2, 2
    v_bfe_u32 v6, v0, 4, 1
    v_lshl_add_u32 v7, v3, 3, v5
    v_lshlrev_b32 v8, 7, v7
    v_lshl_add_u32 v8, v6, 5, v8
    v_lshl_add_u32 v8, v4, 3, v8
    v_lshrrev_b32 v5, 1, v5
    v_lshl_add_u32 v235, v5, 6, v8
    v_and_b32 v4, 1, v4
    v_lshlrev_b32 v7, 4, v7
    v_lshl_add_u32 v236, v4, 3, v7
    s_bitcmp1_b32 s90, 1
    s_cbranch_scc0 L_ty_18
    s_mov_b32 s15, 0x41800000
    s_mov_b32 s13, 0x3fb8aa3b
    v_lshlrev_b32 v4, 16, v161
    v_mul_f32 v4, s13, v4
    v_exp_f32 v4, v4
    v_lshlrev_b32 v8, 16, v155
    v_lshlrev_b32 v9, 16, v158
    v_cvt_pk_bf16_f32 v4, v4, v4
    v_lshlrev_b32 v4, 16, v4
    v_mul_f32 v5, v4, v8
    v_mul_f32 v6, v4, v9
    v_mul_f32 v155, s13, v5
    v_mul_f32 v158, 0.15915494, v6
    v_exp_f32 v4, v155
    v_fract_f32 v5, v158
    v_cos_f32 v6, v5
    v_sin_f32 v5, v5
    v_mul_f32 v164, v4, v6
    v_mul_f32 v5, v4, v5
    v_mul_f32 v170, v14, v5
    v_sub_f32 v167, 0, v170
    v_subrev_f32 v4, 1.0, v164
    v_mul_f32 v6, v8, v8
    v_fmac_f32 v6, v9, v9
    v_rcp_f32 v6, v6
    v_mul_f32 v7, v4, v8
    v_fmac_f32 v7, v5, v9
    v_mul_f32 v10, v5, v8
    v_fma_f32 v10, -v4, v9, v10
    v_add_f32 v6, v6, v6
    v_mul_f32 v7, v7, v6
    v_mul_f32 v10, v10, v6
    v_mul_f32 v173, v14, v7
    v_sub_f32 v176, 0, v10
    v_mul_f32 v4, s15, v155
    v_mul_f32 v5, s15, v158
    v_exp_f32 v4, v4
    v_fract_f32 v5, v5
    v_cos_f32 v6, v5
    v_sin_f32 v5, v5
    v_mul_f32 v179, v4, v6
    v_mul_f32 v5, v4, v5
    v_mul_f32 v182, v14, v5
    v_mul_f32 v4, v13, v155
    v_mul_f32 v5, v13, v158
    v_exp_f32 v4, v4
    v_fract_f32 v5, v5
    v_cos_f32 v6, v5
    v_sin_f32 v5, v5
    v_mul_f32 v185, v4, v6
    v_mul_f32 v5, v4, v5
    v_mul_f32 v188, v14, v5
L_ty_18:
L_lt_17:
    s_waitcnt vmcnt(0)
    s_barrier
    s_cmp_eq_u32 s91, 1
    s_cbranch_scc1 L_lt_19
    s_mul_i32 s14, s4, 144
    s_mov_b32 s3, 3641
    s_mul_i32 s12, s7, 147456
    s_mul_i32 s15, s8, 288
    s_add_u32 s12, s12, s15
    s_mul_i32 s15, s8, 144
    v_add_u32 v4, s14, v0
    v_add_u32 v4, 0, v4
    v_mul_u32_u24 v5, s3, v4
    v_lshrrev_b32 v5, 16, v5
    v_mul_u32_u24 v6, 18, v5
    v_sub_u32 v6, v4, v6
    v_mul_u32_u24 v7, 2304, v5
    v_lshl_add_u32 v7, v6, 4, v7
    v_add_u32 v237, s12, v7
    v_lshl_add_u32 v240, v6, 3, s15
    v_lshlrev_b32 v243, 2, v5
    v_add_u32 v4, s14, v0
    v_add_u32 v4, 64, v4
    v_mul_u32_u24 v5, s3, v4
    v_lshrrev_b32 v5, 16, v5
    v_mul_u32_u24 v6, 18, v5
    v_sub_u32 v6, v4, v6
    v_mul_u32_u24 v7, 2304, v5
    v_lshl_add_u32 v7, v6, 4, v7
    v_add_u32 v238, s12, v7
    v_lshl_add_u32 v241, v6, 3, s15
    v_lshlrev_b32 v244, 2, v5
    v_add_u32 v4, s14, v0
    v_add_u32 v4, 128, v4
    v_mul_u32_u24 v5, s3, v4
    v_lshrrev_b32 v5, 16, v5
    v_mul_u32_u24 v6, 18, v5
    v_sub_u32 v6, v4, v6
    v_mul_u32_u24 v7, 2304, v5
    v_lshl_add_u32 v7, v6, 4, v7
    v_add_u32 v239, s12, v7
    v_lshl_add_u32 v242, v6, 3, s15
    v_lshlrev_b32 v245, 2, v5
    s_mul_i32 s10, s23, 18432
    s_mul_i32 s12, s22, 9216
    s_add_u32 s10, s10, s12
    s_cmp_ge_u32 s4, 4
    s_cselect_b32 s12, 24576, 0
    s_add_u32 s10, s10, s12
    v_mul_u32_u24 v4, 288, v2
    v_lshl_add_u32 v4, v3, 4, v4
    v_add_u32 v246, s10, v4
    s_and_b32 s10, s7, 3
    s_lshl_b32 s10, s10, 3
    s_add_u32 s10, s10, s4
    s_cmp_ge_u32 s10, 7
    s_cselect_b32 s12, 7, 0
    s_cmp_ge_u32 s10, 14
    s_cselect_b32 s12, 14, s12
    s_sub_u32 s12, s10, s12
    s_lshl_b32 s12, s12, 6
    v_add_u32 v4, s12, v0
    s_mov_b32 s3, 10923
    v_mul_u32_u24 v5, s3, v4
    v_lshrrev_b32 v5, 16, v5
    v_mul_u32_u24 v6, 6, v5
    v_sub_u32 v6, v4, v6
    v_min_u32 v5, 71, v5
    s_mul_i32 s14, s8, 72
    v_add_u32 v5, s14, v5
    v_mul_u32_u24 v5, 1152, v5
    v_lshl_add_u32 v5, v6, 7, v5
    v_add_u32 v5, 384, v5
    v_lshrrev_b32 v6, 1, v4
    v_mul_u32_u24 v6, 1152, v6
    v_and_b32 v7, 1, v4
    v_mul_u32_u24 v7, 140, v7
    v_add3_u32 v6, v6, v7, s15
    s_cmp_ge_u32 s10, 14
    s_cselect_b64 vcc, -1, 0
    v_cndmask_b32 v226, v5, v6, vcc
    s_bitcmp1_b32 s90, 1
    s_cbranch_scc0 L_ty_20
    s_mov_b32 s15, 0x41800000
    s_mov_b32 s13, 0x3fb8aa3b
    v_lshlrev_b32 v4, 16, v162
    v_mul_f32 v4, s13, v4
    v_exp_f32 v4, v4
    v_lshlrev_b32 v8, 16, v156
    v_lshlrev_b32 v9, 16, v159
    v_cvt_pk_bf16_f32 v4, v4, v4
    v_lshlrev_b32 v4, 16, v4
    v_mul_f32 v5, v4, v8
    v_mul_f32 v6, v4, v9
    v_mul_f32 v156, s13, v5
    v_mul_f32 v159, 0.15915494, v6
    v_exp_f32 v4, v156
    v_fract_f32 v5, v159
    v_cos_f32 v6, v5
    v_sin_f32 v5, v5
    v_mul_f32 v165, v4, v6
    v_mul_f32 v5, v4, v5
    v_mul_f32 v171, v14, v5
    v_sub_f32 v168, 0, v171
    v_subrev_f32 v4, 1.0, v165
    v_mul_f32 v6, v8, v8
    v_fmac_f32 v6, v9, v9
    v_rcp_f32 v6, v6
    v_mul_f32 v7, v4, v8
    v_fmac_f32 v7, v5, v9
    v_mul_f32 v10, v5, v8
    v_fma_f32 v10, -v4, v9, v10
    v_add_f32 v6, v6, v6
    v_mul_f32 v7, v7, v6
    v_mul_f32 v10, v10, v6
    v_mul_f32 v174, v14, v7
    v_sub_f32 v177, 0, v10
    v_mul_f32 v4, s15, v156
    v_mul_f32 v5, s15, v159
    v_exp_f32 v4, v4
    v_fract_f32 v5, v5
    v_cos_f32 v6, v5
    v_sin_f32 v5, v5
    v_mul_f32 v180, v4, v6
    v_mul_f32 v5, v4, v5
    v_mul_f32 v183, v14, v5
    v_mul_f32 v4, v13, v156
    v_mul_f32 v5, v13, v159
    v_exp_f32 v4, v4
    v_fract_f32 v5, v5
    v_cos_f32 v6, v5
    v_sin_f32 v5, v5
    v_mul_f32 v186, v4, v6
    v_mul_f32 v5, v4, v5
    v_mul_f32 v189, v14, v5
L_ty_20:
L_lt_19:
    s_barrier
    s_cmp_eq_u32 s91, 1
    s_cbranch_scc1 L_lt_21
    s_bitcmp1_b32 s90, 1
    s_cbranch_scc0 L_ty_22
    s_sub_u32 s3, s4, 4
    s_mul_i32 s10, s3, 7168
    s_add_u32 s10, s10, 135168
    v_add_u32 v4, s10, v221
    ds_write_b128 v4, v[162:165] offset:0
    ds_write_b128 v4, v[166:169] offset:1024
    ds_write_b128 v4, v[170:173] offset:2048
    ds_write_b128 v4, v[174:177] offset:3072
    ds_write_b128 v4, v[178:181] offset:4096
    ds_write_b128 v4, v[182:185] offset:5120
    ds_write_b128 v4, v[186:189] offset:6144
L_ty_22:
L_lt_21:
    s_waitcnt lgkmcnt(0)
    s_barrier
    s_branch L_loadend
L_pair0:
    s_waitcnt vmcnt(0)
L_early:
    s_mov_b32 s91, 0
    s_bitcmp1_b32 s90, 2
    s_cbranch_scc0 L_ty_23
    s_mul_i32 s15, s84, 48
    s_min_u32 s15, s15, 528
    v_and_b32 v10, 7, v0
    v_bfe_u32 v11, v0, 4, 1
    v_lshl_add_u32 v10, v11, 3, v10
    v_add_lshl_u32 v10, v10, s15, 1
    global_load_ushort v154, v10, s[24:25] offset:0
    global_load_ushort v157, v10, s[26:27] offset:0
    global_load_ushort v160, v10, s[36:37] offset:0
    global_load_ushort v155, v10, s[24:25] offset:32
    global_load_ushort v158, v10, s[26:27] offset:32
    global_load_ushort v161, v10, s[36:37] offset:32
    global_load_ushort v156, v10, s[24:25] offset:64
    global_load_ushort v159, v10, s[26:27] offset:64
    global_load_ushort v162, v10, s[36:37] offset:64
    s_mov_b32 s60, s46
    s_and_b32 s61, s47, 0xffff
    s_mov_b32 s62, 19922944
    s_mov_b32 s63, 0x20000
    v_lshlrev_b32 v221, 4, v0
    v_lshlrev_b32 v205, 3, v0
    v_mul_u32_u24 v4, 5120, v3
    v_lshl_add_u32 v4, v2, 3, v4
    v_add_u32 v206, 1024, v4
    v_mov_b32 v209, 0xdddd
    v_and_b32 v4, 0x13, v2
    v_bfe_u32 v5, v2, 2, 1
    v_lshl_or_b32 v4, v5, 3, v4
    v_bfe_u32 v5, v2, 3, 1
    v_lshl_or_b32 v4, v5, 2, v4
    v_mul_u32_u24 v5, 288, v3
    v_lshl_add_u32 v4, v4, 4, v5
    v_add_u32 v4, 1280, v4
    v_add_u32 v5, 576, v4
    v_and_b32 v6, 27, v2
    v_cmp_eq_u32 vcc, 18, v6
    v_mov_b32 v6, 2496
    v_mov_b32 v7, 2432
    v_cndmask_b32 v6, v7, v6, vcc
    v_cmp_gt_u32 vcc, 18, v2
    s_lshr_b32 s10, s7, 1
    s_mul_i32 s11, s10, 9
    v_cndmask_b32 v207, v6, v4, vcc
    v_cndmask_b32 v208, v6, v5, vcc
    s_mul_i32 s93, s4, 2560
    s_and_b32 s12, s7, 1
    s_mul_i32 s13, s12, 5
    s_add_u32 s13, s13, s11
    s_lshl_b32 s44, s13, 8
    s_add_u32 s14, s44, 4194304
    v_add_u32 v210, s14, v221
    s_add_u32 s11, s11, 4
    s_lshl_b32 s45, s11, 8
    s_add_u32 s14, s45, 4194304
    v_add_u32 v4, s14, v221
    s_mul_i32 s15, s7, 288
    s_add_u32 s15, s15, 7340032
    s_mov_b32 s3, 3641
    v_add_u32 v5, 4294967280, v0
    v_and_b32 v5, 0x7f, v5
    v_mul_u32_u24 v6, s3, v5
    v_lshrrev_b32 v6, 16, v6
    v_mul_u32_u24 v7, 8928, v6
    v_lshl_add_u32 v7, v5, 4, v7
    v_add_u32 v211, s15, v7
    v_add_u32 v5, 48, v0
    v_and_b32 v5, 0x7f, v5
    v_mul_u32_u24 v6, s3, v5
    v_lshrrev_b32 v6, 16, v6
    v_mul_u32_u24 v7, 8928, v6
    v_lshl_add_u32 v7, v5, 4, v7
    v_add_u32 v212, s15, v7
    v_cmp_gt_u32 vcc, 16, v0
    s_mul_i32 s14, s10, 36
    v_bfe_u32 v5, v0, 4, 1
    v_cndmask_b32 v211, v211, v4, vcc
    v_mul_u32_u24 v5, 35, v5
    v_mul_u32_u24 v7, 576, v3
    v_add3_u32 v4, v5, v7, s14
    v_add_u32 v4, 576, v4
    v_lshrrev_b32 v4, 7, v4
    v_and_b32 v8, 15, v0
    v_lshl_add_u32 v4, v4, 4, v8
    s_and_b32 s3, s4, 3
    s_cmp_eq_u32 s3, 0
    s_cselect_b32 s3, 4096, s99
    v_lshl_add_u32 v222, v4, 7, s3
    v_cmp_gt_u32 s[100:101], 4, v8
    v_bfe_u32 v4, v0, 1, 1
    v_mul_u32_u24 v4, 35, v4
    v_add_u32 v4, s14, v4
    v_lshrrev_b32 v4, 7, v4
    v_cmp_gt_u32 vcc, 4, v0
    v_and_b32 v8, 1, v0
    s_lshl_b32 s12, s8, 1
    v_bfe_u32 v7, v0, 1, 1
    v_add_u32 v7, 14, v7
    v_cndmask_b32 v7, v7, v4, vcc
    v_add_u32 v8, s12, v8
    v_lshl_add_u32 v7, v7, 4, v8
    v_lshl_add_u32 v223, v7, 7, s3
    v_cmp_gt_u32 vcc, 12, v0
    v_add_u32 v4, 16, v0
    s_and_b32 s12, s7, 1
    s_add_u32 s12, s12, 14
    v_mov_b32 v5, s12
    v_cndmask_b32 v4, v5, v4, vcc
    v_lshl_add_u32 v4, v4, 4, s10
    v_lshl_add_u32 v224, v4, 7, s3
    s_lshr_b32 s10, s7, 2
    s_lshl_b32 s10, s10, 12
    s_add_u32 s10, s10, 65536
    s_cmp_eq_u32 s4, 4
    s_cselect_b32 s10, s10, s99
    v_lshl_add_u32 v225, v2, 7, s10
    s_mov_b32 s64, s32
    s_and_b32 s65, s33, 0xffff
    s_mov_b32 s66, 663552
    s_mov_b32 s67, 0x20000
    s_mov_b32 s68, s34
    s_and_b32 s69, s35, 0xffff
    s_mov_b32 s70, 663552
    s_mov_b32 s71, 0x20000
    s_mov_b32 s76, s20
    s_and_b32 s77, s21, 0xffff
    s_mov_b32 s78, 663552
    s_mov_b32 s79, 0x20000
    s_and_b32 s22, s4, 1
    s_lshr_b32 s23, s4, 1
    s_cmp_ge_u32 s4, 6
    s_cselect_b32 s10, 6, 0
    s_sub_u32 s10, s4, s10
    s_cmp_ge_u32 s10, 3
    s_cselect_b32 s72, s34, s32
    s_cselect_b32 s73, s35, s33
    s_cselect_b32 s12, 3, 0
    s_cselect_b32 s96, 27648, 0
    s_and_b32 s73, s73, 0xffff
    s_mov_b32 s74, 663552
    s_mov_b32 s75, 0x20000
    s_sub_u32 s10, s10, s12
    s_lshl_b32 s12, s10, 10
    s_add_u32 s96, s96, s12
    s_add_u32 s96, s96, 24576
    s_lshl_b32 s10, s10, 6
    s_mul_i32 s14, s8, 72
    s_lshl_b32 s15, s4, 3
    s_add_u32 s15, s15, s14
    s_add_u32 s14, s14, 64
    s_mov_b32 s3, 2731
    s_lshl_b32 s12, s22, 2
    v_add_u32 v4, 0, v0
    v_mul_u32_u24 v5, s3, v4
    v_lshrrev_b32 v5, 16, v5
    v_mul_u32_u24 v6, 24, v5
    v_sub_u32 v6, v4, v6
    v_lshrrev_b32 v7, 1, v5
    v_xor_b32 v7, s12, v7
    v_xor_b32 v6, v6, v7
    v_add_u32 v5, s15, v5
    v_mul_u32_u24 v5, 1152, v5
    v_lshl_add_u32 v213, v6, 4, v5
    v_add_u32 v4, 64, v0
    v_mul_u32_u24 v5, s3, v4
    v_lshrrev_b32 v5, 16, v5
    v_mul_u32_u24 v6, 24, v5
    v_sub_u32 v6, v4, v6
    v_lshrrev_b32 v7, 1, v5
    v_xor_b32 v7, s12, v7
    v_xor_b32 v6, v6, v7
    v_add_u32 v5, s15, v5
    v_mul_u32_u24 v5, 1152, v5
    v_lshl_add_u32 v214, v6, 4, v5
    v_add_u32 v4, 128, v0
    v_mul_u32_u24 v5, s3, v4
    v_lshrrev_b32 v5, 16, v5
    v_mul_u32_u24 v6, 24, v5
    v_sub_u32 v6, v4, v6
    v_lshrrev_b32 v7, 1, v5
    v_xor_b32 v7, s12, v7
    v_xor_b32 v6, v6, v7
    v_add_u32 v5, s15, v5
    v_mul_u32_u24 v5, 1152, v5
    v_lshl_add_u32 v215, v6, 4, v5
    v_add_u32 v4, s10, v0
    v_mul_u32_u24 v5, s3, v4
    v_lshrrev_b32 v5, 16, v5
    v_mul_u32_u24 v6, 24, v5
    v_sub_u32 v6, v4, v6
    v_lshrrev_b32 v7, 1, v5
    v_xor_b32 v6, v6, v7
    v_add_u32 v5, s14, v5
    v_mul_u32_u24 v5, 1152, v5
    v_lshl_add_u32 v216, v6, 4, v5
    s_mul_i32 s14, s8, 144
    v_lshrrev_b32 v4, 3, v0
    v_and_b32 v5, 7, v0
    v_bfe_u32 v6, v4, 1, 1
    v_lshlrev_b32 v6, 2, v6
    v_xor_b32 v5, v5, v6
    v_lshl_add_u32 v5, v5, 4, s14
    v_mul_u32_u24 v6, 1152, v4
    v_add_u32 v217, v5, v6
    v_lshrrev_b32 v6, 1, v4
    v_mul_u32_u24 v6, 18, v6
    v_and_b32 v7, 1, v4
    v_add3_u32 v6, v6, v7, 16
    v_mul_u32_u24 v6, 1152, v6
    v_add_u32 v219, v5, v6
    s_add_u32 s14, s14, 128
    v_lshrrev_b32 v4, 4, v0
    v_mul_u32_u24 v4, 18, v4
    v_and_b32 v5, 15, v0
    v_add_u32 v4, v4, v5
    v_mul_u32_u24 v4, 1152, v4
    v_add_u32 v218, s14, v4
    v_bfe_u32 v4, v0, 1, 2
    v_mul_u32_u24 v4, 18, v4
    v_and_b32 v5, 1, v0
    v_add3_u32 v4, v4, v5, 16
    v_mul_u32_u24 v4, 1152, v4
    v_add_u32 v220, s14, v4
    s_lshl_b32 s10, s7, 1
    s_add_u32 s10, s10, s22
    s_mul_i32 s95, s10, 73728
    s_add_u32 s95, s95, 10485760
    s_lshl_b32 s10, s23, 3
    s_lshl_b32 s12, s22, 1
    s_add_u32 s10, s10, s12
    s_mul_i32 s97, s10, 20736
    s_lshl_b32 s10, s23, 2
    s_add_u32 s10, s10, s12
    s_lshl_b32 s98, s10, 11
    v_bfe_u32 v6, v2, 1, 3
    v_mul_u32_u24 v7, 27648, v3
    v_mul_u32_u24 v8, 384, v2
    v_add_u32 v7, v7, v8
    v_add_u32 v7, 61440, v7
    s_mul_i32 s10, s23, 6
    s_add_u32 s12, s10, 0
    v_xor_b32 v8, s12, v6
    v_lshl_add_u32 v229, v8, 4, v7
    s_add_u32 s12, s10, 1
    v_xor_b32 v8, s12, v6
    v_lshl_add_u32 v230, v8, 4, v7
    s_add_u32 s12, s10, 2
    v_xor_b32 v8, s12, v6
    v_lshl_add_u32 v231, v8, 4, v7
    s_add_u32 s12, s10, 3
    v_xor_b32 v8, s12, v6
    v_lshl_add_u32 v232, v8, 4, v7
    s_add_u32 s12, s10, 4
    v_xor_b32 v8, s12, v6
    v_lshl_add_u32 v233, v8, 4, v7
    s_add_u32 s12, s10, 5
    v_xor_b32 v8, s12, v6
    v_lshl_add_u32 v234, v8, 4, v7
    v_and_b32 v4, 3, v0
    v_bfe_u32 v5, v0, 2, 2
    v_bfe_u32 v6, v0, 4, 1
    v_lshl_add_u32 v7, v3, 3, v5
    v_lshlrev_b32 v8, 7, v7
    v_lshl_add_u32 v8, v6, 5, v8
    v_lshl_add_u32 v8, v4, 3, v8
    v_lshrrev_b32 v5, 1, v5
    v_lshl_add_u32 v235, v5, 6, v8
    v_and_b32 v4, 1, v4
    v_lshlrev_b32 v7, 4, v7
    v_lshl_add_u32 v236, v4, 3, v7
    s_mul_i32 s14, s4, 144
    s_mov_b32 s3, 3641
    s_mul_i32 s12, s7, 147456
    s_mul_i32 s15, s8, 288
    s_add_u32 s12, s12, s15
    s_mul_i32 s15, s8, 144
    v_add_u32 v4, s14, v0
    v_add_u32 v4, 0, v4
    v_mul_u32_u24 v5, s3, v4
    v_lshrrev_b32 v5, 16, v5
    v_mul_u32_u24 v6, 18, v5
    v_sub_u32 v6, v4, v6
    v_mul_u32_u24 v7, 2304, v5
    v_lshl_add_u32 v7, v6, 4, v7
    v_add_u32 v237, s12, v7
    v_lshl_add_u32 v240, v6, 3, s15
    v_lshlrev_b32 v243, 2, v5
    v_add_u32 v4, s14, v0
    v_add_u32 v4, 64, v4
    v_mul_u32_u24 v5, s3, v4
    v_lshrrev_b32 v5, 16, v5
    v_mul_u32_u24 v6, 18, v5
    v_sub_u32 v6, v4, v6
    v_mul_u32_u24 v7, 2304, v5
    v_lshl_add_u32 v7, v6, 4, v7
    v_add_u32 v238, s12, v7
    v_lshl_add_u32 v241, v6, 3, s15
    v_lshlrev_b32 v244, 2, v5
    v_add_u32 v4, s14, v0
    v_add_u32 v4, 128, v4
    v_mul_u32_u24 v5, s3, v4
    v_lshrrev_b32 v5, 16, v5
    v_mul_u32_u24 v6, 18, v5
    v_sub_u32 v6, v4, v6
    v_mul_u32_u24 v7, 2304, v5
    v_lshl_add_u32 v7, v6, 4, v7
    v_add_u32 v239, s12, v7
    v_lshl_add_u32 v242, v6, 3, s15
    v_lshlrev_b32 v245, 2, v5
    s_mul_i32 s10, s23, 18432
    s_mul_i32 s12, s22, 9216
    s_add_u32 s10, s10, s12
    s_cmp_ge_u32 s4, 4
    s_cselect_b32 s12, 24576, 0
    s_add_u32 s10, s10, s12
    v_mul_u32_u24 v4, 288, v2
    v_lshl_add_u32 v4, v3, 4, v4
    v_add_u32 v246, s10, v4
    s_and_b32 s10, s7, 3
    s_lshl_b32 s10, s10, 3
    s_add_u32 s10, s10, s4
    s_cmp_ge_u32 s10, 7
    s_cselect_b32 s12, 7, 0
    s_cmp_ge_u32 s10, 14
    s_cselect_b32 s12, 14, s12
    s_sub_u32 s12, s10, s12
    s_lshl_b32 s12, s12, 6
    v_add_u32 v4, s12, v0
    s_mov_b32 s3, 10923
    v_mul_u32_u24 v5, s3, v4
    v_lshrrev_b32 v5, 16, v5
    v_mul_u32_u24 v6, 6, v5
    v_sub_u32 v6, v4, v6
    v_min_u32 v5, 71, v5
    s_mul_i32 s14, s8, 72
    v_add_u32 v5, s14, v5
    v_mul_u32_u24 v5, 1152, v5
    v_lshl_add_u32 v5, v6, 7, v5
    v_add_u32 v5, 384, v5
    v_lshrrev_b32 v6, 1, v4
    v_mul_u32_u24 v6, 1152, v6
    v_and_b32 v7, 1, v4
    v_mul_u32_u24 v7, 140, v7
    v_add3_u32 v6, v6, v7, s15
    s_cmp_ge_u32 s10, 14
    s_cselect_b64 vcc, -1, 0
    v_cndmask_b32 v226, v5, v6, vcc
    s_waitcnt vmcnt(0)
    v_bfe_u32 v4, v0, 3, 1
    v_cmp_eq_u32 vcc, 1, v4
    s_lshl_b32 s10, s4, 1
    s_sub_u32 s10, s10, 8
    v_add_u32 v92, s10, v3
    v_cndmask_b32 v14, 1.0, -1.0, vcc
    v_lshlrev_b32 v13, 4, v92
    v_cvt_f32_u32 v13, v13
    s_mov_b32 s15, 0x41800000
    s_mov_b32 s13, 0x3fb8aa3b
    v_lshlrev_b32 v4, 16, v160
    v_mul_f32 v4, s13, v4
    v_exp_f32 v4, v4
    v_lshlrev_b32 v8, 16, v154
    v_lshlrev_b32 v9, 16, v157
    v_cvt_pk_bf16_f32 v4, v4, v4
    v_lshlrev_b32 v4, 16, v4
    v_mul_f32 v5, v4, v8
    v_mul_f32 v6, v4, v9
    v_mul_f32 v154, s13, v5
    v_mul_f32 v157, 0.15915494, v6
    v_exp_f32 v4, v154
    v_fract_f32 v5, v157
    v_cos_f32 v6, v5
    v_sin_f32 v5, v5
    v_mul_f32 v163, v4, v6
    v_mul_f32 v5, v4, v5
    v_mul_f32 v169, v14, v5
    v_sub_f32 v166, 0, v169
    v_subrev_f32 v4, 1.0, v163
    v_mul_f32 v6, v8, v8
    v_fmac_f32 v6, v9, v9
    v_rcp_f32 v6, v6
    v_mul_f32 v7, v4, v8
    v_fmac_f32 v7, v5, v9
    v_mul_f32 v10, v5, v8
    v_fma_f32 v10, -v4, v9, v10
    v_add_f32 v6, v6, v6
    v_mul_f32 v7, v7, v6
    v_mul_f32 v10, v10, v6
    v_mul_f32 v172, v14, v7
    v_sub_f32 v175, 0, v10
    v_mul_f32 v4, s15, v154
    v_mul_f32 v5, s15, v157
    v_exp_f32 v4, v4
    v_fract_f32 v5, v5
    v_cos_f32 v6, v5
    v_sin_f32 v5, v5
    v_mul_f32 v178, v4, v6
    v_mul_f32 v5, v4, v5
    v_mul_f32 v181, v14, v5
    v_mul_f32 v4, v13, v154
    v_mul_f32 v5, v13, v157
    v_exp_f32 v4, v4
    v_fract_f32 v5, v5
    v_cos_f32 v6, v5
    v_sin_f32 v5, v5
    v_mul_f32 v184, v4, v6
    v_mul_f32 v5, v4, v5
    v_mul_f32 v187, v14, v5
    s_mov_b32 s15, 0x41800000
    s_mov_b32 s13, 0x3fb8aa3b
    v_lshlrev_b32 v4, 16, v161
    v_mul_f32 v4, s13, v4
    v_exp_f32 v4, v4
    v_lshlrev_b32 v8, 16, v155
    v_lshlrev_b32 v9, 16, v158
    v_cvt_pk_bf16_f32 v4, v4, v4
    v_lshlrev_b32 v4, 16, v4
    v_mul_f32 v5, v4, v8
    v_mul_f32 v6, v4, v9
    v_mul_f32 v155, s13, v5
    v_mul_f32 v158, 0.15915494, v6
    v_exp_f32 v4, v155
    v_fract_f32 v5, v158
    v_cos_f32 v6, v5
    v_sin_f32 v5, v5
    v_mul_f32 v164, v4, v6
    v_mul_f32 v5, v4, v5
    v_mul_f32 v170, v14, v5
    v_sub_f32 v167, 0, v170
    v_subrev_f32 v4, 1.0, v164
    v_mul_f32 v6, v8, v8
    v_fmac_f32 v6, v9, v9
    v_rcp_f32 v6, v6
    v_mul_f32 v7, v4, v8
    v_fmac_f32 v7, v5, v9
    v_mul_f32 v10, v5, v8
    v_fma_f32 v10, -v4, v9, v10
    v_add_f32 v6, v6, v6
    v_mul_f32 v7, v7, v6
    v_mul_f32 v10, v10, v6
    v_mul_f32 v173, v14, v7
    v_sub_f32 v176, 0, v10
    v_mul_f32 v4, s15, v155
    v_mul_f32 v5, s15, v158
    v_exp_f32 v4, v4
    v_fract_f32 v5, v5
    v_cos_f32 v6, v5
    v_sin_f32 v5, v5
    v_mul_f32 v179, v4, v6
    v_mul_f32 v5, v4, v5
    v_mul_f32 v182, v14, v5
    v_mul_f32 v4, v13, v155
    v_mul_f32 v5, v13, v158
    v_exp_f32 v4, v4
    v_fract_f32 v5, v5
    v_cos_f32 v6, v5
    v_sin_f32 v5, v5
    v_mul_f32 v185, v4, v6
    v_mul_f32 v5, v4, v5
    v_mul_f32 v188, v14, v5
    s_mov_b32 s15, 0x41800000
    s_mov_b32 s13, 0x3fb8aa3b
    v_lshlrev_b32 v4, 16, v162
    v_mul_f32 v4, s13, v4
    v_exp_f32 v4, v4
    v_lshlrev_b32 v8, 16, v156
    v_lshlrev_b32 v9, 16, v159
    v_cvt_pk_bf16_f32 v4, v4, v4
    v_lshlrev_b32 v4, 16, v4
    v_mul_f32 v5, v4, v8
    v_mul_f32 v6, v4, v9
    v_mul_f32 v156, s13, v5
    v_mul_f32 v159, 0.15915494, v6
    v_exp_f32 v4, v156
    v_fract_f32 v5, v159
    v_cos_f32 v6, v5
    v_sin_f32 v5, v5
    v_mul_f32 v165, v4, v6
    v_mul_f32 v5, v4, v5
    v_mul_f32 v171, v14, v5
    v_sub_f32 v168, 0, v171
    v_subrev_f32 v4, 1.0, v165
    v_mul_f32 v6, v8, v8
    v_fmac_f32 v6, v9, v9
    v_rcp_f32 v6, v6
    v_mul_f32 v7, v4, v8
    v_fmac_f32 v7, v5, v9
    v_mul_f32 v10, v5, v8
    v_fma_f32 v10, -v4, v9, v10
    v_add_f32 v6, v6, v6
    v_mul_f32 v7, v7, v6
    v_mul_f32 v10, v10, v6
    v_mul_f32 v174, v14, v7
    v_sub_f32 v177, 0, v10
    v_mul_f32 v4, s15, v156
    v_mul_f32 v5, s15, v159
    v_exp_f32 v4, v4
    v_fract_f32 v5, v5
    v_cos_f32 v6, v5
    v_sin_f32 v5, v5
    v_mul_f32 v180, v4, v6
    v_mul_f32 v5, v4, v5
    v_mul_f32 v183, v14, v5
    v_mul_f32 v4, v13, v156
    v_mul_f32 v5, v13, v159
    v_exp_f32 v4, v4
    v_fract_f32 v5, v5
    v_cos_f32 v6, v5
    v_sin_f32 v5, v5
    v_mul_f32 v186, v4, v6
    v_mul_f32 v5, v4, v5
    v_mul_f32 v189, v14, v5
    s_sub_u32 s3, s4, 4
    s_mul_i32 s10, s3, 7168
    s_add_u32 s10, s10, 135168
    v_add_u32 v4, s10, v221
    ds_write_b128 v4, v[162:165] offset:0
    ds_write_b128 v4, v[166:169] offset:1024
    ds_write_b128 v4, v[170:173] offset:2048
    ds_write_b128 v4, v[174:177] offset:3072
    ds_write_b128 v4, v[178:181] offset:4096
    ds_write_b128 v4, v[182:185] offset:5120
    ds_write_b128 v4, v[186:189] offset:6144
    s_mov_b32 s91, 1
L_ty_23:
    s_cmp_ge_u32 s4, 6
    s_cbranch_scc1 L_back1
    s_waitcnt lgkmcnt(0)
    s_barrier
    s_mul_i32 s9, s9, 0x9E3779B1
    s_add_u32 s9, s9, 0x7F4A7C15
    s_add_u32 s12, s83, 2
    s_cmp_ge_u32 s12, 9
    s_cselect_b32 s11, 9, 0
    s_sub_u32 s12, s12, s11
    s_lshl_b32 s11, s12, 7
    s_mul_i32 s12, s12, 221184
    s_add_u32 m0, s40, 90112
    s_add_u32 s10, s11, 0
    buffer_load_dwordx4 v16, s[48:51], s10 offen lds
    s_add_u32 m0, s40, 91136
    s_add_u32 s10, s11, 0
    buffer_load_dwordx4 v17, s[48:51], s10 offen lds
    s_add_u32 m0, s40, 92160
    s_add_u32 s10, s11, 0
    buffer_load_dwordx4 v18, s[48:51], s10 offen lds
    s_add_u32 m0, s40, 93184
    s_add_u32 s10, s11, 0
    buffer_load_dwordx4 v19, s[48:51], s10 offen lds
    s_add_u32 m0, s40, 98304
    s_add_u32 s10, s11, 73728
    buffer_load_dwordx4 v16, s[48:51], s10 offen lds
    s_add_u32 m0, s40, 99328
    s_add_u32 s10, s11, 73728
    buffer_load_dwordx4 v17, s[48:51], s10 offen lds
    s_add_u32 m0, s40, 100352
    s_add_u32 s10, s11, 73728
    buffer_load_dwordx4 v18, s[48:51], s10 offen lds
    s_add_u32 m0, s40, 101376
    s_add_u32 s10, s11, 73728
    buffer_load_dwordx4 v19, s[48:51], s10 offen lds
    s_bitcmp1_b32 s90, 0
    s_cbranch_scc0 L_ty_24
    s_add_u32 m0, s40, 106496
    s_add_u32 s10, s12, 0
    buffer_load_dwordx4 v20, s[52:55], s10 offen lds
    s_add_u32 m0, s40, 107520
    s_add_u32 s10, s12, 13824
    buffer_load_dwordx4 v20, s[52:55], s10 offen lds
    s_add_u32 m0, s40, 108544
    s_add_u32 s10, s12, 27648
    buffer_load_dwordx4 v20, s[52:55], s10 offen lds
    s_add_u32 m0, s40, 109568
    s_add_u32 s10, s12, 41472
    buffer_load_dwordx4 v20, s[52:55], s10 offen lds
    s_add_u32 m0, s40, 114688
    s_add_u32 s10, s12, 110592
    buffer_load_dwordx4 v20, s[52:55], s10 offen lds
    s_add_u32 m0, s40, 115712
    s_add_u32 s10, s12, 124416
    buffer_load_dwordx4 v20, s[52:55], s10 offen lds
    s_add_u32 m0, s40, 116736
    s_add_u32 s10, s12, 138240
    buffer_load_dwordx4 v20, s[52:55], s10 offen lds
    s_add_u32 m0, s40, 117760
    s_add_u32 s10, s12, 152064
    buffer_load_dwordx4 v20, s[52:55], s10 offen lds
L_ty_24:
    s_bitcmp1_b32 s90, 1
    s_cbranch_scc0 L_ty_25
    s_add_u32 m0, s41, 122880
    s_add_u32 s10, s11, 0
    buffer_load_dwordx4 v24, s[16:19], s10 offen lds
    s_add_u32 m0, s41, 123904
    s_add_u32 s10, s11, 0
    buffer_load_dwordx4 v25, s[56:59], s10 offen lds
    s_add_u32 m0, s41, 124928
    s_add_u32 s10, s11, 0
    buffer_load_dwordx4 v26, s[16:19], s10 offen lds
    s_add_u32 m0, s41, 129024
    s_add_u32 s10, s11, 27648
    buffer_load_dwordx4 v24, s[16:19], s10 offen lds
    s_add_u32 m0, s41, 130048
    s_add_u32 s10, s11, 27648
    buffer_load_dwordx4 v25, s[56:59], s10 offen lds
    s_add_u32 m0, s41, 131072
    s_add_u32 s10, s11, 27648
    buffer_load_dwordx4 v26, s[16:19], s10 offen lds
L_ty_25:
    s_barrier
    s_cmp_eq_u32 s91, 1
    s_cbranch_scc1 L_lt_26
    s_mul_i32 s15, s84, 48
    s_min_u32 s15, s15, 528
    v_and_b32 v10, 7, v0
    v_bfe_u32 v11, v0, 4, 1
    v_lshl_add_u32 v10, v11, 3, v10
    v_add_lshl_u32 v10, v10, s15, 1
    global_load_ushort v154, v10, s[24:25] offset:0
    global_load_ushort v157, v10, s[26:27] offset:0
    global_load_ushort v160, v10, s[36:37] offset:0
    global_load_ushort v155, v10, s[24:25] offset:32
    global_load_ushort v158, v10, s[26:27] offset:32
    global_load_ushort v161, v10, s[36:37] offset:32
    global_load_ushort v156, v10, s[24:25] offset:64
    global_load_ushort v159, v10, s[26:27] offset:64
    global_load_ushort v162, v10, s[36:37] offset:64
    s_mov_b32 s60, s46
    s_and_b32 s61, s47, 0xffff
    s_mov_b32 s62, 19922944
    s_mov_b32 s63, 0x20000
    v_lshlrev_b32 v221, 4, v0
    v_lshlrev_b32 v205, 3, v0
    v_mul_u32_u24 v4, 5120, v3
    v_lshl_add_u32 v4, v2, 3, v4
    v_add_u32 v206, 1024, v4
    v_mov_b32 v209, 0xdddd
    v_and_b32 v4, 0x13, v2
    v_bfe_u32 v5, v2, 2, 1
    v_lshl_or_b32 v4, v5, 3, v4
    v_bfe_u32 v5, v2, 3, 1
    v_lshl_or_b32 v4, v5, 2, v4
    v_mul_u32_u24 v5, 288, v3
    v_lshl_add_u32 v4, v4, 4, v5
    v_add_u32 v4, 1280, v4
    v_add_u32 v5, 576, v4
    v_and_b32 v6, 27, v2
    v_cmp_eq_u32 vcc, 18, v6
    v_mov_b32 v6, 2496
    v_mov_b32 v7, 2432
    v_cndmask_b32 v6, v7, v6, vcc
    v_cmp_gt_u32 vcc, 18, v2
    s_lshr_b32 s10, s7, 1
    s_mul_i32 s11, s10, 9
    v_cndmask_b32 v207, v6, v4, vcc
    v_cndmask_b32 v208, v6, v5, vcc
    s_mul_i32 s93, s4, 2560
    s_and_b32 s12, s7, 1
    s_mul_i32 s13, s12, 5
    s_add_u32 s13, s13, s11
    s_lshl_b32 s44, s13, 8
    s_add_u32 s14, s44, 4194304
    v_add_u32 v210, s14, v221
    s_add_u32 s11, s11, 4
    s_lshl_b32 s45, s11, 8
    s_add_u32 s14, s45, 4194304
    v_add_u32 v4, s14, v221
    s_mul_i32 s15, s7, 288
    s_add_u32 s15, s15, 7340032
    s_mov_b32 s3, 3641
    v_add_u32 v5, 4294967280, v0
    v_and_b32 v5, 0x7f, v5
    v_mul_u32_u24 v6, s3, v5
    v_lshrrev_b32 v6, 16, v6
    v_mul_u32_u24 v7, 8928, v6
    v_lshl_add_u32 v7, v5, 4, v7
    v_add_u32 v211, s15, v7
    v_add_u32 v5, 48, v0
    v_and_b32 v5, 0x7f, v5
    v_mul_u32_u24 v6, s3, v5
    v_lshrrev_b32 v6, 16, v6
    v_mul_u32_u24 v7, 8928, v6
    v_lshl_add_u32 v7, v5, 4, v7
    v_add_u32 v212, s15, v7
    v_cmp_gt_u32 vcc, 16, v0
    s_mul_i32 s14, s10, 36
    v_bfe_u32 v5, v0, 4, 1
    v_cndmask_b32 v211, v211, v4, vcc
    v_mul_u32_u24 v5, 35, v5
    v_mul_u32_u24 v7, 576, v3
    v_add3_u32 v4, v5, v7, s14
    v_add_u32 v4, 576, v4
    v_lshrrev_b32 v4, 7, v4
    v_and_b32 v8, 15, v0
    v_lshl_add_u32 v4, v4, 4, v8
    s_and_b32 s3, s4, 3
    s_cmp_eq_u32 s3, 0
    s_cselect_b32 s3, 4096, s99
    v_lshl_add_u32 v222, v4, 7, s3
    v_cmp_gt_u32 s[100:101], 4, v8
    v_bfe_u32 v4, v0, 1, 1
    v_mul_u32_u24 v4, 35, v4
    v_add_u32 v4, s14, v4
    v_lshrrev_b32 v4, 7, v4
    v_cmp_gt_u32 vcc, 4, v0
    v_and_b32 v8, 1, v0
    s_lshl_b32 s12, s8, 1
    v_bfe_u32 v7, v0, 1, 1
    v_add_u32 v7, 14, v7
    v_cndmask_b32 v7, v7, v4, vcc
    v_add_u32 v8, s12, v8
    v_lshl_add_u32 v7, v7, 4, v8
    v_lshl_add_u32 v223, v7, 7, s3
    v_cmp_gt_u32 vcc, 12, v0
    v_add_u32 v4, 16, v0
    s_and_b32 s12, s7, 1
    s_add_u32 s12, s12, 14
    v_mov_b32 v5, s12
    v_cndmask_b32 v4, v5, v4, vcc
    v_lshl_add_u32 v4, v4, 4, s10
    v_lshl_add_u32 v224, v4, 7, s3
    s_lshr_b32 s10, s7, 2
    s_lshl_b32 s10, s10, 12
    s_add_u32 s10, s10, 65536
    s_cmp_eq_u32 s4, 4
    s_cselect_b32 s10, s10, s99
    v_lshl_add_u32 v225, v2, 7, s10
L_lt_26:
    s_and_b32 s14, s2, 1
    s_add_u32 s14, s14, 14
    s_lshl_b32 s10, s14, 4
    s_add_u32 s10, s10, s5
    s_lshl_b32 s10, s10, 7
    s_add_u32 s10, s10, 4096
    s_bitcmp1_b32 s90, 2
    s_cselect_b32 s10, s10, s99
    s_cmp_eq_u32 s4, 4
    s_cselect_b32 s10, s10, s99
    v_mov_b32 v4, s10
    v_mov_b32 v5, s9
    s_mov_b64 exec, 1
    buffer_store_dword v5, v4, s[60:63], 0 offen sc1
    s_mov_b64 exec, -1
    s_cmp_eq_u32 s91, 0
    s_cbranch_scc1 L_ew_27
    s_waitcnt vmcnt(1)
L_ew_27:
    s_waitcnt vmcnt(10)
    s_barrier
    s_add_u32 s12, s83, 4
    s_cmp_ge_u32 s12, 9
    s_cselect_b32 s11, 9, 0
    s_sub_u32 s12, s12, s11
    s_lshl_b32 s11, s12, 7
    s_mul_i32 s12, s12, 221184
    s_add_u32 m0, s40, 45056
    s_add_u32 s10, s11, 0
    buffer_load_dwordx4 v16, s[48:51], s10 offen lds
    s_add_u32 m0, s40, 46080
    s_add_u32 s10, s11, 0
    buffer_load_dwordx4 v17, s[48:51], s10 offen lds
    s_add_u32 m0, s40, 47104
    s_add_u32 s10, s11, 0
    buffer_load_dwordx4 v18, s[48:51], s10 offen lds
    s_add_u32 m0, s40, 48128
    s_add_u32 s10, s11, 0
    buffer_load_dwordx4 v19, s[48:51], s10 offen lds
    s_add_u32 m0, s40, 53248
    s_add_u32 s10, s11, 73728
    buffer_load_dwordx4 v16, s[48:51], s10 offen lds
    s_add_u32 m0, s40, 54272
    s_add_u32 s10, s11, 73728
    buffer_load_dwordx4 v17, s[48:51], s10 offen lds
    s_add_u32 m0, s40, 55296
    s_add_u32 s10, s11, 73728
    buffer_load_dwordx4 v18, s[48:51], s10 offen lds
    s_add_u32 m0, s40, 56320
    s_add_u32 s10, s11, 73728
    buffer_load_dwordx4 v19, s[48:51], s10 offen lds
    s_bitcmp1_b32 s90, 0
    s_cbranch_scc0 L_ty_28
    s_add_u32 m0, s40, 61440
    s_add_u32 s10, s12, 0
    buffer_load_dwordx4 v20, s[52:55], s10 offen lds
    s_add_u32 m0, s40, 62464
    s_add_u32 s10, s12, 13824
    buffer_load_dwordx4 v20, s[52:55], s10 offen lds
    s_add_u32 m0, s40, 63488
    s_add_u32 s10, s12, 27648
    buffer_load_dwordx4 v20, s[52:55], s10 offen lds
    s_add_u32 m0, s40, 64512
    s_add_u32 s10, s12, 41472
    buffer_load_dwordx4 v20, s[52:55], s10 offen lds
    s_add_u32 m0, s40, 69632
    s_add_u32 s10, s12, 110592
    buffer_load_dwordx4 v20, s[52:55], s10 offen lds
    s_add_u32 m0, s40, 70656
    s_add_u32 s10, s12, 124416
    buffer_load_dwordx4 v20, s[52:55], s10 offen lds
    s_add_u32 m0, s40, 71680
    s_add_u32 s10, s12, 138240
    buffer_load_dwordx4 v20, s[52:55], s10 offen lds
    s_add_u32 m0, s40, 72704
    s_add_u32 s10, s12, 152064
    buffer_load_dwordx4 v20, s[52:55], s10 offen lds
L_ty_28:
    s_bitcmp1_b32 s90, 1
    s_cbranch_scc0 L_ty_29
    s_add_u32 m0, s41, 77824
    s_add_u32 s10, s11, 0
    buffer_load_dwordx4 v24, s[16:19], s10 offen lds
    s_add_u32 m0, s41, 78848
    s_add_u32 s10, s11, 0
    buffer_load_dwordx4 v25, s[56:59], s10 offen lds
    s_add_u32 m0, s41, 79872
    s_add_u32 s10, s11, 0
    buffer_load_dwordx4 v26, s[16:19], s10 offen lds
    s_add_u32 m0, s41, 83968
    s_add_u32 s10, s11, 27648
    buffer_load_dwordx4 v24, s[16:19], s10 offen lds
    s_add_u32 m0, s41, 84992
    s_add_u32 s10, s11, 27648
    buffer_load_dwordx4 v25, s[56:59], s10 offen lds
    s_add_u32 m0, s41, 86016
    s_add_u32 s10, s11, 27648
    buffer_load_dwordx4 v26, s[16:19], s10 offen lds
L_ty_29:
    s_barrier
    s_cmp_eq_u32 s91, 1
    s_cbranch_scc1 L_lt_30
    s_mov_b32 s64, s32
    s_and_b32 s65, s33, 0xffff
    s_mov_b32 s66, 663552
    s_mov_b32 s67, 0x20000
    s_mov_b32 s68, s34
    s_and_b32 s69, s35, 0xffff
    s_mov_b32 s70, 663552
    s_mov_b32 s71, 0x20000
    s_mov_b32 s76, s20
    s_and_b32 s77, s21, 0xffff
    s_mov_b32 s78, 663552
    s_mov_b32 s79, 0x20000
    s_and_b32 s22, s4, 1
    s_lshr_b32 s23, s4, 1
    s_cmp_ge_u32 s4, 6
    s_cselect_b32 s10, 6, 0
    s_sub_u32 s10, s4, s10
    s_cmp_ge_u32 s10, 3
    s_cselect_b32 s72, s34, s32
    s_cselect_b32 s73, s35, s33
    s_cselect_b32 s12, 3, 0
    s_cselect_b32 s96, 27648, 0
    s_and_b32 s73, s73, 0xffff
    s_mov_b32 s74, 663552
    s_mov_b32 s75, 0x20000
    s_sub_u32 s10, s10, s12
    s_lshl_b32 s12, s10, 10
    s_add_u32 s96, s96, s12
    s_add_u32 s96, s96, 24576
    s_lshl_b32 s10, s10, 6
    s_mul_i32 s14, s8, 72
    s_lshl_b32 s15, s4, 3
    s_add_u32 s15, s15, s14
    s_add_u32 s14, s14, 64
    s_mov_b32 s3, 2731
    s_lshl_b32 s12, s22, 2
    v_add_u32 v4, 0, v0
    v_mul_u32_u24 v5, s3, v4
    v_lshrrev_b32 v5, 16, v5
    v_mul_u32_u24 v6, 24, v5
    v_sub_u32 v6, v4, v6
    v_lshrrev_b32 v7, 1, v5
    v_xor_b32 v7, s12, v7
    v_xor_b32 v6, v6, v7
    v_add_u32 v5, s15, v5
    v_mul_u32_u24 v5, 1152, v5
    v_lshl_add_u32 v213, v6, 4, v5
    v_add_u32 v4, 64, v0
    v_mul_u32_u24 v5, s3, v4
    v_lshrrev_b32 v5, 16, v5
    v_mul_u32_u24 v6, 24, v5
    v_sub_u32 v6, v4, v6
    v_lshrrev_b32 v7, 1, v5
    v_xor_b32 v7, s12, v7
    v_xor_b32 v6, v6, v7
    v_add_u32 v5, s15, v5
    v_mul_u32_u24 v5, 1152, v5
    v_lshl_add_u32 v214, v6, 4, v5
    v_add_u32 v4, 128, v0
    v_mul_u32_u24 v5, s3, v4
    v_lshrrev_b32 v5, 16, v5
    v_mul_u32_u24 v6, 24, v5
    v_sub_u32 v6, v4, v6
    v_lshrrev_b32 v7, 1, v5
    v_xor_b32 v7, s12, v7
    v_xor_b32 v6, v6, v7
    v_add_u32 v5, s15, v5
    v_mul_u32_u24 v5, 1152, v5
    v_lshl_add_u32 v215, v6, 4, v5
    v_add_u32 v4, s10, v0
    v_mul_u32_u24 v5, s3, v4
    v_lshrrev_b32 v5, 16, v5
    v_mul_u32_u24 v6, 24, v5
    v_sub_u32 v6, v4, v6
    v_lshrrev_b32 v7, 1, v5
    v_xor_b32 v6, v6, v7
    v_add_u32 v5, s14, v5
    v_mul_u32_u24 v5, 1152, v5
    v_lshl_add_u32 v216, v6, 4, v5
    s_bitcmp1_b32 s90, 1
    s_cbranch_scc0 L_ty_31
    v_bfe_u32 v4, v0, 3, 1
    v_cmp_eq_u32 vcc, 1, v4
    s_lshl_b32 s10, s4, 1
    s_sub_u32 s10, s10, 8
    v_add_u32 v92, s10, v3
    v_cndmask_b32 v14, 1.0, -1.0, vcc
    v_lshlrev_b32 v13, 4, v92
    v_cvt_f32_u32 v13, v13
    s_mov_b32 s15, 0x41800000
    s_mov_b32 s13, 0x3fb8aa3b
    v_lshlrev_b32 v4, 16, v160
    v_mul_f32 v4, s13, v4
    v_exp_f32 v4, v4
    v_lshlrev_b32 v8, 16, v154
    v_lshlrev_b32 v9, 16, v157
    v_cvt_pk_bf16_f32 v4, v4, v4
    v_lshlrev_b32 v4, 16, v4
    v_mul_f32 v5, v4, v8
    v_mul_f32 v6, v4, v9
    v_mul_f32 v154, s13, v5
    v_mul_f32 v157, 0.15915494, v6
    v_exp_f32 v4, v154
    v_fract_f32 v5, v157
    v_cos_f32 v6, v5
    v_sin_f32 v5, v5
    v_mul_f32 v163, v4, v6
    v_mul_f32 v5, v4, v5
    v_mul_f32 v169, v14, v5
    v_sub_f32 v166, 0, v169
    v_subrev_f32 v4, 1.0, v163
    v_mul_f32 v6, v8, v8
    v_fmac_f32 v6, v9, v9
    v_rcp_f32 v6, v6
    v_mul_f32 v7, v4, v8
    v_fmac_f32 v7, v5, v9
    v_mul_f32 v10, v5, v8
    v_fma_f32 v10, -v4, v9, v10
    v_add_f32 v6, v6, v6
    v_mul_f32 v7, v7, v6
    v_mul_f32 v10, v10, v6
    v_mul_f32 v172, v14, v7
    v_sub_f32 v175, 0, v10
    v_mul_f32 v4, s15, v154
    v_mul_f32 v5, s15, v157
    v_exp_f32 v4, v4
    v_fract_f32 v5, v5
    v_cos_f32 v6, v5
    v_sin_f32 v5, v5
    v_mul_f32 v178, v4, v6
    v_mul_f32 v5, v4, v5
    v_mul_f32 v181, v14, v5
    v_mul_f32 v4, v13, v154
    v_mul_f32 v5, v13, v157
    v_exp_f32 v4, v4
    v_fract_f32 v5, v5
    v_cos_f32 v6, v5
    v_sin_f32 v5, v5
    v_mul_f32 v184, v4, v6
    v_mul_f32 v5, v4, v5
    v_mul_f32 v187, v14, v5
L_ty_31:
L_lt_30:
    s_waitcnt vmcnt(0)
    s_barrier
    s_add_u32 s12, s83, 6
    s_cmp_ge_u32 s12, 9
    s_cselect_b32 s11, 9, 0
    s_sub_u32 s12, s12, s11
    s_lshl_b32 s11, s12, 7
    s_mul_i32 s12, s12, 221184
    s_add_u32 m0, s40, 0
    s_add_u32 s10, s11, 0
    buffer_load_dwordx4 v16, s[48:51], s10 offen lds
    s_add_u32 m0, s40, 1024
    s_add_u32 s10, s11, 0
    buffer_load_dwordx4 v17, s[48:51], s10 offen lds
    s_add_u32 m0, s40, 2048
    s_add_u32 s10, s11, 0
    buffer_load_dwordx4 v18, s[48:51], s10 offen lds
    s_add_u32 m0, s40, 3072
    s_add_u32 s10, s11, 0
    buffer_load_dwordx4 v19, s[48:51], s10 offen lds
    s_add_u32 m0, s40, 8192
    s_add_u32 s10, s11, 73728
    buffer_load_dwordx4 v16, s[48:51], s10 offen lds
    s_add_u32 m0, s40, 9216
    s_add_u32 s10, s11, 73728
    buffer_load_dwordx4 v17, s[48:51], s10 offen lds
    s_add_u32 m0, s40, 10240
    s_add_u32 s10, s11, 73728
    buffer_load_dwordx4 v18, s[48:51], s10 offen lds
    s_add_u32 m0, s40, 11264
    s_add_u32 s10, s11, 73728
    buffer_load_dwordx4 v19, s[48:51], s10 offen lds
    s_bitcmp1_b32 s90, 0
    s_cbranch_scc0 L_ty_32
    s_add_u32 m0, s40, 16384
    s_add_u32 s10, s12, 0
    buffer_load_dwordx4 v20, s[52:55], s10 offen lds
    s_add_u32 m0, s40, 17408
    s_add_u32 s10, s12, 13824
    buffer_load_dwordx4 v20, s[52:55], s10 offen lds
    s_add_u32 m0, s40, 18432
    s_add_u32 s10, s12, 27648
    buffer_load_dwordx4 v20, s[52:55], s10 offen lds
    s_add_u32 m0, s40, 19456
    s_add_u32 s10, s12, 41472
    buffer_load_dwordx4 v20, s[52:55], s10 offen lds
    s_add_u32 m0, s40, 24576
    s_add_u32 s10, s12, 110592
    buffer_load_dwordx4 v20, s[52:55], s10 offen lds
    s_add_u32 m0, s40, 25600
    s_add_u32 s10, s12, 124416
    buffer_load_dwordx4 v20, s[52:55], s10 offen lds
    s_add_u32 m0, s40, 26624
    s_add_u32 s10, s12, 138240
    buffer_load_dwordx4 v20, s[52:55], s10 offen lds
    s_add_u32 m0, s40, 27648
    s_add_u32 s10, s12, 152064
    buffer_load_dwordx4 v20, s[52:55], s10 offen lds
L_ty_32:
    s_bitcmp1_b32 s90, 1
    s_cbranch_scc0 L_ty_33
    s_add_u32 m0, s41, 32768
    s_add_u32 s10, s11, 0
    buffer_load_dwordx4 v24, s[16:19], s10 offen lds
    s_add_u32 m0, s41, 33792
    s_add_u32 s10, s11, 0
    buffer_load_dwordx4 v25, s[56:59], s10 offen lds
    s_add_u32 m0, s41, 34816
    s_add_u32 s10, s11, 0
    buffer_load_dwordx4 v26, s[16:19], s10 offen lds
    s_add_u32 m0, s41, 38912
    s_add_u32 s10, s11, 27648
    buffer_load_dwordx4 v24, s[16:19], s10 offen lds
    s_add_u32 m0, s41, 39936
    s_add_u32 s10, s11, 27648
    buffer_load_dwordx4 v25, s[56:59], s10 offen lds
    s_add_u32 m0, s41, 40960
    s_add_u32 s10, s11, 27648
    buffer_load_dwordx4 v26, s[16:19], s10 offen lds
L_ty_33:
    s_barrier
    s_cmp_eq_u32 s91, 1
    s_cbranch_scc1 L_lt_34
    s_mul_i32 s14, s8, 144
    v_lshrrev_b32 v4, 3, v0
    v_and_b32 v5, 7, v0
    v_bfe_u32 v6, v4, 1, 1
    v_lshlrev_b32 v6, 2, v6
    v_xor_b32 v5, v5, v6
    v_lshl_add_u32 v5, v5, 4, s14
    v_mul_u32_u24 v6, 1152, v4
    v_add_u32 v217, v5, v6
    v_lshrrev_b32 v6, 1, v4
    v_mul_u32_u24 v6, 18, v6
    v_and_b32 v7, 1, v4
    v_add3_u32 v6, v6, v7, 16
    v_mul_u32_u24 v6, 1152, v6
    v_add_u32 v219, v5, v6
    s_add_u32 s14, s14, 128
    v_lshrrev_b32 v4, 4, v0
    v_mul_u32_u24 v4, 18, v4
    v_and_b32 v5, 15, v0
    v_add_u32 v4, v4, v5
    v_mul_u32_u24 v4, 1152, v4
    v_add_u32 v218, s14, v4
    v_bfe_u32 v4, v0, 1, 2
    v_mul_u32_u24 v4, 18, v4
    v_and_b32 v5, 1, v0
    v_add3_u32 v4, v4, v5, 16
    v_mul_u32_u24 v4, 1152, v4
    v_add_u32 v220, s14, v4
    s_lshl_b32 s10, s7, 1
    s_add_u32 s10, s10, s22
    s_mul_i32 s95, s10, 73728
    s_add_u32 s95, s95, 10485760
    s_lshl_b32 s10, s23, 3
    s_lshl_b32 s12, s22, 1
    s_add_u32 s10, s10, s12
    s_mul_i32 s97, s10, 20736
    s_lshl_b32 s10, s23, 2
    s_add_u32 s10, s10, s12
    s_lshl_b32 s98, s10, 11
    v_bfe_u32 v6, v2, 1, 3
    v_mul_u32_u24 v7, 27648, v3
    v_mul_u32_u24 v8, 384, v2
    v_add_u32 v7, v7, v8
    v_add_u32 v7, 61440, v7
    s_mul_i32 s10, s23, 6
    s_add_u32 s12, s10, 0
    v_xor_b32 v8, s12, v6
    v_lshl_add_u32 v229, v8, 4, v7
    s_add_u32 s12, s10, 1
    v_xor_b32 v8, s12, v6
    v_lshl_add_u32 v230, v8, 4, v7
    s_add_u32 s12, s10, 2
    v_xor_b32 v8, s12, v6
    v_lshl_add_u32 v231, v8, 4, v7
    s_add_u32 s12, s10, 3
    v_xor_b32 v8, s12, v6
    v_lshl_add_u32 v232, v8, 4, v7
    s_add_u32 s12, s10, 4
    v_xor_b32 v8, s12, v6
    v_lshl_add_u32 v233, v8, 4, v7
    s_add_u32 s12, s10, 5
    v_xor_b32 v8, s12, v6
    v_lshl_add_u32 v234, v8, 4, v7
    v_and_b32 v4, 3, v0
    v_bfe_u32 v5, v0, 2, 2
    v_bfe_u32 v6, v0, 4, 1
    v_lshl_add_u32 v7, v3, 3, v5
    v_lshlrev_b32 v8, 7, v7
    v_lshl_add_u32 v8, v6, 5, v8
    v_lshl_add_u32 v8, v4, 3, v8
    v_lshrrev_b32 v5, 1, v5
    v_lshl_add_u32 v235, v5, 6, v8
    v_and_b32 v4, 1, v4
    v_lshlrev_b32 v7, 4, v7
    v_lshl_add_u32 v236, v4, 3, v7
    s_bitcmp1_b32 s90, 1
    s_cbranch_scc0 L_ty_35
    s_mov_b32 s15, 0x41800000
    s_mov_b32 s13, 0x3fb8aa3b
    v_lshlrev_b32 v4, 16, v161
    v_mul_f32 v4, s13, v4
    v_exp_f32 v4, v4
    v_lshlrev_b32 v8, 16, v155
    v_lshlrev_b32 v9, 16, v158
    v_cvt_pk_bf16_f32 v4, v4, v4
    v_lshlrev_b32 v4, 16, v4
    v_mul_f32 v5, v4, v8
    v_mul_f32 v6, v4, v9
    v_mul_f32 v155, s13, v5
    v_mul_f32 v158, 0.15915494, v6
    v_exp_f32 v4, v155
    v_fract_f32 v5, v158
    v_cos_f32 v6, v5
    v_sin_f32 v5, v5
    v_mul_f32 v164, v4, v6
    v_mul_f32 v5, v4, v5
    v_mul_f32 v170, v14, v5
    v_sub_f32 v167, 0, v170
    v_subrev_f32 v4, 1.0, v164
    v_mul_f32 v6, v8, v8
    v_fmac_f32 v6, v9, v9
    v_rcp_f32 v6, v6
    v_mul_f32 v7, v4, v8
    v_fmac_f32 v7, v5, v9
    v_mul_f32 v10, v5, v8
    v_fma_f32 v10, -v4, v9, v10
    v_add_f32 v6, v6, v6
    v_mul_f32 v7, v7, v6
    v_mul_f32 v10, v10, v6
    v_mul_f32 v173, v14, v7
    v_sub_f32 v176, 0, v10
    v_mul_f32 v4, s15, v155
    v_mul_f32 v5, s15, v158
    v_exp_f32 v4, v4
    v_fract_f32 v5, v5
    v_cos_f32 v6, v5
    v_sin_f32 v5, v5
    v_mul_f32 v179, v4, v6
    v_mul_f32 v5, v4, v5
    v_mul_f32 v182, v14, v5
    v_mul_f32 v4, v13, v155
    v_mul_f32 v5, v13, v158
    v_exp_f32 v4, v4
    v_fract_f32 v5, v5
    v_cos_f32 v6, v5
    v_sin_f32 v5, v5
    v_mul_f32 v185, v4, v6
    v_mul_f32 v5, v4, v5
    v_mul_f32 v188, v14, v5
L_ty_35:
L_lt_34:
    s_waitcnt vmcnt(0)
    s_barrier
    s_add_u32 s12, s83, 8
    s_cmp_ge_u32 s12, 9
    s_cselect_b32 s11, 9, 0
    s_sub_u32 s12, s12, s11
    s_lshl_b32 s11, s12, 7
    s_mul_i32 s12, s12, 221184
    s_add_u32 m0, s40, 90112
    s_add_u32 s10, s11, 0
    buffer_load_dwordx4 v16, s[48:51], s10 offen lds
    s_add_u32 m0, s40, 91136
    s_add_u32 s10, s11, 0
    buffer_load_dwordx4 v17, s[48:51], s10 offen lds
    s_add_u32 m0, s40, 92160
    s_add_u32 s10, s11, 0
    buffer_load_dwordx4 v18, s[48:51], s10 offen lds
    s_add_u32 m0, s40, 93184
    s_add_u32 s10, s11, 0
    buffer_load_dwordx4 v19, s[48:51], s10 offen lds
    s_add_u32 m0, s40, 98304
    s_add_u32 s10, s11, 73728
    buffer_load_dwordx4 v16, s[48:51], s10 offen lds
    s_add_u32 m0, s40, 99328
    s_add_u32 s10, s11, 73728
    buffer_load_dwordx4 v17, s[48:51], s10 offen lds
    s_add_u32 m0, s40, 100352
    s_add_u32 s10, s11, 73728
    buffer_load_dwordx4 v18, s[48:51], s10 offen lds
    s_add_u32 m0, s40, 101376
    s_add_u32 s10, s11, 73728
    buffer_load_dwordx4 v19, s[48:51], s10 offen lds
    s_bitcmp1_b32 s90, 0
    s_cbranch_scc0 L_ty_36
    s_add_u32 m0, s40, 106496
    s_add_u32 s10, s12, 0
    buffer_load_dwordx4 v20, s[52:55], s10 offen lds
    s_add_u32 m0, s40, 107520
    s_add_u32 s10, s12, 13824
    buffer_load_dwordx4 v20, s[52:55], s10 offen lds
    s_add_u32 m0, s40, 108544
    s_add_u32 s10, s12, 27648
    buffer_load_dwordx4 v20, s[52:55], s10 offen lds
    s_add_u32 m0, s40, 109568
    s_add_u32 s10, s12, 41472
    buffer_load_dwordx4 v20, s[52:55], s10 offen lds
    s_add_u32 m0, s40, 114688
    s_add_u32 s10, s12, 110592
    buffer_load_dwordx4 v20, s[52:55], s10 offen lds
    s_add_u32 m0, s40, 115712
    s_add_u32 s10, s12, 124416
    buffer_load_dwordx4 v20, s[52:55], s10 offen lds
    s_add_u32 m0, s40, 116736
    s_add_u32 s10, s12, 138240
    buffer_load_dwordx4 v20, s[52:55], s10 offen lds
    s_add_u32 m0, s40, 117760
    s_add_u32 s10, s12, 152064
    buffer_load_dwordx4 v20, s[52:55], s10 offen lds
L_ty_36:
    s_bitcmp1_b32 s90, 1
    s_cbranch_scc0 L_ty_37
    s_add_u32 m0, s41, 122880
    s_add_u32 s10, s11, 0
    buffer_load_dwordx4 v24, s[16:19], s10 offen lds
    s_add_u32 m0, s41, 123904
    s_add_u32 s10, s11, 0
    buffer_load_dwordx4 v25, s[56:59], s10 offen lds
    s_add_u32 m0, s41, 124928
    s_add_u32 s10, s11, 0
    buffer_load_dwordx4 v26, s[16:19], s10 offen lds
    s_add_u32 m0, s41, 129024
    s_add_u32 s10, s11, 27648
    buffer_load_dwordx4 v24, s[16:19], s10 offen lds
    s_add_u32 m0, s41, 130048
    s_add_u32 s10, s11, 27648
    buffer_load_dwordx4 v25, s[56:59], s10 offen lds
    s_add_u32 m0, s41, 131072
    s_add_u32 s10, s11, 27648
    buffer_load_dwordx4 v26, s[16:19], s10 offen lds
L_ty_37:
    s_barrier
    s_cmp_eq_u32 s91, 1
    s_cbranch_scc1 L_lt_38
    s_mul_i32 s14, s4, 144
    s_mov_b32 s3, 3641
    s_mul_i32 s12, s7, 147456
    s_mul_i32 s15, s8, 288
    s_add_u32 s12, s12, s15
    s_mul_i32 s15, s8, 144
    v_add_u32 v4, s14, v0
    v_add_u32 v4, 0, v4
    v_mul_u32_u24 v5, s3, v4
    v_lshrrev_b32 v5, 16, v5
    v_mul_u32_u24 v6, 18, v5
    v_sub_u32 v6, v4, v6
    v_mul_u32_u24 v7, 2304, v5
    v_lshl_add_u32 v7, v6, 4, v7
    v_add_u32 v237, s12, v7
    v_lshl_add_u32 v240, v6, 3, s15
    v_lshlrev_b32 v243, 2, v5
    v_add_u32 v4, s14, v0
    v_add_u32 v4, 64, v4
    v_mul_u32_u24 v5, s3, v4
    v_lshrrev_b32 v5, 16, v5
    v_mul_u32_u24 v6, 18, v5
    v_sub_u32 v6, v4, v6
    v_mul_u32_u24 v7, 2304, v5
    v_lshl_add_u32 v7, v6, 4, v7
    v_add_u32 v238, s12, v7
    v_lshl_add_u32 v241, v6, 3, s15
    v_lshlrev_b32 v244, 2, v5
    v_add_u32 v4, s14, v0
    v_add_u32 v4, 128, v4
    v_mul_u32_u24 v5, s3, v4
    v_lshrrev_b32 v5, 16, v5
    v_mul_u32_u24 v6, 18, v5
    v_sub_u32 v6, v4, v6
    v_mul_u32_u24 v7, 2304, v5
    v_lshl_add_u32 v7, v6, 4, v7
    v_add_u32 v239, s12, v7
    v_lshl_add_u32 v242, v6, 3, s15
    v_lshlrev_b32 v245, 2, v5
    s_mul_i32 s10, s23, 18432
    s_mul_i32 s12, s22, 9216
    s_add_u32 s10, s10, s12
    s_cmp_ge_u32 s4, 4
    s_cselect_b32 s12, 24576, 0
    s_add_u32 s10, s10, s12
    v_mul_u32_u24 v4, 288, v2
    v_lshl_add_u32 v4, v3, 4, v4
    v_add_u32 v246, s10, v4
    s_and_b32 s10, s7, 3
    s_lshl_b32 s10, s10, 3
    s_add_u32 s10, s10, s4
    s_cmp_ge_u32 s10, 7
    s_cselect_b32 s12, 7, 0
    s_cmp_ge_u32 s10, 14
    s_cselect_b32 s12, 14, s12
    s_sub_u32 s12, s10, s12
    s_lshl_b32 s12, s12, 6
    v_add_u32 v4, s12, v0
    s_mov_b32 s3, 10923
    v_mul_u32_u24 v5, s3, v4
    v_lshrrev_b32 v5, 16, v5
    v_mul_u32_u24 v6, 6, v5
    v_sub_u32 v6, v4, v6
    v_min_u32 v5, 71, v5
    s_mul_i32 s14, s8, 72
    v_add_u32 v5, s14, v5
    v_mul_u32_u24 v5, 1152, v5
    v_lshl_add_u32 v5, v6, 7, v5
    v_add_u32 v5, 384, v5
    v_lshrrev_b32 v6, 1, v4
    v_mul_u32_u24 v6, 1152, v6
    v_and_b32 v7, 1, v4
    v_mul_u32_u24 v7, 140, v7
    v_add3_u32 v6, v6, v7, s15
    s_cmp_ge_u32 s10, 14
    s_cselect_b64 vcc, -1, 0
    v_cndmask_b32 v226, v5, v6, vcc
    s_bitcmp1_b32 s90, 1
    s_cbranch_scc0 L_ty_39
    s_mov_b32 s15, 0x41800000
    s_mov_b32 s13, 0x3fb8aa3b
    v_lshlrev_b32 v4, 16, v162
    v_mul_f32 v4, s13, v4
    v_exp_f32 v4, v4
    v_lshlrev_b32 v8, 16, v156
    v_lshlrev_b32 v9, 16, v159
    v_cvt_pk_bf16_f32 v4, v4, v4
    v_lshlrev_b32 v4, 16, v4
    v_mul_f32 v5, v4, v8
    v_mul_f32 v6, v4, v9
    v_mul_f32 v156, s13, v5
    v_mul_f32 v159, 0.15915494, v6
    v_exp_f32 v4, v156
    v_fract_f32 v5, v159
    v_cos_f32 v6, v5
    v_sin_f32 v5, v5
    v_mul_f32 v165, v4, v6
    v_mul_f32 v5, v4, v5
    v_mul_f32 v171, v14, v5
    v_sub_f32 v168, 0, v171
    v_subrev_f32 v4, 1.0, v165
    v_mul_f32 v6, v8, v8
    v_fmac_f32 v6, v9, v9
    v_rcp_f32 v6, v6
    v_mul_f32 v7, v4, v8
    v_fmac_f32 v7, v5, v9
    v_mul_f32 v10, v5, v8
    v_fma_f32 v10, -v4, v9, v10
    v_add_f32 v6, v6, v6
    v_mul_f32 v7, v7, v6
    v_mul_f32 v10, v10, v6
    v_mul_f32 v174, v14, v7
    v_sub_f32 v177, 0, v10
    v_mul_f32 v4, s15, v156
    v_mul_f32 v5, s15, v159
    v_exp_f32 v4, v4
    v_fract_f32 v5, v5
    v_cos_f32 v6, v5
    v_sin_f32 v5, v5
    v_mul_f32 v180, v4, v6
    v_mul_f32 v5, v4, v5
    v_mul_f32 v183, v14, v5
    v_mul_f32 v4, v13, v156
    v_mul_f32 v5, v13, v159
    v_exp_f32 v4, v4
    v_fract_f32 v5, v5
    v_cos_f32 v6, v5
    v_sin_f32 v5, v5
    v_mul_f32 v186, v4, v6
    v_mul_f32 v5, v4, v5
    v_mul_f32 v189, v14, v5
L_ty_39:
L_lt_38:
    s_waitcnt vmcnt(0)
    s_barrier
    s_cmp_eq_u32 s91, 1
    s_cbranch_scc1 L_lt_40
    s_bitcmp1_b32 s90, 1
    s_cbranch_scc0 L_ty_41
    s_sub_u32 s3, s4, 4
    s_mul_i32 s10, s3, 7168
    s_add_u32 s10, s10, 135168
    v_add_u32 v4, s10, v221
    ds_write_b128 v4, v[162:165] offset:0
    ds_write_b128 v4, v[166:169] offset:1024
    ds_write_b128 v4, v[170:173] offset:2048
    ds_write_b128 v4, v[174:177] offset:3072
    ds_write_b128 v4, v[178:181] offset:4096
    ds_write_b128 v4, v[182:185] offset:5120
    ds_write_b128 v4, v[186:189] offset:6144
L_ty_41:
L_lt_40:
    s_waitcnt lgkmcnt(0)
    s_barrier
L_loadend:
    s_mov_b32 s91, 0
    s_sub_u32 s10, s4, 4
    s_mul_i32 s10, s10, 5120
    v_and_b32 v4, 7, v0
    v_lshl_add_u32 v4, v4, 4, s10
    v_bfe_u32 v5, v0, 2, 1
    v_mul_u32_u24 v8, 0x3f80, v5
    v_lshl_or_b32 v8, v8, 16, v8
    v_mov_b32 v9, v8
    v_mov_b32 v10, v8
    v_mov_b32 v11, v8
    ds_write_b128 v4, v[8:11] offset:2432
    ds_write_b128 v4, v[8:11] offset:4992
    ds_write_b128 v4, v[8:11] offset:22912
    ds_write_b128 v4, v[8:11] offset:25472
    ds_write_b128 v4, v[8:11] offset:43392
    ds_write_b128 v4, v[8:11] offset:45952
    s_waitcnt lgkmcnt(0)
    s_bitcmp1_b32 s90, 1
    s_cbranch_scc0 L_p2
    s_sub_u32 s3, s4, 4
    s_lshl_b32 s11, s3, 6
    v_add_u32 v5, s11, v0
    v_min_u32 v5, 167, v5
    v_lshlrev_b32 v5, 4, v5
    v_add_u32 v5, 65536, v5
    v_mov_b32 v8, 0
    v_mov_b32 v9, 0
    v_mov_b32 v10, 0
    v_mov_b32 v11, 0
    ds_write_b128 v5, v[8:11]
    v_mov_b32 v5, 75776
    ds_write_b32 v5, v9
    s_lshl_b32 s12, s84, 13
    s_add_u32 s12, s12, 131072
    v_lshl_add_u32 v5, v2, 4, s12
    v_lshlrev_b32 v6, 1, v92
    v_sub_u32 v6, s5, v6
    v_mov_b32 v7, s99
    v_add_u32 v8, 4294967294, v6
    v_cmp_le_i32 s[16:17], 0, v8
    v_and_b32 v8, 15, v8
    v_lshl_add_u32 v8, v8, 9, v5
    v_cndmask_b32 v118, v7, v8, s[16:17]
    v_add_u32 v8, 4294967295, v6
    v_cmp_le_i32 s[18:19], 0, v8
    v_and_b32 v8, 15, v8
    v_lshl_add_u32 v8, v8, 9, v5
    v_cndmask_b32 v119, v7, v8, s[18:19]
    s_mul_i32 s10, s3, 384
    s_add_u32 s10, s10, 73728
    v_lshl_add_u32 v93, v2, 2, s10
    s_waitcnt lgkmcnt(0)
    s_barrier
    v_lshrrev_b32 v4, 4, v0
    v_and_b32 v5, 15, v0
    s_lshl_b32 s10, s22, 3
    s_mul_i32 s14, s8, 72
    s_and_b32 s15, s4, 3
    s_lshl_b32 s15, s15, 3
    s_add_u32 s15, s15, s14
    v_add_u32 v6, 0, v4
    v_add_u32 v7, s10, v6
    v_xor_b32 v7, v7, v5
    v_add_u32 v6, s15, v6
    v_mul_u32_u24 v6, 1152, v6
    v_lshl_add_u32 v202, v7, 4, v6
    v_add_u32 v6, 4, v4
    v_add_u32 v7, s10, v6
    v_xor_b32 v7, v7, v5
    v_add_u32 v6, s15, v6
    v_mul_u32_u24 v6, 1152, v6
    v_lshl_add_u32 v203, v7, 4, v6
    s_lshl_b32 s10, s22, 2
    s_mul_i32 s14, s8, 72
    v_lshrrev_b32 v4, 4, v0
    v_and_b32 v5, 15, v0
    v_add_u32 v6, s10, v4
    v_xor_b32 v7, v6, v5
    s_add_u32 s14, s14, 64
    v_add_u32 v6, s14, v6
    v_mul_u32_u24 v6, 1152, v6
    v_lshl_add_u32 v204, v7, 4, v6
    s_bitcmp1_b32 s4, 1
    s_cselect_b32 s32, s68, s64
    s_cselect_b32 s33, s69, s65
    s_mov_b32 s34, 663552
    s_mov_b32 s35, 0x20000
    s_cselect_b32 s28, 18432, 0
    s_lshl_b32 s10, s22, 10
    s_add_u32 s28, s28, s10
    s_add_u32 s28, s28, 16384
    v_and_b32 v6, 15, v2
    v_mul_u32_u24 v7, 18432, v3
    v_lshl_add_u32 v7, v2, 8, v7
    s_lshl_b32 s10, s23, 2
    s_add_u32 s12, s10, 0
    v_xor_b32 v8, s12, v6
    v_lshl_add_u32 v247, v8, 4, v7
    s_add_u32 s12, s10, 1
    v_xor_b32 v8, s12, v6
    v_lshl_add_u32 v248, v8, 4, v7
    s_add_u32 s12, s10, 2
    v_xor_b32 v8, s12, v6
    v_lshl_add_u32 v249, v8, 4, v7
    s_add_u32 s12, s10, 3
    v_xor_b32 v8, s12, v6
    v_lshl_add_u32 v250, v8, 4, v7
    s_lshl_b32 s10, s23, 13
    s_add_u32 s12, s10, 116736
    v_add_u32 v193, s12, v235
    v_xor_b32 v194, 64, v193
    s_lshl_b32 s10, s23, 12
    s_add_u32 s10, s10, 40960
    v_add_u32 v196, s10, v235
    v_xor_b32 v197, 64, v196
    s_mov_b32 s12, 32768
    s_cmp_ge_u32 s4, 4
    s_cselect_b32 s12, s12, 57344
    s_lshl_b32 s10, s23, 11
    s_add_u32 s10, s10, s12
    v_add_u32 v199, s10, v235
    v_xor_b32 v200, 64, v199
    s_lshl_b32 s10, s23, 10
    s_add_u32 s12, s10, 149504
    v_add_u32 v195, s12, v236
    s_add_u32 s12, s10, 153600
    v_add_u32 v198, s12, v236
    s_lshl_b32 s10, s23, 8
    s_add_u32 s10, s10, 157696
    v_add_u32 v201, s10, v236
    v_lshlrev_b32 v13, 8, v92
    v_cvt_f32_u32 v13, v13
    s_mov_b32 s15, 0x43000000
    v_mul_f32 v4, s15, v154
    v_mul_f32 v5, s15, v157
    v_exp_f32 v4, v4
    v_fract_f32 v5, v5
    v_cos_f32 v6, v5
    v_sin_f32 v5, v5
    v_mul_f32 v178, v4, v6
    v_mul_f32 v5, v4, v5
    v_mul_f32 v181, v14, v5
    v_mul_f32 v4, v13, v154
    v_mul_f32 v5, v13, v157
    v_exp_f32 v4, v4
    v_fract_f32 v5, v5
    v_cos_f32 v6, v5
    v_sin_f32 v5, v5
    v_mul_f32 v184, v4, v6
    v_mul_f32 v5, v4, v5
    v_mul_f32 v187, v14, v5
    v_mul_f32 v4, s15, v155
    v_mul_f32 v5, s15, v158
    v_exp_f32 v4, v4
    v_fract_f32 v5, v5
    v_cos_f32 v6, v5
    v_sin_f32 v5, v5
    v_mul_f32 v179, v4, v6
    v_mul_f32 v5, v4, v5
    v_mul_f32 v182, v14, v5
    v_mul_f32 v4, v13, v155
    v_mul_f32 v5, v13, v158
    v_exp_f32 v4, v4
    v_fract_f32 v5, v5
    v_cos_f32 v6, v5
    v_sin_f32 v5, v5
    v_mul_f32 v185, v4, v6
    v_mul_f32 v5, v4, v5
    v_mul_f32 v188, v14, v5
    v_mul_f32 v4, s15, v156
    v_mul_f32 v5, s15, v159
    v_exp_f32 v4, v4
    v_fract_f32 v5, v5
    v_cos_f32 v6, v5
    v_sin_f32 v5, v5
    v_mul_f32 v180, v4, v6
    v_mul_f32 v5, v4, v5
    v_mul_f32 v183, v14, v5
    v_mul_f32 v4, v13, v156
    v_mul_f32 v5, v13, v159
    v_exp_f32 v4, v4
    v_fract_f32 v5, v5
    v_cos_f32 v6, v5
    v_sin_f32 v5, v5
    v_mul_f32 v186, v4, v6
    v_mul_f32 v5, v4, v5
    v_mul_f32 v189, v14, v5
    s_mov_b32 s92, 0
L_epoll_42:
    s_sleep 6
    buffer_load_dwordx4 v[106:109], v118, s[60:63], 0 offen sc1
    buffer_load_dwordx4 v[110:113], v119, s[60:63], 0 offen sc1
    s_add_u32 s92, s92, 1
    s_waitcnt vmcnt(0)
    v_cmp_ne_u32 vcc, s9, v109
    v_cmp_ne_u32 s[12:13], s9, v113
    s_and_b64 vcc, vcc, s[16:17]
    s_and_b64 s[12:13], s[12:13], s[18:19]
    s_or_b64 vcc, vcc, s[12:13]
    s_cmp_gt_u32 s92, 20000
    s_cbranch_scc1 L_epollq_43
    s_cbranch_vccnz L_epoll_42
L_epollq_43:
    v_fma_f32 v80, v178, v106, v110
    v_fma_f32 v81, v179, v107, v111
    v_fma_f32 v82, v180, v108, v112
    v_fmac_f32_dpp v80, v106, v181 row_ror:8 row_mask:0xf bank_mask:0xf
    v_fmac_f32_dpp v81, v107, v182 row_ror:8 row_mask:0xf bank_mask:0xf
    v_fmac_f32_dpp v82, v108, v183 row_ror:8 row_mask:0xf bank_mask:0xf
    v_mul_f32 v83, v184, v80
    v_mul_f32 v84, v185, v81
    v_mul_f32 v85, v186, v82
    v_fmac_f32_dpp v83, v80, v187 row_ror:8 row_mask:0xf bank_mask:0xf
    v_fmac_f32_dpp v84, v81, v188 row_ror:8 row_mask:0xf bank_mask:0xf
    v_fmac_f32_dpp v85, v82, v189 row_ror:8 row_mask:0xf bank_mask:0xf
    v_mov_b32 v80, v83
    v_mov_b32 v81, v84
    v_mov_b32 v82, v85
    v_permlane32_swap_b32 v80, v83
    v_permlane32_swap_b32 v81, v84
    v_permlane32_swap_b32 v82, v85
    v_add_f32 v80, v80, v83
    v_add_f32 v81, v81, v84
    v_add_f32 v82, v82, v85
    ds_write_b32 v93, v80 offset:0
    ds_write_b32 v93, v81 offset:128
    ds_write_b32 v93, v82 offset:256
    s_waitcnt lgkmcnt(0)
    s_barrier
    s_lshl_b32 s10, s4, 1
    s_sub_u32 s10, s10, 8
    s_mul_i32 s11, s10, 2560
    s_mul_i32 s94, s10, 36864
    s_add_u32 m0, s11, 0
    s_nop 0
    buffer_load_dwordx4 v210, s[60:63], s94 offen sc1 lds
    s_add_u32 m0, s11, 1024
    s_nop 0
    buffer_load_dwordx4 v211, s[60:63], s94 offen sc1 lds
    s_add_u32 m0, s11, 2048
    s_mov_b64 exec, 0xffffff
    buffer_load_dwordx4 v212, s[60:63], s94 offen sc1 lds
    s_mov_b64 exec, -1
    s_lshl_b32 s10, s4, 1
    s_sub_u32 s10, s10, 7
    s_mul_i32 s11, s10, 2560
    s_mul_i32 s94, s10, 36864
    s_add_u32 m0, s11, 0
    s_nop 0
    buffer_load_dwordx4 v210, s[60:63], s94 offen sc1 lds
    s_add_u32 m0, s11, 1024
    s_nop 0
    buffer_load_dwordx4 v211, s[60:63], s94 offen sc1 lds
    s_add_u32 m0, s11, 2048
    s_mov_b64 exec, 0xffffff
    buffer_load_dwordx4 v212, s[60:63], s94 offen sc1 lds
    s_mov_b64 exec, -1
    s_lshl_b32 s10, s8, 3
    s_add_u32 s10, s10, s4
    s_mul_i32 s12, s10, 36864
    s_add_u32 s12, s12, 1048576
    s_add_u32 s14, s12, s44
    s_add_u32 s15, s12, s45
    s_lshr_b32 s12, s10, 2
    s_lshl_b32 s12, s12, 10
    s_and_b32 s13, s10, 3
    s_lshl_b32 s13, s13, 7
    s_add_u32 s12, s12, s13
    s_add_u32 s12, s12, 327680
    v_lshlrev_b32 v14, 3, v2
    v_lshlrev_b32 v15, 2, v2
    buffer_load_dwordx2 v[96:97], v205, s[60:63], s14 offen sc1
    buffer_load_dwordx2 v[98:99], v205, s[60:63], s14 offen offset:512 sc1
    buffer_load_dwordx2 v[100:101], v14, s[60:63], s15 offen sc1
    buffer_load_dword v104, v15, s[60:63], s12 offen sc1
    s_branch L_p2c
L_compute:
    s_mov_b32 s82, 0
    s_mov_b32 s85, 0
    v_and_b32 v4, 0x13, v2
    v_bfe_u32 v5, v2, 2, 1
    v_lshl_or_b32 v4, v5, 3, v4
    v_bfe_u32 v6, v2, 3, 1
    v_lshl_or_b32 v4, v6, 2, v4
    s_cmp_ge_u32 s6, 9
    s_cselect_b64 vcc, -1, 0
    v_cndmask_b32 v4, v2, v4, vcc
    v_and_b32 v6, 3, v2
    v_lshl_or_b32 v6, v5, 4, v6
    v_lshrrev_b32 v5, 3, v2
    v_lshl_or_b32 v5, v5, 2, v6
    s_lshl_b32 s10, s80, 13
    s_lshl_b32 s11, s4, 12
    s_mov_b32 s12, 32768
    v_bfe_u32 v7, v4, 1, 3
    v_xor_b32 v7, v7, v3
    v_lshlrev_b32 v7, 4, v7
    v_lshl_add_u32 v7, v4, 7, v7
    v_add_u32 v198, s10, v7
    v_xor_b32 v199, 32, v198
    v_xor_b32 v200, 64, v198
    v_xor_b32 v201, 0x60, v198
    v_bfe_u32 v7, v5, 1, 3
    v_xor_b32 v7, v7, v3
    v_lshlrev_b32 v7, 4, v7
    v_lshl_add_u32 v7, v5, 7, v7
    v_add_u32 v100, s11, v7
    v_xor_b32 v101, 32, v100
    v_xor_b32 v102, 64, v100
    v_xor_b32 v103, 0x60, v100
    v_bfe_u32 v7, v2, 1, 3
    v_xor_b32 v7, v7, v3
    v_lshlrev_b32 v7, 4, v7
    v_lshl_add_u32 v7, v2, 7, v7
    v_add_u32 v247, s12, v7
    v_xor_b32 v248, 32, v247
    v_xor_b32 v249, 64, v247
    v_xor_b32 v250, 0x60, v247
    v_and_b32 v4, 3, v0
    v_bfe_u32 v5, v0, 2, 2
    v_bfe_u32 v6, v0, 4, 1
    v_lshl_add_u32 v8, v3, 3, v5
    v_lshlrev_b32 v8, 8, v8
    v_lshl_add_u32 v8, v6, 5, v8
    v_lshl_add_u32 v8, v4, 3, v8
    s_lshl_b32 s10, s81, 1
    v_xor_b32 v5, s10, v5
    v_lshl_add_u32 v8, v5, 6, v8
    v_add_u32 v104, 16384, v8
    v_xor_b32 v105, 64, v104
    v_mov_b32 v16, 0
    v_mov_b32 v17, 0
    v_mov_b32 v18, 0
    v_mov_b32 v19, 0
    v_mov_b32 v20, 0
    v_mov_b32 v21, 0
    v_mov_b32 v22, 0
    v_mov_b32 v23, 0
    v_mov_b32 v24, 0
    v_mov_b32 v25, 0
    v_mov_b32 v26, 0
    v_mov_b32 v27, 0
    v_mov_b32 v28, 0
    v_mov_b32 v29, 0
    v_mov_b32 v30, 0
    v_mov_b32 v31, 0
    v_mov_b32 v32, 0
    v_mov_b32 v33, 0
    v_mov_b32 v34, 0
    v_mov_b32 v35, 0
    v_mov_b32 v36, 0
    v_mov_b32 v37, 0
    v_mov_b32 v38, 0
    v_mov_b32 v39, 0
    v_mov_b32 v40, 0
    v_mov_b32 v41, 0
    v_mov_b32 v42, 0
    v_mov_b32 v43, 0
    v_mov_b32 v44, 0
    v_mov_b32 v45, 0
    v_mov_b32 v46, 0
    v_mov_b32 v47, 0
    v_mov_b32 v48, 0
    v_mov_b32 v49, 0
    v_mov_b32 v50, 0
    v_mov_b32 v51, 0
    v_mov_b32 v52, 0
    v_mov_b32 v53, 0
    v_mov_b32 v54, 0
    v_mov_b32 v55, 0
    v_mov_b32 v56, 0
    v_mov_b32 v57, 0
    v_mov_b32 v58, 0
    v_mov_b32 v59, 0
    v_mov_b32 v60, 0
    v_mov_b32 v61, 0
    v_mov_b32 v62, 0
    v_mov_b32 v63, 0
    v_mov_b32 v64, 0
    v_mov_b32 v65, 0
    v_mov_b32 v66, 0
    v_mov_b32 v67, 0
    v_mov_b32 v68, 0
    v_mov_b32 v69, 0
    v_mov_b32 v70, 0
    v_mov_b32 v71, 0
    v_mov_b32 v72, 0
    v_mov_b32 v73, 0
    v_mov_b32 v74, 0
    v_mov_b32 v75, 0
    v_mov_b32 v76, 0
    v_mov_b32 v77, 0
    v_mov_b32 v78, 0
    v_mov_b32 v79, 0
    v_mov_b32 v106, 0
    v_mov_b32 v107, 0
    v_mov_b32 v108, 0
    v_mov_b32 v109, 0
    v_mov_b32 v110, 0
    v_mov_b32 v111, 0
    v_mov_b32 v112, 0
    v_mov_b32 v113, 0
    v_mov_b32 v114, 0
    v_mov_b32 v115, 0
    v_mov_b32 v116, 0
    v_mov_b32 v117, 0
    v_mov_b32 v118, 0
    v_mov_b32 v119, 0
    v_mov_b32 v120, 0
    v_mov_b32 v121, 0
    v_mov_b32 v122, 0
    v_mov_b32 v123, 0
    v_mov_b32 v124, 0
    v_mov_b32 v125, 0
    v_mov_b32 v126, 0
    v_mov_b32 v127, 0
    v_mov_b32 v128, 0
    v_mov_b32 v129, 0
    v_mov_b32 v130, 0
    v_mov_b32 v131, 0
    v_mov_b32 v132, 0
    v_mov_b32 v133, 0
    v_mov_b32 v134, 0
    v_mov_b32 v135, 0
    v_mov_b32 v136, 0
    v_mov_b32 v137, 0
    v_mov_b32 v138, 0
    v_mov_b32 v139, 0
    v_mov_b32 v140, 0
    v_mov_b32 v141, 0
    v_mov_b32 v142, 0
    v_mov_b32 v143, 0
    v_mov_b32 v144, 0
    v_mov_b32 v145, 0
    v_mov_b32 v146, 0
    v_mov_b32 v147, 0
    v_mov_b32 v148, 0
    v_mov_b32 v149, 0
    v_mov_b32 v150, 0
    v_mov_b32 v151, 0
    v_mov_b32 v152, 0
    v_mov_b32 v153, 0
    s_waitcnt lgkmcnt(0)
    s_load_dword s9, s[46:47], 0
    s_mov_b32 s48, s16
    s_and_b32 s49, s17, 0xffff
    s_mov_b32 s50, 2359296
    s_mov_b32 s51, 0x20000
    s_bitcmp1_b32 s90, 2
    s_cbranch_scc0 L_ty_44
    v_lshrrev_b32 v4, 3, v0
    v_and_b32 v5, 7, v0
    s_lshl_b32 s10, s5, 7
    s_and_b32 s11, s2, 1
    s_lshl_b32 s11, s11, 6
    s_add_u32 s10, s10, s11
    s_lshl_b32 s11, s4, 4
    s_add_u32 s10, s10, s11
    v_add_u32 v4, s10, v4
    v_mul_u32_u24 v4, 1152, v4
    v_lshlrev_b32 v5, 4, v5
    v_add_u32 v4, v4, v5
    s_mov_b32 s11, 9216
    global_load_dwordx4 v[154:157], v5, s[40:41] offset:0
    buffer_load_dwordx4 v[16:19], v4, s[48:51], 0 offen offset:0
    buffer_load_dwordx4 v[52:55], v4, s[48:51], s11 offen offset:0
    global_load_dwordx4 v[158:161], v5, s[40:41] offset:128
    buffer_load_dwordx4 v[20:23], v4, s[48:51], 0 offen offset:128
    buffer_load_dwordx4 v[56:59], v4, s[48:51], s11 offen offset:128
    global_load_dwordx4 v[162:165], v5, s[40:41] offset:256
    buffer_load_dwordx4 v[24:27], v4, s[48:51], 0 offen offset:256
    buffer_load_dwordx4 v[60:63], v4, s[48:51], s11 offen offset:256
    global_load_dwordx4 v[166:169], v5, s[40:41] offset:384
    buffer_load_dwordx4 v[28:31], v4, s[48:51], 0 offen offset:384
    buffer_load_dwordx4 v[64:67], v4, s[48:51], s11 offen offset:384
    global_load_dwordx4 v[170:173], v5, s[40:41] offset:512
    buffer_load_dwordx4 v[32:35], v4, s[48:51], 0 offen offset:512
    buffer_load_dwordx4 v[68:71], v4, s[48:51], s11 offen offset:512
    global_load_dwordx4 v[174:177], v5, s[40:41] offset:640
    buffer_load_dwordx4 v[36:39], v4, s[48:51], 0 offen offset:640
    buffer_load_dwordx4 v[72:75], v4, s[48:51], s11 offen offset:640
    global_load_dwordx4 v[178:181], v5, s[40:41] offset:768
    buffer_load_dwordx4 v[40:43], v4, s[48:51], 0 offen offset:768
    buffer_load_dwordx4 v[76:79], v4, s[48:51], s11 offen offset:768
    global_load_dwordx4 v[182:185], v5, s[40:41] offset:896
    buffer_load_dwordx4 v[44:47], v4, s[48:51], 0 offen offset:896
    buffer_load_dwordx4 v[80:83], v4, s[48:51], s11 offen offset:896
    global_load_dwordx4 v[186:189], v5, s[40:41] offset:1024
    buffer_load_dwordx4 v[48:51], v4, s[48:51], 0 offen offset:1024
    buffer_load_dwordx4 v[84:87], v4, s[48:51], s11 offen offset:1024
L_ty_44:
    s_mov_b32 s60, s46
    s_and_b32 s61, s47, 0xffff
    s_mov_b32 s62, 19922944
    s_mov_b32 s63, 0x20000
    v_lshlrev_b32 v221, 4, v0
    v_lshlrev_b32 v205, 3, v0
    v_mul_u32_u24 v4, 5120, v3
    v_lshl_add_u32 v4, v2, 3, v4
    v_add_u32 v206, 1024, v4
    v_mov_b32 v209, 0xdddd
    v_and_b32 v4, 0x13, v2
    v_bfe_u32 v5, v2, 2, 1
    v_lshl_or_b32 v4, v5, 3, v4
    v_bfe_u32 v5, v2, 3, 1
    v_lshl_or_b32 v4, v5, 2, v4
    v_mul_u32_u24 v5, 288, v3
    v_lshl_add_u32 v4, v4, 4, v5
    v_add_u32 v4, 1280, v4
    v_add_u32 v5, 576, v4
    v_and_b32 v6, 27, v2
    v_cmp_eq_u32 vcc, 18, v6
    v_mov_b32 v6, 2496
    v_mov_b32 v7, 2432
    v_cndmask_b32 v6, v7, v6, vcc
    v_cmp_gt_u32 vcc, 18, v2
    s_lshr_b32 s10, s7, 1
    s_mul_i32 s11, s10, 9
    v_cndmask_b32 v207, v6, v4, vcc
    v_cndmask_b32 v208, v6, v5, vcc
    s_mul_i32 s93, s4, 2560
    s_and_b32 s12, s7, 1
    s_mul_i32 s13, s12, 5
    s_add_u32 s13, s13, s11
    s_lshl_b32 s44, s13, 8
    s_add_u32 s14, s44, 4194304
    v_add_u32 v210, s14, v221
    s_add_u32 s11, s11, 4
    s_lshl_b32 s45, s11, 8
    s_add_u32 s14, s45, 4194304
    v_add_u32 v4, s14, v221
    s_mul_i32 s15, s7, 288
    s_add_u32 s15, s15, 7340032
    s_mov_b32 s3, 3641
    v_add_u32 v5, 4294967280, v0
    v_and_b32 v5, 0x7f, v5
    v_mul_u32_u24 v6, s3, v5
    v_lshrrev_b32 v6, 16, v6
    v_mul_u32_u24 v7, 8928, v6
    v_lshl_add_u32 v7, v5, 4, v7
    v_add_u32 v211, s15, v7
    v_add_u32 v5, 48, v0
    v_and_b32 v5, 0x7f, v5
    v_mul_u32_u24 v6, s3, v5
    v_lshrrev_b32 v6, 16, v6
    v_mul_u32_u24 v7, 8928, v6
    v_lshl_add_u32 v7, v5, 4, v7
    v_add_u32 v212, s15, v7
    v_cmp_gt_u32 vcc, 16, v0
    s_mul_i32 s14, s10, 36
    v_bfe_u32 v5, v0, 4, 1
    v_cndmask_b32 v211, v211, v4, vcc
    v_mul_u32_u24 v5, 35, v5
    v_mul_u32_u24 v7, 576, v3
    v_add3_u32 v4, v5, v7, s14
    v_add_u32 v4, 576, v4
    v_lshrrev_b32 v4, 7, v4
    v_and_b32 v8, 15, v0
    v_lshl_add_u32 v4, v4, 4, v8
    s_and_b32 s3, s4, 3
    s_cmp_eq_u32 s3, 0
    s_cselect_b32 s3, 4096, s99
    v_lshl_add_u32 v222, v4, 7, s3
    v_cmp_gt_u32 s[100:101], 4, v8
    v_bfe_u32 v4, v0, 1, 1
    v_mul_u32_u24 v4, 35, v4
    v_add_u32 v4, s14, v4
    v_lshrrev_b32 v4, 7, v4
    v_cmp_gt_u32 vcc, 4, v0
    v_and_b32 v8, 1, v0
    s_lshl_b32 s12, s8, 1
    v_bfe_u32 v7, v0, 1, 1
    v_add_u32 v7, 14, v7
    v_cndmask_b32 v7, v7, v4, vcc
    v_add_u32 v8, s12, v8
    v_lshl_add_u32 v7, v7, 4, v8
    v_lshl_add_u32 v223, v7, 7, s3
    v_cmp_gt_u32 vcc, 12, v0
    v_add_u32 v4, 16, v0
    s_and_b32 s12, s7, 1
    s_add_u32 s12, s12, 14
    v_mov_b32 v5, s12
    v_cndmask_b32 v4, v5, v4, vcc
    v_lshl_add_u32 v4, v4, 4, s10
    v_lshl_add_u32 v224, v4, 7, s3
    s_lshr_b32 s10, s7, 2
    s_lshl_b32 s10, s10, 12
    s_add_u32 s10, s10, 65536
    s_cmp_eq_u32 s4, 4
    s_cselect_b32 s10, s10, s99
    v_lshl_add_u32 v225, v2, 7, s10
    s_mov_b32 s64, s32
    s_and_b32 s65, s33, 0xffff
    s_mov_b32 s66, 663552
    s_mov_b32 s67, 0x20000
    s_mov_b32 s68, s34
    s_and_b32 s69, s35, 0xffff
    s_mov_b32 s70, 663552
    s_mov_b32 s71, 0x20000
    s_mov_b32 s76, s20
    s_and_b32 s77, s21, 0xffff
    s_mov_b32 s78, 663552
    s_mov_b32 s79, 0x20000
    s_and_b32 s22, s4, 1
    s_lshr_b32 s23, s4, 1
    s_cmp_ge_u32 s4, 6
    s_cselect_b32 s10, 6, 0
    s_sub_u32 s10, s4, s10
    s_cmp_ge_u32 s10, 3
    s_cselect_b32 s72, s34, s32
    s_cselect_b32 s73, s35, s33
    s_cselect_b32 s12, 3, 0
    s_cselect_b32 s96, 27648, 0
    s_and_b32 s73, s73, 0xffff
    s_mov_b32 s74, 663552
    s_mov_b32 s75, 0x20000
    s_sub_u32 s10, s10, s12
    s_lshl_b32 s12, s10, 10
    s_add_u32 s96, s96, s12
    s_add_u32 s96, s96, 24576
    s_lshl_b32 s10, s10, 6
    s_mul_i32 s14, s8, 72
    s_lshl_b32 s15, s4, 3
    s_add_u32 s15, s15, s14
    s_add_u32 s14, s14, 64
    s_mov_b32 s3, 2731
    s_lshl_b32 s12, s22, 2
    v_add_u32 v4, 0, v0
    v_mul_u32_u24 v5, s3, v4
    v_lshrrev_b32 v5, 16, v5
    v_mul_u32_u24 v6, 24, v5
    v_sub_u32 v6, v4, v6
    v_lshrrev_b32 v7, 1, v5
    v_xor_b32 v7, s12, v7
    v_xor_b32 v6, v6, v7
    v_add_u32 v5, s15, v5
    v_mul_u32_u24 v5, 1152, v5
    v_lshl_add_u32 v213, v6, 4, v5
    v_add_u32 v4, 64, v0
    v_mul_u32_u24 v5, s3, v4
    v_lshrrev_b32 v5, 16, v5
    v_mul_u32_u24 v6, 24, v5
    v_sub_u32 v6, v4, v6
    v_lshrrev_b32 v7, 1, v5
    v_xor_b32 v7, s12, v7
    v_xor_b32 v6, v6, v7
    v_add_u32 v5, s15, v5
    v_mul_u32_u24 v5, 1152, v5
    v_lshl_add_u32 v214, v6, 4, v5
    v_add_u32 v4, 128, v0
    v_mul_u32_u24 v5, s3, v4
    v_lshrrev_b32 v5, 16, v5
    v_mul_u32_u24 v6, 24, v5
    v_sub_u32 v6, v4, v6
    v_lshrrev_b32 v7, 1, v5
    v_xor_b32 v7, s12, v7
    v_xor_b32 v6, v6, v7
    v_add_u32 v5, s15, v5
    v_mul_u32_u24 v5, 1152, v5
    v_lshl_add_u32 v215, v6, 4, v5
    v_add_u32 v4, s10, v0
    v_mul_u32_u24 v5, s3, v4
    v_lshrrev_b32 v5, 16, v5
    v_mul_u32_u24 v6, 24, v5
    v_sub_u32 v6, v4, v6
    v_lshrrev_b32 v7, 1, v5
    v_xor_b32 v6, v6, v7
    v_add_u32 v5, s14, v5
    v_mul_u32_u24 v5, 1152, v5
    v_lshl_add_u32 v216, v6, 4, v5
    s_mul_i32 s14, s8, 144
    v_lshrrev_b32 v4, 3, v0
    v_and_b32 v5, 7, v0
    v_bfe_u32 v6, v4, 1, 1
    v_lshlrev_b32 v6, 2, v6
    v_xor_b32 v5, v5, v6
    v_lshl_add_u32 v5, v5, 4, s14
    v_mul_u32_u24 v6, 1152, v4
    v_add_u32 v217, v5, v6
    v_lshrrev_b32 v6, 1, v4
    v_mul_u32_u24 v6, 18, v6
    v_and_b32 v7, 1, v4
    v_add3_u32 v6, v6, v7, 16
    v_mul_u32_u24 v6, 1152, v6
    v_add_u32 v219, v5, v6
    s_add_u32 s14, s14, 128
    v_lshrrev_b32 v4, 4, v0
    v_mul_u32_u24 v4, 18, v4
    v_and_b32 v5, 15, v0
    v_add_u32 v4, v4, v5
    v_mul_u32_u24 v4, 1152, v4
    v_add_u32 v218, s14, v4
    v_bfe_u32 v4, v0, 1, 2
    v_mul_u32_u24 v4, 18, v4
    v_and_b32 v5, 1, v0
    v_add3_u32 v4, v4, v5, 16
    v_mul_u32_u24 v4, 1152, v4
    v_add_u32 v220, s14, v4
    s_lshl_b32 s10, s7, 1
    s_add_u32 s10, s10, s22
    s_mul_i32 s95, s10, 73728
    s_add_u32 s95, s95, 10485760
    s_lshl_b32 s10, s23, 3
    s_lshl_b32 s12, s22, 1
    s_add_u32 s10, s10, s12
    s_mul_i32 s97, s10, 20736
    s_lshl_b32 s10, s23, 2
    s_add_u32 s10, s10, s12
    s_lshl_b32 s98, s10, 11
    v_bfe_u32 v6, v2, 1, 3
    v_mul_u32_u24 v7, 27648, v3
    v_mul_u32_u24 v8, 384, v2
    v_add_u32 v7, v7, v8
    v_add_u32 v7, 61440, v7
    s_mul_i32 s10, s23, 6
    s_add_u32 s12, s10, 0
    v_xor_b32 v8, s12, v6
    v_lshl_add_u32 v229, v8, 4, v7
    s_add_u32 s12, s10, 1
    v_xor_b32 v8, s12, v6
    v_lshl_add_u32 v230, v8, 4, v7
    s_add_u32 s12, s10, 2
    v_xor_b32 v8, s12, v6
    v_lshl_add_u32 v231, v8, 4, v7
    s_add_u32 s12, s10, 3
    v_xor_b32 v8, s12, v6
    v_lshl_add_u32 v232, v8, 4, v7
    s_add_u32 s12, s10, 4
    v_xor_b32 v8, s12, v6
    v_lshl_add_u32 v233, v8, 4, v7
    s_add_u32 s12, s10, 5
    v_xor_b32 v8, s12, v6
    v_lshl_add_u32 v234, v8, 4, v7
    v_and_b32 v4, 3, v0
    v_bfe_u32 v5, v0, 2, 2
    v_bfe_u32 v6, v0, 4, 1
    v_lshl_add_u32 v7, v3, 3, v5
    v_lshlrev_b32 v8, 7, v7
    v_lshl_add_u32 v8, v6, 5, v8
    v_lshl_add_u32 v8, v4, 3, v8
    v_lshrrev_b32 v5, 1, v5
    v_lshl_add_u32 v235, v5, 6, v8
    v_and_b32 v4, 1, v4
    v_lshlrev_b32 v7, 4, v7
    v_lshl_add_u32 v236, v4, 3, v7
    s_mul_i32 s14, s4, 144
    s_mov_b32 s3, 3641
    s_mul_i32 s12, s7, 147456
    s_mul_i32 s15, s8, 288
    s_add_u32 s12, s12, s15
    s_mul_i32 s15, s8, 144
    v_add_u32 v4, s14, v0
    v_add_u32 v4, 0, v4
    v_mul_u32_u24 v5, s3, v4
    v_lshrrev_b32 v5, 16, v5
    v_mul_u32_u24 v6, 18, v5
    v_sub_u32 v6, v4, v6
    v_mul_u32_u24 v7, 2304, v5
    v_lshl_add_u32 v7, v6, 4, v7
    v_add_u32 v237, s12, v7
    v_lshl_add_u32 v240, v6, 3, s15
    v_lshlrev_b32 v243, 2, v5
    v_add_u32 v4, s14, v0
    v_add_u32 v4, 64, v4
    v_mul_u32_u24 v5, s3, v4
    v_lshrrev_b32 v5, 16, v5
    v_mul_u32_u24 v6, 18, v5
    v_sub_u32 v6, v4, v6
    v_mul_u32_u24 v7, 2304, v5
    v_lshl_add_u32 v7, v6, 4, v7
    v_add_u32 v238, s12, v7
    v_lshl_add_u32 v241, v6, 3, s15
    v_lshlrev_b32 v244, 2, v5
    v_add_u32 v4, s14, v0
    v_add_u32 v4, 128, v4
    v_mul_u32_u24 v5, s3, v4
    v_lshrrev_b32 v5, 16, v5
    v_mul_u32_u24 v6, 18, v5
    v_sub_u32 v6, v4, v6
    v_mul_u32_u24 v7, 2304, v5
    v_lshl_add_u32 v7, v6, 4, v7
    v_add_u32 v239, s12, v7
    v_lshl_add_u32 v242, v6, 3, s15
    v_lshlrev_b32 v245, 2, v5
    s_mul_i32 s10, s23, 18432
    s_mul_i32 s12, s22, 9216
    s_add_u32 s10, s10, s12
    s_cmp_ge_u32 s4, 4
    s_cselect_b32 s12, 24576, 0
    s_add_u32 s10, s10, s12
    v_mul_u32_u24 v4, 288, v2
    v_lshl_add_u32 v4, v3, 4, v4
    v_add_u32 v246, s10, v4
    s_and_b32 s10, s7, 3
    s_lshl_b32 s10, s10, 3
    s_add_u32 s10, s10, s4
    s_cmp_ge_u32 s10, 7
    s_cselect_b32 s12, 7, 0
    s_cmp_ge_u32 s10, 14
    s_cselect_b32 s12, 14, s12
    s_sub_u32 s12, s10, s12
    s_lshl_b32 s12, s12, 6
    v_add_u32 v4, s12, v0
    s_mov_b32 s3, 10923
    v_mul_u32_u24 v5, s3, v4
    v_lshrrev_b32 v5, 16, v5
    v_mul_u32_u24 v6, 6, v5
    v_sub_u32 v6, v4, v6
    v_min_u32 v5, 71, v5
    s_mul_i32 s14, s8, 72
    v_add_u32 v5, s14, v5
    v_mul_u32_u24 v5, 1152, v5
    v_lshl_add_u32 v5, v6, 7, v5
    v_add_u32 v5, 384, v5
    v_lshrrev_b32 v6, 1, v4
    v_mul_u32_u24 v6, 1152, v6
    v_and_b32 v7, 1, v4
    v_mul_u32_u24 v7, 140, v7
    v_add3_u32 v6, v6, v7, s15
    s_cmp_ge_u32 s10, 14
    s_cselect_b64 vcc, -1, 0
    v_cndmask_b32 v226, v5, v6, vcc
    s_bitcmp1_b32 s90, 2
    s_cbranch_scc0 L_ty_45
    s_waitcnt vmcnt(0)
    s_mov_b32 s12, 0xffff0000
    s_mov_b32 s13, 0x3f803f80
    v_mov_b32 v10, 0
    v_mov_b32 v11, 0
    v_lshlrev_b32 v4, 16, v154
    v_and_b32 v5, s12, v154
    v_lshlrev_b32 v6, 16, v16
    v_and_b32 v7, s12, v16
    v_pk_mul_f32 v[6:7], v[6:7], v[4:5]
    v_cvt_pk_bf16_f32 v16, v6, v7
    v_dot2c_f32_bf16 v10, s13, v16
    v_lshlrev_b32 v8, 16, v52
    v_and_b32 v9, s12, v52
    v_pk_mul_f32 v[8:9], v[8:9], v[4:5]
    v_cvt_pk_bf16_f32 v52, v8, v9
    v_dot2c_f32_bf16 v11, s13, v52
    v_lshlrev_b32 v4, 16, v155
    v_and_b32 v5, s12, v155
    v_lshlrev_b32 v6, 16, v17
    v_and_b32 v7, s12, v17
    v_pk_mul_f32 v[6:7], v[6:7], v[4:5]
    v_cvt_pk_bf16_f32 v17, v6, v7
    v_dot2c_f32_bf16 v10, s13, v17
    v_lshlrev_b32 v8, 16, v53
    v_and_b32 v9, s12, v53
    v_pk_mul_f32 v[8:9], v[8:9], v[4:5]
    v_cvt_pk_bf16_f32 v53, v8, v9
    v_dot2c_f32_bf16 v11, s13, v53
    v_lshlrev_b32 v4, 16, v156
    v_and_b32 v5, s12, v156
    v_lshlrev_b32 v6, 16, v18
    v_and_b32 v7, s12, v18
    v_pk_mul_f32 v[6:7], v[6:7], v[4:5]
    v_cvt_pk_bf16_f32 v18, v6, v7
    v_dot2c_f32_bf16 v10, s13, v18
    v_lshlrev_b32 v8, 16, v54
    v_and_b32 v9, s12, v54
    v_pk_mul_f32 v[8:9], v[8:9], v[4:5]
    v_cvt_pk_bf16_f32 v54, v8, v9
    v_dot2c_f32_bf16 v11, s13, v54
    v_lshlrev_b32 v4, 16, v157
    v_and_b32 v5, s12, v157
    v_lshlrev_b32 v6, 16, v19
    v_and_b32 v7, s12, v19
    v_pk_mul_f32 v[6:7], v[6:7], v[4:5]
    v_cvt_pk_bf16_f32 v19, v6, v7
    v_dot2c_f32_bf16 v10, s13, v19
    v_lshlrev_b32 v8, 16, v55
    v_and_b32 v9, s12, v55
    v_pk_mul_f32 v[8:9], v[8:9], v[4:5]
    v_cvt_pk_bf16_f32 v55, v8, v9
    v_dot2c_f32_bf16 v11, s13, v55
    v_lshlrev_b32 v4, 16, v158
    v_and_b32 v5, s12, v158
    v_lshlrev_b32 v6, 16, v20
    v_and_b32 v7, s12, v20
    v_pk_mul_f32 v[6:7], v[6:7], v[4:5]
    v_cvt_pk_bf16_f32 v20, v6, v7
    v_dot2c_f32_bf16 v10, s13, v20
    v_lshlrev_b32 v8, 16, v56
    v_and_b32 v9, s12, v56
    v_pk_mul_f32 v[8:9], v[8:9], v[4:5]
    v_cvt_pk_bf16_f32 v56, v8, v9
    v_dot2c_f32_bf16 v11, s13, v56
    v_lshlrev_b32 v4, 16, v159
    v_and_b32 v5, s12, v159
    v_lshlrev_b32 v6, 16, v21
    v_and_b32 v7, s12, v21
    v_pk_mul_f32 v[6:7], v[6:7], v[4:5]
    v_cvt_pk_bf16_f32 v21, v6, v7
    v_dot2c_f32_bf16 v10, s13, v21
    v_lshlrev_b32 v8, 16, v57
    v_and_b32 v9, s12, v57
    v_pk_mul_f32 v[8:9], v[8:9], v[4:5]
    v_cvt_pk_bf16_f32 v57, v8, v9
    v_dot2c_f32_bf16 v11, s13, v57
    v_lshlrev_b32 v4, 16, v160
    v_and_b32 v5, s12, v160
    v_lshlrev_b32 v6, 16, v22
    v_and_b32 v7, s12, v22
    v_pk_mul_f32 v[6:7], v[6:7], v[4:5]
    v_cvt_pk_bf16_f32 v22, v6, v7
    v_dot2c_f32_bf16 v10, s13, v22
    v_lshlrev_b32 v8, 16, v58
    v_and_b32 v9, s12, v58
    v_pk_mul_f32 v[8:9], v[8:9], v[4:5]
    v_cvt_pk_bf16_f32 v58, v8, v9
    v_dot2c_f32_bf16 v11, s13, v58
    v_lshlrev_b32 v4, 16, v161
    v_and_b32 v5, s12, v161
    v_lshlrev_b32 v6, 16, v23
    v_and_b32 v7, s12, v23
    v_pk_mul_f32 v[6:7], v[6:7], v[4:5]
    v_cvt_pk_bf16_f32 v23, v6, v7
    v_dot2c_f32_bf16 v10, s13, v23
    v_lshlrev_b32 v8, 16, v59
    v_and_b32 v9, s12, v59
    v_pk_mul_f32 v[8:9], v[8:9], v[4:5]
    v_cvt_pk_bf16_f32 v59, v8, v9
    v_dot2c_f32_bf16 v11, s13, v59
    v_lshlrev_b32 v4, 16, v162
    v_and_b32 v5, s12, v162
    v_lshlrev_b32 v6, 16, v24
    v_and_b32 v7, s12, v24
    v_pk_mul_f32 v[6:7], v[6:7], v[4:5]
    v_cvt_pk_bf16_f32 v24, v6, v7
    v_dot2c_f32_bf16 v10, s13, v24
    v_lshlrev_b32 v8, 16, v60
    v_and_b32 v9, s12, v60
    v_pk_mul_f32 v[8:9], v[8:9], v[4:5]
    v_cvt_pk_bf16_f32 v60, v8, v9
    v_dot2c_f32_bf16 v11, s13, v60
    v_lshlrev_b32 v4, 16, v163
    v_and_b32 v5, s12, v163
    v_lshlrev_b32 v6, 16, v25
    v_and_b32 v7, s12, v25
    v_pk_mul_f32 v[6:7], v[6:7], v[4:5]
    v_cvt_pk_bf16_f32 v25, v6, v7
    v_dot2c_f32_bf16 v10, s13, v25
    v_lshlrev_b32 v8, 16, v61
    v_and_b32 v9, s12, v61
    v_pk_mul_f32 v[8:9], v[8:9], v[4:5]
    v_cvt_pk_bf16_f32 v61, v8, v9
    v_dot2c_f32_bf16 v11, s13, v61
    v_lshlrev_b32 v4, 16, v164
    v_and_b32 v5, s12, v164
    v_lshlrev_b32 v6, 16, v26
    v_and_b32 v7, s12, v26
    v_pk_mul_f32 v[6:7], v[6:7], v[4:5]
    v_cvt_pk_bf16_f32 v26, v6, v7
    v_dot2c_f32_bf16 v10, s13, v26
    v_lshlrev_b32 v8, 16, v62
    v_and_b32 v9, s12, v62
    v_pk_mul_f32 v[8:9], v[8:9], v[4:5]
    v_cvt_pk_bf16_f32 v62, v8, v9
    v_dot2c_f32_bf16 v11, s13, v62
    v_lshlrev_b32 v4, 16, v165
    v_and_b32 v5, s12, v165
    v_lshlrev_b32 v6, 16, v27
    v_and_b32 v7, s12, v27
    v_pk_mul_f32 v[6:7], v[6:7], v[4:5]
    v_cvt_pk_bf16_f32 v27, v6, v7
    v_dot2c_f32_bf16 v10, s13, v27
    v_lshlrev_b32 v8, 16, v63
    v_and_b32 v9, s12, v63
    v_pk_mul_f32 v[8:9], v[8:9], v[4:5]
    v_cvt_pk_bf16_f32 v63, v8, v9
    v_dot2c_f32_bf16 v11, s13, v63
    v_lshlrev_b32 v4, 16, v166
    v_and_b32 v5, s12, v166
    v_lshlrev_b32 v6, 16, v28
    v_and_b32 v7, s12, v28
    v_pk_mul_f32 v[6:7], v[6:7], v[4:5]
    v_cvt_pk_bf16_f32 v28, v6, v7
    v_dot2c_f32_bf16 v10, s13, v28
    v_lshlrev_b32 v8, 16, v64
    v_and_b32 v9, s12, v64
    v_pk_mul_f32 v[8:9], v[8:9], v[4:5]
    v_cvt_pk_bf16_f32 v64, v8, v9
    v_dot2c_f32_bf16 v11, s13, v64
    v_lshlrev_b32 v4, 16, v167
    v_and_b32 v5, s12, v167
    v_lshlrev_b32 v6, 16, v29
    v_and_b32 v7, s12, v29
    v_pk_mul_f32 v[6:7], v[6:7], v[4:5]
    v_cvt_pk_bf16_f32 v29, v6, v7
    v_dot2c_f32_bf16 v10, s13, v29
    v_lshlrev_b32 v8, 16, v65
    v_and_b32 v9, s12, v65
    v_pk_mul_f32 v[8:9], v[8:9], v[4:5]
    v_cvt_pk_bf16_f32 v65, v8, v9
    v_dot2c_f32_bf16 v11, s13, v65
    v_lshlrev_b32 v4, 16, v168
    v_and_b32 v5, s12, v168
    v_lshlrev_b32 v6, 16, v30
    v_and_b32 v7, s12, v30
    v_pk_mul_f32 v[6:7], v[6:7], v[4:5]
    v_cvt_pk_bf16_f32 v30, v6, v7
    v_dot2c_f32_bf16 v10, s13, v30
    v_lshlrev_b32 v8, 16, v66
    v_and_b32 v9, s12, v66
    v_pk_mul_f32 v[8:9], v[8:9], v[4:5]
    v_cvt_pk_bf16_f32 v66, v8, v9
    v_dot2c_f32_bf16 v11, s13, v66
    v_lshlrev_b32 v4, 16, v169
    v_and_b32 v5, s12, v169
    v_lshlrev_b32 v6, 16, v31
    v_and_b32 v7, s12, v31
    v_pk_mul_f32 v[6:7], v[6:7], v[4:5]
    v_cvt_pk_bf16_f32 v31, v6, v7
    v_dot2c_f32_bf16 v10, s13, v31
    v_lshlrev_b32 v8, 16, v67
    v_and_b32 v9, s12, v67
    v_pk_mul_f32 v[8:9], v[8:9], v[4:5]
    v_cvt_pk_bf16_f32 v67, v8, v9
    v_dot2c_f32_bf16 v11, s13, v67
    v_lshlrev_b32 v4, 16, v170
    v_and_b32 v5, s12, v170
    v_lshlrev_b32 v6, 16, v32
    v_and_b32 v7, s12, v32
    v_pk_mul_f32 v[6:7], v[6:7], v[4:5]
    v_cvt_pk_bf16_f32 v32, v6, v7
    v_dot2c_f32_bf16 v10, s13, v32
    v_lshlrev_b32 v8, 16, v68
    v_and_b32 v9, s12, v68
    v_pk_mul_f32 v[8:9], v[8:9], v[4:5]
    v_cvt_pk_bf16_f32 v68, v8, v9
    v_dot2c_f32_bf16 v11, s13, v68
    v_lshlrev_b32 v4, 16, v171
    v_and_b32 v5, s12, v171
    v_lshlrev_b32 v6, 16, v33
    v_and_b32 v7, s12, v33
    v_pk_mul_f32 v[6:7], v[6:7], v[4:5]
    v_cvt_pk_bf16_f32 v33, v6, v7
    v_dot2c_f32_bf16 v10, s13, v33
    v_lshlrev_b32 v8, 16, v69
    v_and_b32 v9, s12, v69
    v_pk_mul_f32 v[8:9], v[8:9], v[4:5]
    v_cvt_pk_bf16_f32 v69, v8, v9
    v_dot2c_f32_bf16 v11, s13, v69
    v_lshlrev_b32 v4, 16, v172
    v_and_b32 v5, s12, v172
    v_lshlrev_b32 v6, 16, v34
    v_and_b32 v7, s12, v34
    v_pk_mul_f32 v[6:7], v[6:7], v[4:5]
    v_cvt_pk_bf16_f32 v34, v6, v7
    v_dot2c_f32_bf16 v10, s13, v34
    v_lshlrev_b32 v8, 16, v70
    v_and_b32 v9, s12, v70
    v_pk_mul_f32 v[8:9], v[8:9], v[4:5]
    v_cvt_pk_bf16_f32 v70, v8, v9
    v_dot2c_f32_bf16 v11, s13, v70
    v_lshlrev_b32 v4, 16, v173
    v_and_b32 v5, s12, v173
    v_lshlrev_b32 v6, 16, v35
    v_and_b32 v7, s12, v35
    v_pk_mul_f32 v[6:7], v[6:7], v[4:5]
    v_cvt_pk_bf16_f32 v35, v6, v7
    v_dot2c_f32_bf16 v10, s13, v35
    v_lshlrev_b32 v8, 16, v71
    v_and_b32 v9, s12, v71
    v_pk_mul_f32 v[8:9], v[8:9], v[4:5]
    v_cvt_pk_bf16_f32 v71, v8, v9
    v_dot2c_f32_bf16 v11, s13, v71
    v_lshlrev_b32 v4, 16, v174
    v_and_b32 v5, s12, v174
    v_lshlrev_b32 v6, 16, v36
    v_and_b32 v7, s12, v36
    v_pk_mul_f32 v[6:7], v[6:7], v[4:5]
    v_cvt_pk_bf16_f32 v36, v6, v7
    v_dot2c_f32_bf16 v10, s13, v36
    v_lshlrev_b32 v8, 16, v72
    v_and_b32 v9, s12, v72
    v_pk_mul_f32 v[8:9], v[8:9], v[4:5]
    v_cvt_pk_bf16_f32 v72, v8, v9
    v_dot2c_f32_bf16 v11, s13, v72
    v_lshlrev_b32 v4, 16, v175
    v_and_b32 v5, s12, v175
    v_lshlrev_b32 v6, 16, v37
    v_and_b32 v7, s12, v37
    v_pk_mul_f32 v[6:7], v[6:7], v[4:5]
    v_cvt_pk_bf16_f32 v37, v6, v7
    v_dot2c_f32_bf16 v10, s13, v37
    v_lshlrev_b32 v8, 16, v73
    v_and_b32 v9, s12, v73
    v_pk_mul_f32 v[8:9], v[8:9], v[4:5]
    v_cvt_pk_bf16_f32 v73, v8, v9
    v_dot2c_f32_bf16 v11, s13, v73
    v_lshlrev_b32 v4, 16, v176
    v_and_b32 v5, s12, v176
    v_lshlrev_b32 v6, 16, v38
    v_and_b32 v7, s12, v38
    v_pk_mul_f32 v[6:7], v[6:7], v[4:5]
    v_cvt_pk_bf16_f32 v38, v6, v7
    v_dot2c_f32_bf16 v10, s13, v38
    v_lshlrev_b32 v8, 16, v74
    v_and_b32 v9, s12, v74
    v_pk_mul_f32 v[8:9], v[8:9], v[4:5]
    v_cvt_pk_bf16_f32 v74, v8, v9
    v_dot2c_f32_bf16 v11, s13, v74
    v_lshlrev_b32 v4, 16, v177
    v_and_b32 v5, s12, v177
    v_lshlrev_b32 v6, 16, v39
    v_and_b32 v7, s12, v39
    v_pk_mul_f32 v[6:7], v[6:7], v[4:5]
    v_cvt_pk_bf16_f32 v39, v6, v7
    v_dot2c_f32_bf16 v10, s13, v39
    v_lshlrev_b32 v8, 16, v75
    v_and_b32 v9, s12, v75
    v_pk_mul_f32 v[8:9], v[8:9], v[4:5]
    v_cvt_pk_bf16_f32 v75, v8, v9
    v_dot2c_f32_bf16 v11, s13, v75
    v_lshlrev_b32 v4, 16, v178
    v_and_b32 v5, s12, v178
    v_lshlrev_b32 v6, 16, v40
    v_and_b32 v7, s12, v40
    v_pk_mul_f32 v[6:7], v[6:7], v[4:5]
    v_cvt_pk_bf16_f32 v40, v6, v7
    v_dot2c_f32_bf16 v10, s13, v40
    v_lshlrev_b32 v8, 16, v76
    v_and_b32 v9, s12, v76
    v_pk_mul_f32 v[8:9], v[8:9], v[4:5]
    v_cvt_pk_bf16_f32 v76, v8, v9
    v_dot2c_f32_bf16 v11, s13, v76
    v_lshlrev_b32 v4, 16, v179
    v_and_b32 v5, s12, v179
    v_lshlrev_b32 v6, 16, v41
    v_and_b32 v7, s12, v41
    v_pk_mul_f32 v[6:7], v[6:7], v[4:5]
    v_cvt_pk_bf16_f32 v41, v6, v7
    v_dot2c_f32_bf16 v10, s13, v41
    v_lshlrev_b32 v8, 16, v77
    v_and_b32 v9, s12, v77
    v_pk_mul_f32 v[8:9], v[8:9], v[4:5]
    v_cvt_pk_bf16_f32 v77, v8, v9
    v_dot2c_f32_bf16 v11, s13, v77
    v_lshlrev_b32 v4, 16, v180
    v_and_b32 v5, s12, v180
    v_lshlrev_b32 v6, 16, v42
    v_and_b32 v7, s12, v42
    v_pk_mul_f32 v[6:7], v[6:7], v[4:5]
    v_cvt_pk_bf16_f32 v42, v6, v7
    v_dot2c_f32_bf16 v10, s13, v42
    v_lshlrev_b32 v8, 16, v78
    v_and_b32 v9, s12, v78
    v_pk_mul_f32 v[8:9], v[8:9], v[4:5]
    v_cvt_pk_bf16_f32 v78, v8, v9
    v_dot2c_f32_bf16 v11, s13, v78
    v_lshlrev_b32 v4, 16, v181
    v_and_b32 v5, s12, v181
    v_lshlrev_b32 v6, 16, v43
    v_and_b32 v7, s12, v43
    v_pk_mul_f32 v[6:7], v[6:7], v[4:5]
    v_cvt_pk_bf16_f32 v43, v6, v7
    v_dot2c_f32_bf16 v10, s13, v43
    v_lshlrev_b32 v8, 16, v79
    v_and_b32 v9, s12, v79
    v_pk_mul_f32 v[8:9], v[8:9], v[4:5]
    v_cvt_pk_bf16_f32 v79, v8, v9
    v_dot2c_f32_bf16 v11, s13, v79
    v_lshlrev_b32 v4, 16, v182
    v_and_b32 v5, s12, v182
    v_lshlrev_b32 v6, 16, v44
    v_and_b32 v7, s12, v44
    v_pk_mul_f32 v[6:7], v[6:7], v[4:5]
    v_cvt_pk_bf16_f32 v44, v6, v7
    v_dot2c_f32_bf16 v10, s13, v44
    v_lshlrev_b32 v8, 16, v80
    v_and_b32 v9, s12, v80
    v_pk_mul_f32 v[8:9], v[8:9], v[4:5]
    v_cvt_pk_bf16_f32 v80, v8, v9
    v_dot2c_f32_bf16 v11, s13, v80
    v_lshlrev_b32 v4, 16, v183
    v_and_b32 v5, s12, v183
    v_lshlrev_b32 v6, 16, v45
    v_and_b32 v7, s12, v45
    v_pk_mul_f32 v[6:7], v[6:7], v[4:5]
    v_cvt_pk_bf16_f32 v45, v6, v7
    v_dot2c_f32_bf16 v10, s13, v45
    v_lshlrev_b32 v8, 16, v81
    v_and_b32 v9, s12, v81
    v_pk_mul_f32 v[8:9], v[8:9], v[4:5]
    v_cvt_pk_bf16_f32 v81, v8, v9
    v_dot2c_f32_bf16 v11, s13, v81
    v_lshlrev_b32 v4, 16, v184
    v_and_b32 v5, s12, v184
    v_lshlrev_b32 v6, 16, v46
    v_and_b32 v7, s12, v46
    v_pk_mul_f32 v[6:7], v[6:7], v[4:5]
    v_cvt_pk_bf16_f32 v46, v6, v7
    v_dot2c_f32_bf16 v10, s13, v46
    v_lshlrev_b32 v8, 16, v82
    v_and_b32 v9, s12, v82
    v_pk_mul_f32 v[8:9], v[8:9], v[4:5]
    v_cvt_pk_bf16_f32 v82, v8, v9
    v_dot2c_f32_bf16 v11, s13, v82
    v_lshlrev_b32 v4, 16, v185
    v_and_b32 v5, s12, v185
    v_lshlrev_b32 v6, 16, v47
    v_and_b32 v7, s12, v47
    v_pk_mul_f32 v[6:7], v[6:7], v[4:5]
    v_cvt_pk_bf16_f32 v47, v6, v7
    v_dot2c_f32_bf16 v10, s13, v47
    v_lshlrev_b32 v8, 16, v83
    v_and_b32 v9, s12, v83
    v_pk_mul_f32 v[8:9], v[8:9], v[4:5]
    v_cvt_pk_bf16_f32 v83, v8, v9
    v_dot2c_f32_bf16 v11, s13, v83
    v_lshlrev_b32 v4, 16, v186
    v_and_b32 v5, s12, v186
    v_lshlrev_b32 v6, 16, v48
    v_and_b32 v7, s12, v48
    v_pk_mul_f32 v[6:7], v[6:7], v[4:5]
    v_cvt_pk_bf16_f32 v48, v6, v7
    v_dot2c_f32_bf16 v10, s13, v48
    v_lshlrev_b32 v8, 16, v84
    v_and_b32 v9, s12, v84
    v_pk_mul_f32 v[8:9], v[8:9], v[4:5]
    v_cvt_pk_bf16_f32 v84, v8, v9
    v_dot2c_f32_bf16 v11, s13, v84
    v_lshlrev_b32 v4, 16, v187
    v_and_b32 v5, s12, v187
    v_lshlrev_b32 v6, 16, v49
    v_and_b32 v7, s12, v49
    v_pk_mul_f32 v[6:7], v[6:7], v[4:5]
    v_cvt_pk_bf16_f32 v49, v6, v7
    v_dot2c_f32_bf16 v10, s13, v49
    v_lshlrev_b32 v8, 16, v85
    v_and_b32 v9, s12, v85
    v_pk_mul_f32 v[8:9], v[8:9], v[4:5]
    v_cvt_pk_bf16_f32 v85, v8, v9
    v_dot2c_f32_bf16 v11, s13, v85
    v_lshlrev_b32 v4, 16, v188
    v_and_b32 v5, s12, v188
    v_lshlrev_b32 v6, 16, v50
    v_and_b32 v7, s12, v50
    v_pk_mul_f32 v[6:7], v[6:7], v[4:5]
    v_cvt_pk_bf16_f32 v50, v6, v7
    v_dot2c_f32_bf16 v10, s13, v50
    v_lshlrev_b32 v8, 16, v86
    v_and_b32 v9, s12, v86
    v_pk_mul_f32 v[8:9], v[8:9], v[4:5]
    v_cvt_pk_bf16_f32 v86, v8, v9
    v_dot2c_f32_bf16 v11, s13, v86
    v_lshlrev_b32 v4, 16, v189
    v_and_b32 v5, s12, v189
    v_lshlrev_b32 v6, 16, v51
    v_and_b32 v7, s12, v51
    v_pk_mul_f32 v[6:7], v[6:7], v[4:5]
    v_cvt_pk_bf16_f32 v51, v6, v7
    v_dot2c_f32_bf16 v10, s13, v51
    v_lshlrev_b32 v8, 16, v87
    v_and_b32 v9, s12, v87
    v_pk_mul_f32 v[8:9], v[8:9], v[4:5]
    v_cvt_pk_bf16_f32 v87, v8, v9
    v_dot2c_f32_bf16 v11, s13, v87
    s_nop 3
    v_add_f32_dpp v12, v10, v10 quad_perm:[1,0,3,2] row_mask:0xf bank_mask:0xf
    v_add_f32_dpp v13, v11, v11 quad_perm:[1,0,3,2] row_mask:0xf bank_mask:0xf
    v_mov_b32 v10, v12
    v_mov_b32 v11, v13
    s_nop 0
    v_add_f32_dpp v12, v10, v10 quad_perm:[2,3,0,1] row_mask:0xf bank_mask:0xf
    v_add_f32_dpp v13, v11, v11 quad_perm:[2,3,0,1] row_mask:0xf bank_mask:0xf
    v_mov_b32 v10, v12
    v_mov_b32 v11, v13
    s_nop 0
    v_add_f32_dpp v12, v10, v10 row_half_mirror row_mask:0xf bank_mask:0xf
    v_add_f32_dpp v13, v11, v11 row_half_mirror row_mask:0xf bank_mask:0xf
    v_mov_b32 v10, v12
    v_mov_b32 v11, v13
    v_and_b32 v4, 1, v0
    v_cmp_eq_u32 vcc, 1, v4
    s_mov_b32 s13, 0xbfb8aa3b
    v_bfe_u32 v5, v0, 1, 1
    v_cndmask_b32 v10, v10, v11, vcc
    v_cvt_pk_bf16_f32 v6, v10, v10
    v_lshlrev_b32 v6, 16, v6
    v_mul_f32 v6, s13, v6
    v_exp_f32 v6, v6
    v_cmp_eq_u32 vcc, 1, v5
    v_add_f32 v6, 1.0, v6
    v_rcp_f32 v6, v6
    v_lshrrev_b32 v7, 3, v0
    v_cvt_pk_bf16_f32 v6, v6, v6
    v_lshlrev_b32 v12, 16, v6
    v_sub_f32 v6, 1.0, v12
    v_cvt_pk_bf16_f32 v6, v6, v6
    v_lshlrev_b32 v13, 16, v6
    v_cndmask_b32 v12, v12, v13, vcc
    v_lshl_add_u32 v7, v4, 3, v7
    v_lshlrev_b32 v7, 2, v7
    v_lshl_add_u32 v7, v5, 9, v7
    s_lshl_b32 s10, s5, 10
    s_and_b32 s11, s2, 1
    s_lshl_b32 s11, s11, 8
    s_add_u32 s10, s10, s11
    s_lshl_b32 s11, s4, 6
    s_add_u32 s10, s10, s11
    s_add_u32 s10, s10, 327680
    s_mov_b32 exec_lo, 0x0f0f0f0f
    s_mov_b32 exec_hi, 0x0f0f0f0f
    buffer_store_dword v12, v7, s[60:63], s10 offen sc1
    s_mov_b64 exec, -1
    s_waitcnt vmcnt(0)
L_ty_45:
    s_waitcnt lgkmcnt(0)
    s_mul_i32 s9, s9, 0x9E3779B1
    s_add_u32 s9, s9, 0x7F4A7C15
    s_barrier
    s_bitcmp1_b32 s90, 2
    s_cbranch_scc1 L_U
    s_lshl_b32 s15, s6, 1
    s_add_u32 s15, s15, s81
    s_bitcmp1_b32 s90, 1
    s_cbranch_scc0 L_Aonly
    s_cmp_ge_u32 s6, 9
    s_cbranch_scc1 L_VU
L_TU:
    ds_read_b128 v[80:83], v198 offset:0
    ds_read_b128 v[84:87], v198 offset:4096
    ds_read_b64_tr_b16 v[88:89], v104 offset:0
    ds_read_b64_tr_b16 v[90:91], v104 offset:1024
    ds_read_b64_tr_b16 v[92:93], v105 offset:0
    ds_read_b64_tr_b16 v[94:95], v105 offset:1024
    ds_read_b128 v[96:99], v100
    ds_read_b128 v[154:157], v247 offset:0
    ds_read_b128 v[158:161], v247 offset:4096
    ds_read_b128 v[162:165], v247 offset:8192
L_g1_46:
    s_waitcnt lgkmcnt(4)
    v_mfma_f32_32x32x16_bf16 v[16:31], v[88:91], v[80:83], v[16:31]
    ds_read_b128 v[166:169], v199 offset:0
    ds_read_b128 v[170:173], v199 offset:4096
    ds_read_b64_tr_b16 v[174:175], v104 offset:4096
    v_mfma_f32_32x32x16_bf16 v[32:47], v[88:91], v[84:87], v[32:47]
    ds_read_b64_tr_b16 v[176:177], v104 offset:5120
    ds_read_b64_tr_b16 v[178:179], v105 offset:4096
    ds_read_b64_tr_b16 v[180:181], v105 offset:5120
    v_mfma_f32_32x32x16_bf16 v[48:63], v[92:95], v[80:83], v[48:63]
    ds_read_b128 v[182:185], v101
    ds_read_b128 v[186:189], v248 offset:0
    ds_read_b128 v[190:193], v248 offset:4096
    v_mfma_f32_32x32x16_bf16 v[64:79], v[92:95], v[84:87], v[64:79]
    ds_read_b128 v[194:197], v248 offset:8192
    s_waitcnt lgkmcnt(10)
    v_mfma_f32_32x32x16_bf16 v[106:121], v[96:99], v[154:157], v[106:121]
    v_mfma_f32_32x32x16_bf16 v[122:137], v[96:99], v[158:161], v[122:137]
    v_mfma_f32_32x32x16_bf16 v[138:153], v[96:99], v[162:165], v[138:153]
    s_waitcnt lgkmcnt(4)
    v_mfma_f32_32x32x16_bf16 v[16:31], v[174:177], v[166:169], v[16:31]
    ds_read_b128 v[80:83], v200 offset:0
    ds_read_b128 v[84:87], v200 offset:4096
    ds_read_b64_tr_b16 v[88:89], v104 offset:8192
    v_mfma_f32_32x32x16_bf16 v[32:47], v[174:177], v[170:173], v[32:47]
    ds_read_b64_tr_b16 v[90:91], v104 offset:9216
    ds_read_b64_tr_b16 v[92:93], v105 offset:8192
    ds_read_b64_tr_b16 v[94:95], v105 offset:9216
    v_mfma_f32_32x32x16_bf16 v[48:63], v[178:181], v[166:169], v[48:63]
    ds_read_b128 v[96:99], v102
    ds_read_b128 v[154:157], v249 offset:0
    ds_read_b128 v[158:161], v249 offset:4096
    v_mfma_f32_32x32x16_bf16 v[64:79], v[178:181], v[170:173], v[64:79]
    ds_read_b128 v[162:165], v249 offset:8192
    s_waitcnt lgkmcnt(10)
    v_mfma_f32_32x32x16_bf16 v[106:121], v[182:185], v[186:189], v[106:121]
    v_mfma_f32_32x32x16_bf16 v[122:137], v[182:185], v[190:193], v[122:137]
    v_mfma_f32_32x32x16_bf16 v[138:153], v[182:185], v[194:197], v[138:153]
    s_mov_b32 s14, 45056
    s_cmp_eq_u32 s85, 90112
    s_cselect_b32 s14, 4294877184, s14
    s_waitcnt lgkmcnt(4)
    v_mfma_f32_32x32x16_bf16 v[16:31], v[88:91], v[80:83], v[16:31]
    ds_read_b128 v[166:169], v201 offset:0
    ds_read_b128 v[170:173], v201 offset:4096
    ds_read_b64_tr_b16 v[174:175], v104 offset:12288
    v_mfma_f32_32x32x16_bf16 v[32:47], v[88:91], v[84:87], v[32:47]
    ds_read_b64_tr_b16 v[176:177], v104 offset:13312
    ds_read_b64_tr_b16 v[178:179], v105 offset:12288
    ds_read_b64_tr_b16 v[180:181], v105 offset:13312
    v_mfma_f32_32x32x16_bf16 v[48:63], v[92:95], v[80:83], v[48:63]
    ds_read_b128 v[182:185], v103
    ds_read_b128 v[186:189], v250 offset:0
    ds_read_b128 v[190:193], v250 offset:4096
    v_mfma_f32_32x32x16_bf16 v[64:79], v[92:95], v[84:87], v[64:79]
    ds_read_b128 v[194:197], v250 offset:8192
    v_add_u32 v198, s14, v198
    v_add_u32 v199, s14, v199
    v_add_u32 v200, s14, v200
    v_add_u32 v201, s14, v201
    v_add_u32 v104, s14, v104
    s_waitcnt lgkmcnt(10)
    v_mfma_f32_32x32x16_bf16 v[106:121], v[96:99], v[154:157], v[106:121]
    v_add_u32 v105, s14, v105
    v_add_u32 v100, s14, v100
    v_add_u32 v101, s14, v101
    v_add_u32 v102, s14, v102
    v_add_u32 v103, s14, v103
    v_mfma_f32_32x32x16_bf16 v[122:137], v[96:99], v[158:161], v[122:137]
    v_add_u32 v247, s14, v247
    v_add_u32 v248, s14, v248
    v_add_u32 v249, s14, v249
    v_add_u32 v250, s14, v250
    v_mfma_f32_32x32x16_bf16 v[138:153], v[96:99], v[162:165], v[138:153]
    s_waitcnt lgkmcnt(0)
    s_barrier
    v_mfma_f32_32x32x16_bf16 v[16:31], v[174:177], v[166:169], v[16:31]
    s_cmp_eq_u32 s82, 8
    s_cbranch_scc1 L_g1x_47
    s_add_u32 s85, s85, s14
    s_add_u32 s82, s82, 1
    ds_read_b128 v[80:83], v198 offset:0
    ds_read_b128 v[84:87], v198 offset:4096
    ds_read_b64_tr_b16 v[88:89], v104 offset:0
    v_mfma_f32_32x32x16_bf16 v[32:47], v[174:177], v[170:173], v[32:47]
    ds_read_b64_tr_b16 v[90:91], v104 offset:1024
    ds_read_b64_tr_b16 v[92:93], v105 offset:0
    ds_read_b64_tr_b16 v[94:95], v105 offset:1024
    v_mfma_f32_32x32x16_bf16 v[48:63], v[178:181], v[166:169], v[48:63]
    ds_read_b128 v[96:99], v100
    ds_read_b128 v[154:157], v247 offset:0
    ds_read_b128 v[158:161], v247 offset:4096
    v_mfma_f32_32x32x16_bf16 v[64:79], v[178:181], v[170:173], v[64:79]
    ds_read_b128 v[162:165], v247 offset:8192
    v_mfma_f32_32x32x16_bf16 v[106:121], v[182:185], v[186:189], v[106:121]
    v_mfma_f32_32x32x16_bf16 v[122:137], v[182:185], v[190:193], v[122:137]
    v_mfma_f32_32x32x16_bf16 v[138:153], v[182:185], v[194:197], v[138:153]
    s_branch L_g1_46
L_g1x_47:
    v_mfma_f32_32x32x16_bf16 v[32:47], v[174:177], v[170:173], v[32:47]
    v_mfma_f32_32x32x16_bf16 v[48:63], v[178:181], v[166:169], v[48:63]
    v_mfma_f32_32x32x16_bf16 v[64:79], v[178:181], v[170:173], v[64:79]
    v_mfma_f32_32x32x16_bf16 v[106:121], v[182:185], v[186:189], v[106:121]
    v_mfma_f32_32x32x16_bf16 v[122:137], v[182:185], v[190:193], v[122:137]
    v_mfma_f32_32x32x16_bf16 v[138:153], v[182:185], v[194:197], v[138:153]
    s_mul_i32 s10, s4, 7168
    s_add_u32 s10, s10, 135168
    v_add_u32 v13, s10, v221
    ds_read_b128 v[162:165], v13 offset:0
    ds_read_b128 v[166:169], v13 offset:1024
    ds_read_b128 v[170:173], v13 offset:2048
    ds_read_b128 v[174:177], v13 offset:3072
    ds_read_b128 v[178:181], v13 offset:4096
    ds_read_b128 v[182:185], v13 offset:5120
    ds_read_b128 v[186:189], v13 offset:6144
    s_lshl_b32 s12, s5, 1
    s_add_u32 s12, s12, s80
    s_mul_i32 s12, s12, 73728
    s_mov_b32 s13, 4157440
    s_cmp_lt_u32 s15, 9
    s_cselect_b32 s10, 0x3eae1a93, 1.0
    s_cselect_b32 s13, 1048576, s13
    s_mov_b32 s11, s10
    s_add_u32 s13, s13, s12
    s_lshl_b32 s12, s15, 12
    s_add_u32 s13, s13, s12
    s_add_u32 s12, s13, 36864
    v_pk_mul_f32 v[16:17], v[16:17], s[10:11]
    v_pk_mul_f32 v[18:19], v[18:19], s[10:11]
    v_cvt_pk_bf16_f32 v16, v16, v17
    v_cvt_pk_bf16_f32 v17, v18, v19
    buffer_store_dwordx2 v[16:17], v205, s[60:63], s13 offen offset:0 sc1
    s_waitcnt lgkmcnt(0)
    v_fma_f32 v80, v163, v106, v107
    v_fma_f32 v81, v164, v122, v123
    v_fma_f32 v82, v165, v138, v139
    v_fmac_f32_dpp v80, v106, v166 row_ror:8 row_mask:0xf bank_mask:0xf
    v_fmac_f32_dpp v81, v122, v167 row_ror:8 row_mask:0xf bank_mask:0xf
    v_fmac_f32_dpp v82, v138, v168 row_ror:8 row_mask:0xf bank_mask:0xf
    v_fma_f32 v83, v163, v80, v108
    v_fma_f32 v84, v164, v81, v124
    v_fma_f32 v85, v165, v82, v140
    v_fmac_f32_dpp v83, v80, v166 row_ror:8 row_mask:0xf bank_mask:0xf
    v_fmac_f32_dpp v84, v81, v167 row_ror:8 row_mask:0xf bank_mask:0xf
    v_fmac_f32_dpp v85, v82, v168 row_ror:8 row_mask:0xf bank_mask:0xf
    v_pk_mul_f32 v[20:21], v[20:21], s[10:11]
    v_pk_mul_f32 v[22:23], v[22:23], s[10:11]
    v_cvt_pk_bf16_f32 v18, v20, v21
    v_cvt_pk_bf16_f32 v19, v22, v23
    buffer_store_dwordx2 v[18:19], v205, s[60:63], s13 offen offset:512 sc1
    v_fma_f32 v80, v163, v83, v109
    v_fma_f32 v81, v164, v84, v125
    v_fma_f32 v82, v165, v85, v141
    v_fmac_f32_dpp v80, v83, v166 row_ror:8 row_mask:0xf bank_mask:0xf
    v_fmac_f32_dpp v81, v84, v167 row_ror:8 row_mask:0xf bank_mask:0xf
    v_fmac_f32_dpp v82, v85, v168 row_ror:8 row_mask:0xf bank_mask:0xf
    v_fma_f32 v83, v163, v80, v110
    v_fma_f32 v84, v164, v81, v126
    v_fma_f32 v85, v165, v82, v142
    v_fmac_f32_dpp v83, v80, v166 row_ror:8 row_mask:0xf bank_mask:0xf
    v_fmac_f32_dpp v84, v81, v167 row_ror:8 row_mask:0xf bank_mask:0xf
    v_fmac_f32_dpp v85, v82, v168 row_ror:8 row_mask:0xf bank_mask:0xf
    v_pk_mul_f32 v[24:25], v[24:25], s[10:11]
    v_pk_mul_f32 v[26:27], v[26:27], s[10:11]
    v_cvt_pk_bf16_f32 v20, v24, v25
    v_cvt_pk_bf16_f32 v21, v26, v27
    buffer_store_dwordx2 v[20:21], v205, s[60:63], s13 offen offset:1024 sc1
    v_fma_f32 v80, v163, v83, v111
    v_fma_f32 v81, v164, v84, v127
    v_fma_f32 v82, v165, v85, v143
    v_fmac_f32_dpp v80, v83, v166 row_ror:8 row_mask:0xf bank_mask:0xf
    v_fmac_f32_dpp v81, v84, v167 row_ror:8 row_mask:0xf bank_mask:0xf
    v_fmac_f32_dpp v82, v85, v168 row_ror:8 row_mask:0xf bank_mask:0xf
    v_fma_f32 v83, v163, v80, v112
    v_fma_f32 v84, v164, v81, v128
    v_fma_f32 v85, v165, v82, v144
    v_fmac_f32_dpp v83, v80, v166 row_ror:8 row_mask:0xf bank_mask:0xf
    v_fmac_f32_dpp v84, v81, v167 row_ror:8 row_mask:0xf bank_mask:0xf
    v_fmac_f32_dpp v85, v82, v168 row_ror:8 row_mask:0xf bank_mask:0xf
    v_pk_mul_f32 v[28:29], v[28:29], s[10:11]
    v_pk_mul_f32 v[30:31], v[30:31], s[10:11]
    v_cvt_pk_bf16_f32 v22, v28, v29
    v_cvt_pk_bf16_f32 v23, v30, v31
    buffer_store_dwordx2 v[22:23], v205, s[60:63], s13 offen offset:1536 sc1
    v_fma_f32 v80, v163, v83, v113
    v_fma_f32 v81, v164, v84, v129
    v_fma_f32 v82, v165, v85, v145
    v_fmac_f32_dpp v80, v83, v166 row_ror:8 row_mask:0xf bank_mask:0xf
    v_fmac_f32_dpp v81, v84, v167 row_ror:8 row_mask:0xf bank_mask:0xf
    v_fmac_f32_dpp v82, v85, v168 row_ror:8 row_mask:0xf bank_mask:0xf
    v_fma_f32 v83, v163, v80, v114
    v_fma_f32 v84, v164, v81, v130
    v_fma_f32 v85, v165, v82, v146
    v_fmac_f32_dpp v83, v80, v166 row_ror:8 row_mask:0xf bank_mask:0xf
    v_fmac_f32_dpp v84, v81, v167 row_ror:8 row_mask:0xf bank_mask:0xf
    v_fmac_f32_dpp v85, v82, v168 row_ror:8 row_mask:0xf bank_mask:0xf
    v_pk_mul_f32 v[32:33], v[32:33], s[10:11]
    v_pk_mul_f32 v[34:35], v[34:35], s[10:11]
    v_cvt_pk_bf16_f32 v32, v32, v33
    v_cvt_pk_bf16_f32 v33, v34, v35
    buffer_store_dwordx2 v[32:33], v205, s[60:63], s12 offen offset:0 sc1
    v_fma_f32 v80, v163, v83, v115
    v_fma_f32 v81, v164, v84, v131
    v_fma_f32 v82, v165, v85, v147
    v_fmac_f32_dpp v80, v83, v166 row_ror:8 row_mask:0xf bank_mask:0xf
    v_fmac_f32_dpp v81, v84, v167 row_ror:8 row_mask:0xf bank_mask:0xf
    v_fmac_f32_dpp v82, v85, v168 row_ror:8 row_mask:0xf bank_mask:0xf
    v_fma_f32 v83, v163, v80, v116
    v_fma_f32 v84, v164, v81, v132
    v_fma_f32 v85, v165, v82, v148
    v_fmac_f32_dpp v83, v80, v166 row_ror:8 row_mask:0xf bank_mask:0xf
    v_fmac_f32_dpp v84, v81, v167 row_ror:8 row_mask:0xf bank_mask:0xf
    v_fmac_f32_dpp v85, v82, v168 row_ror:8 row_mask:0xf bank_mask:0xf
    v_pk_mul_f32 v[36:37], v[36:37], s[10:11]
    v_pk_mul_f32 v[38:39], v[38:39], s[10:11]
    v_cvt_pk_bf16_f32 v34, v36, v37
    v_cvt_pk_bf16_f32 v35, v38, v39
    buffer_store_dwordx2 v[34:35], v205, s[60:63], s12 offen offset:512 sc1
    v_fma_f32 v80, v163, v83, v117
    v_fma_f32 v81, v164, v84, v133
    v_fma_f32 v82, v165, v85, v149
    v_fmac_f32_dpp v80, v83, v166 row_ror:8 row_mask:0xf bank_mask:0xf
    v_fmac_f32_dpp v81, v84, v167 row_ror:8 row_mask:0xf bank_mask:0xf
    v_fmac_f32_dpp v82, v85, v168 row_ror:8 row_mask:0xf bank_mask:0xf
    v_fma_f32 v83, v163, v80, v118
    v_fma_f32 v84, v164, v81, v134
    v_fma_f32 v85, v165, v82, v150
    v_fmac_f32_dpp v83, v80, v166 row_ror:8 row_mask:0xf bank_mask:0xf
    v_fmac_f32_dpp v84, v81, v167 row_ror:8 row_mask:0xf bank_mask:0xf
    v_fmac_f32_dpp v85, v82, v168 row_ror:8 row_mask:0xf bank_mask:0xf
    v_pk_mul_f32 v[40:41], v[40:41], s[10:11]
    v_pk_mul_f32 v[42:43], v[42:43], s[10:11]
    v_cvt_pk_bf16_f32 v36, v40, v41
    v_cvt_pk_bf16_f32 v37, v42, v43
    buffer_store_dwordx2 v[36:37], v205, s[60:63], s12 offen offset:1024 sc1
    v_fma_f32 v80, v163, v83, v119
    v_fma_f32 v81, v164, v84, v135
    v_fma_f32 v82, v165, v85, v151
    v_fmac_f32_dpp v80, v83, v166 row_ror:8 row_mask:0xf bank_mask:0xf
    v_fmac_f32_dpp v81, v84, v167 row_ror:8 row_mask:0xf bank_mask:0xf
    v_fmac_f32_dpp v82, v85, v168 row_ror:8 row_mask:0xf bank_mask:0xf
    v_fma_f32 v83, v163, v80, v120
    v_fma_f32 v84, v164, v81, v136
    v_fma_f32 v85, v165, v82, v152
    v_fmac_f32_dpp v83, v80, v166 row_ror:8 row_mask:0xf bank_mask:0xf
    v_fmac_f32_dpp v84, v81, v167 row_ror:8 row_mask:0xf bank_mask:0xf
    v_fmac_f32_dpp v85, v82, v168 row_ror:8 row_mask:0xf bank_mask:0xf
    v_pk_mul_f32 v[44:45], v[44:45], s[10:11]
    v_pk_mul_f32 v[46:47], v[46:47], s[10:11]
    v_cvt_pk_bf16_f32 v38, v44, v45
    v_cvt_pk_bf16_f32 v39, v46, v47
    buffer_store_dwordx2 v[38:39], v205, s[60:63], s12 offen offset:1536 sc1
    v_fma_f32 v80, v163, v83, v121
    v_fma_f32 v81, v164, v84, v137
    v_fma_f32 v82, v165, v85, v153
    v_fmac_f32_dpp v80, v83, v166 row_ror:8 row_mask:0xf bank_mask:0xf
    v_fmac_f32_dpp v81, v84, v167 row_ror:8 row_mask:0xf bank_mask:0xf
    v_fmac_f32_dpp v82, v85, v168 row_ror:8 row_mask:0xf bank_mask:0xf
    v_mul_f32 v89, v172, v80
    v_mul_f32 v90, v173, v81
    v_mul_f32 v91, v174, v82
    v_fmac_f32_dpp v89, v80, v175 row_ror:8 row_mask:0xf bank_mask:0xf
    v_fmac_f32_dpp v90, v81, v176 row_ror:8 row_mask:0xf bank_mask:0xf
    v_fmac_f32_dpp v91, v82, v177 row_ror:8 row_mask:0xf bank_mask:0xf
    v_pk_mul_f32 v[48:49], v[48:49], s[10:11]
    v_pk_mul_f32 v[50:51], v[50:51], s[10:11]
    v_cvt_pk_bf16_f32 v48, v48, v49
    v_cvt_pk_bf16_f32 v49, v50, v51
    buffer_store_dwordx2 v[48:49], v205, s[60:63], s13 offen offset:2048 sc1
    v_pk_mul_f32 v[52:53], v[52:53], s[10:11]
    v_pk_mul_f32 v[54:55], v[54:55], s[10:11]
    v_cvt_pk_bf16_f32 v50, v52, v53
    v_cvt_pk_bf16_f32 v51, v54, v55
    buffer_store_dwordx2 v[50:51], v205, s[60:63], s13 offen offset:2560 sc1
    v_pk_mul_f32 v[56:57], v[56:57], s[10:11]
    v_pk_mul_f32 v[58:59], v[58:59], s[10:11]
    v_cvt_pk_bf16_f32 v52, v56, v57
    v_cvt_pk_bf16_f32 v53, v58, v59
    buffer_store_dwordx2 v[52:53], v205, s[60:63], s13 offen offset:3072 sc1
    v_pk_mul_f32 v[60:61], v[60:61], s[10:11]
    v_pk_mul_f32 v[62:63], v[62:63], s[10:11]
    v_cvt_pk_bf16_f32 v54, v60, v61
    v_cvt_pk_bf16_f32 v55, v62, v63
    buffer_store_dwordx2 v[54:55], v205, s[60:63], s13 offen offset:3584 sc1
    v_pk_mul_f32 v[64:65], v[64:65], s[10:11]
    v_pk_mul_f32 v[66:67], v[66:67], s[10:11]
    v_cvt_pk_bf16_f32 v64, v64, v65
    v_cvt_pk_bf16_f32 v65, v66, v67
    buffer_store_dwordx2 v[64:65], v205, s[60:63], s12 offen offset:2048 sc1
    v_pk_mul_f32 v[68:69], v[68:69], s[10:11]
    v_pk_mul_f32 v[70:71], v[70:71], s[10:11]
    v_cvt_pk_bf16_f32 v66, v68, v69
    v_cvt_pk_bf16_f32 v67, v70, v71
    buffer_store_dwordx2 v[66:67], v205, s[60:63], s12 offen offset:2560 sc1
    v_pk_mul_f32 v[72:73], v[72:73], s[10:11]
    v_pk_mul_f32 v[74:75], v[74:75], s[10:11]
    v_cvt_pk_bf16_f32 v68, v72, v73
    v_cvt_pk_bf16_f32 v69, v74, v75
    buffer_store_dwordx2 v[68:69], v205, s[60:63], s12 offen offset:3072 sc1
    v_pk_mul_f32 v[76:77], v[76:77], s[10:11]
    v_pk_mul_f32 v[78:79], v[78:79], s[10:11]
    v_cvt_pk_bf16_f32 v70, v76, v77
    v_cvt_pk_bf16_f32 v71, v78, v79
    buffer_store_dwordx2 v[70:71], v205, s[60:63], s12 offen offset:3584 sc1
    s_branch L_scan
L_VU:
    ds_read_b128 v[80:83], v198 offset:0
    ds_read_b128 v[84:87], v198 offset:4096
    ds_read_b64_tr_b16 v[88:89], v104 offset:0
    ds_read_b64_tr_b16 v[90:91], v104 offset:1024
    ds_read_b64_tr_b16 v[92:93], v105 offset:0
    ds_read_b64_tr_b16 v[94:95], v105 offset:1024
    ds_read_b128 v[96:99], v100
    ds_read_b128 v[154:157], v247 offset:0
    ds_read_b128 v[158:161], v247 offset:4096
    ds_read_b128 v[162:165], v247 offset:8192
L_g1_48:
    s_waitcnt lgkmcnt(4)
    v_mfma_f32_32x32x16_bf16 v[16:31], v[80:83], v[88:91], v[16:31]
    ds_read_b128 v[166:169], v199 offset:0
    ds_read_b128 v[170:173], v199 offset:4096
    ds_read_b64_tr_b16 v[174:175], v104 offset:4096
    v_mfma_f32_32x32x16_bf16 v[32:47], v[84:87], v[88:91], v[32:47]
    ds_read_b64_tr_b16 v[176:177], v104 offset:5120
    ds_read_b64_tr_b16 v[178:179], v105 offset:4096
    ds_read_b64_tr_b16 v[180:181], v105 offset:5120
    v_mfma_f32_32x32x16_bf16 v[48:63], v[80:83], v[92:95], v[48:63]
    ds_read_b128 v[182:185], v101
    ds_read_b128 v[186:189], v248 offset:0
    ds_read_b128 v[190:193], v248 offset:4096
    v_mfma_f32_32x32x16_bf16 v[64:79], v[84:87], v[92:95], v[64:79]
    ds_read_b128 v[194:197], v248 offset:8192
    s_waitcnt lgkmcnt(10)
    v_mfma_f32_32x32x16_bf16 v[106:121], v[96:99], v[154:157], v[106:121]
    v_mfma_f32_32x32x16_bf16 v[122:137], v[96:99], v[158:161], v[122:137]
    v_mfma_f32_32x32x16_bf16 v[138:153], v[96:99], v[162:165], v[138:153]
    s_waitcnt lgkmcnt(4)
    v_mfma_f32_32x32x16_bf16 v[16:31], v[166:169], v[174:177], v[16:31]
    ds_read_b128 v[80:83], v200 offset:0
    ds_read_b128 v[84:87], v200 offset:4096
    ds_read_b64_tr_b16 v[88:89], v104 offset:8192
    v_mfma_f32_32x32x16_bf16 v[32:47], v[170:173], v[174:177], v[32:47]
    ds_read_b64_tr_b16 v[90:91], v104 offset:9216
    ds_read_b64_tr_b16 v[92:93], v105 offset:8192
    ds_read_b64_tr_b16 v[94:95], v105 offset:9216
    v_mfma_f32_32x32x16_bf16 v[48:63], v[166:169], v[178:181], v[48:63]
    ds_read_b128 v[96:99], v102
    ds_read_b128 v[154:157], v249 offset:0
    ds_read_b128 v[158:161], v249 offset:4096
    v_mfma_f32_32x32x16_bf16 v[64:79], v[170:173], v[178:181], v[64:79]
    ds_read_b128 v[162:165], v249 offset:8192
    s_waitcnt lgkmcnt(10)
    v_mfma_f32_32x32x16_bf16 v[106:121], v[182:185], v[186:189], v[106:121]
    v_mfma_f32_32x32x16_bf16 v[122:137], v[182:185], v[190:193], v[122:137]
    v_mfma_f32_32x32x16_bf16 v[138:153], v[182:185], v[194:197], v[138:153]
    s_mov_b32 s14, 45056
    s_cmp_eq_u32 s85, 90112
    s_cselect_b32 s14, 4294877184, s14
    s_waitcnt lgkmcnt(4)
    v_mfma_f32_32x32x16_bf16 v[16:31], v[80:83], v[88:91], v[16:31]
    ds_read_b128 v[166:169], v201 offset:0
    ds_read_b128 v[170:173], v201 offset:4096
    ds_read_b64_tr_b16 v[174:175], v104 offset:12288
    v_mfma_f32_32x32x16_bf16 v[32:47], v[84:87], v[88:91], v[32:47]
    ds_read_b64_tr_b16 v[176:177], v104 offset:13312
    ds_read_b64_tr_b16 v[178:179], v105 offset:12288
    ds_read_b64_tr_b16 v[180:181], v105 offset:13312
    v_mfma_f32_32x32x16_bf16 v[48:63], v[80:83], v[92:95], v[48:63]
    ds_read_b128 v[182:185], v103
    ds_read_b128 v[186:189], v250 offset:0
    ds_read_b128 v[190:193], v250 offset:4096
    v_mfma_f32_32x32x16_bf16 v[64:79], v[84:87], v[92:95], v[64:79]
    ds_read_b128 v[194:197], v250 offset:8192
    v_add_u32 v198, s14, v198
    v_add_u32 v199, s14, v199
    v_add_u32 v200, s14, v200
    v_add_u32 v201, s14, v201
    v_add_u32 v104, s14, v104
    s_waitcnt lgkmcnt(10)
    v_mfma_f32_32x32x16_bf16 v[106:121], v[96:99], v[154:157], v[106:121]
    v_add_u32 v105, s14, v105
    v_add_u32 v100, s14, v100
    v_add_u32 v101, s14, v101
    v_add_u32 v102, s14, v102
    v_add_u32 v103, s14, v103
    v_mfma_f32_32x32x16_bf16 v[122:137], v[96:99], v[158:161], v[122:137]
    v_add_u32 v247, s14, v247
    v_add_u32 v248, s14, v248
    v_add_u32 v249, s14, v249
    v_add_u32 v250, s14, v250
    v_mfma_f32_32x32x16_bf16 v[138:153], v[96:99], v[162:165], v[138:153]
    s_waitcnt lgkmcnt(0)
    s_barrier
    v_mfma_f32_32x32x16_bf16 v[16:31], v[166:169], v[174:177], v[16:31]
    s_cmp_eq_u32 s82, 8
    s_cbranch_scc1 L_g1x_49
    s_add_u32 s85, s85, s14
    s_add_u32 s82, s82, 1
    ds_read_b128 v[80:83], v198 offset:0
    ds_read_b128 v[84:87], v198 offset:4096
    ds_read_b64_tr_b16 v[88:89], v104 offset:0
    v_mfma_f32_32x32x16_bf16 v[32:47], v[170:173], v[174:177], v[32:47]
    ds_read_b64_tr_b16 v[90:91], v104 offset:1024
    ds_read_b64_tr_b16 v[92:93], v105 offset:0
    ds_read_b64_tr_b16 v[94:95], v105 offset:1024
    v_mfma_f32_32x32x16_bf16 v[48:63], v[166:169], v[178:181], v[48:63]
    ds_read_b128 v[96:99], v100
    ds_read_b128 v[154:157], v247 offset:0
    ds_read_b128 v[158:161], v247 offset:4096
    v_mfma_f32_32x32x16_bf16 v[64:79], v[170:173], v[178:181], v[64:79]
    ds_read_b128 v[162:165], v247 offset:8192
    v_mfma_f32_32x32x16_bf16 v[106:121], v[182:185], v[186:189], v[106:121]
    v_mfma_f32_32x32x16_bf16 v[122:137], v[182:185], v[190:193], v[122:137]
    v_mfma_f32_32x32x16_bf16 v[138:153], v[182:185], v[194:197], v[138:153]
    s_branch L_g1_48
L_g1x_49:
    v_mfma_f32_32x32x16_bf16 v[32:47], v[170:173], v[174:177], v[32:47]
    v_mfma_f32_32x32x16_bf16 v[48:63], v[166:169], v[178:181], v[48:63]
    v_mfma_f32_32x32x16_bf16 v[64:79], v[170:173], v[178:181], v[64:79]
    v_mfma_f32_32x32x16_bf16 v[106:121], v[182:185], v[186:189], v[106:121]
    v_mfma_f32_32x32x16_bf16 v[122:137], v[182:185], v[190:193], v[122:137]
    v_mfma_f32_32x32x16_bf16 v[138:153], v[182:185], v[194:197], v[138:153]
    s_mul_i32 s10, s4, 7168
    s_add_u32 s10, s10, 135168
    v_add_u32 v13, s10, v221
    ds_read_b128 v[162:165], v13 offset:0
    ds_read_b128 v[166:169], v13 offset:1024
    ds_read_b128 v[170:173], v13 offset:2048
    ds_read_b128 v[174:177], v13 offset:3072
    ds_read_b128 v[178:181], v13 offset:4096
    ds_read_b128 v[182:185], v13 offset:5120
    ds_read_b128 v[186:189], v13 offset:6144
    s_lshl_b32 s12, s5, 1
    s_add_u32 s12, s12, s80
    s_mul_i32 s12, s12, 73728
    s_lshl_b32 s13, s15, 10
    s_add_u32 s13, s13, 7321600
    s_add_u32 s13, s13, s12
    v_mul_u32_u24 v12, 9216, v3
    v_lshl_add_u32 v12, v2, 4, v12
    s_add_u32 s12, s13, 0
    v_cvt_pk_bf16_f32 v16, v16, v17
    v_cvt_pk_bf16_f32 v17, v18, v19
    v_cvt_pk_bf16_f32 v18, v20, v21
    v_cvt_pk_bf16_f32 v19, v22, v23
    buffer_store_dwordx4 v[16:19], v12, s[60:63], s12 offen offset:0 sc1
    s_waitcnt lgkmcnt(0)
    v_fma_f32 v80, v163, v106, v107
    v_fma_f32 v81, v164, v122, v123
    v_fma_f32 v82, v165, v138, v139
    v_fmac_f32_dpp v80, v106, v166 row_ror:8 row_mask:0xf bank_mask:0xf
    v_fmac_f32_dpp v81, v122, v167 row_ror:8 row_mask:0xf bank_mask:0xf
    v_fmac_f32_dpp v82, v138, v168 row_ror:8 row_mask:0xf bank_mask:0xf
    v_fma_f32 v83, v163, v80, v108
    v_fma_f32 v84, v164, v81, v124
    v_fma_f32 v85, v165, v82, v140
    v_fmac_f32_dpp v83, v80, v166 row_ror:8 row_mask:0xf bank_mask:0xf
    v_fmac_f32_dpp v84, v81, v167 row_ror:8 row_mask:0xf bank_mask:0xf
    v_fmac_f32_dpp v85, v82, v168 row_ror:8 row_mask:0xf bank_mask:0xf
    v_fma_f32 v80, v163, v83, v109
    v_fma_f32 v81, v164, v84, v125
    v_fma_f32 v82, v165, v85, v141
    v_fmac_f32_dpp v80, v83, v166 row_ror:8 row_mask:0xf bank_mask:0xf
    v_fmac_f32_dpp v81, v84, v167 row_ror:8 row_mask:0xf bank_mask:0xf
    v_fmac_f32_dpp v82, v85, v168 row_ror:8 row_mask:0xf bank_mask:0xf
    s_add_u32 s12, s13, 18432
    v_cvt_pk_bf16_f32 v20, v24, v25
    v_cvt_pk_bf16_f32 v21, v26, v27
    v_cvt_pk_bf16_f32 v22, v28, v29
    v_cvt_pk_bf16_f32 v23, v30, v31
    buffer_store_dwordx4 v[20:23], v12, s[60:63], s12 offen offset:0 sc1
    v_fma_f32 v83, v163, v80, v110
    v_fma_f32 v84, v164, v81, v126
    v_fma_f32 v85, v165, v82, v142
    v_fmac_f32_dpp v83, v80, v166 row_ror:8 row_mask:0xf bank_mask:0xf
    v_fmac_f32_dpp v84, v81, v167 row_ror:8 row_mask:0xf bank_mask:0xf
    v_fmac_f32_dpp v85, v82, v168 row_ror:8 row_mask:0xf bank_mask:0xf
    v_fma_f32 v80, v163, v83, v111
    v_fma_f32 v81, v164, v84, v127
    v_fma_f32 v82, v165, v85, v143
    v_fmac_f32_dpp v80, v83, v166 row_ror:8 row_mask:0xf bank_mask:0xf
    v_fmac_f32_dpp v81, v84, v167 row_ror:8 row_mask:0xf bank_mask:0xf
    v_fmac_f32_dpp v82, v85, v168 row_ror:8 row_mask:0xf bank_mask:0xf
    v_fma_f32 v83, v163, v80, v112
    v_fma_f32 v84, v164, v81, v128
    v_fma_f32 v85, v165, v82, v144
    v_fmac_f32_dpp v83, v80, v166 row_ror:8 row_mask:0xf bank_mask:0xf
    v_fmac_f32_dpp v84, v81, v167 row_ror:8 row_mask:0xf bank_mask:0xf
    v_fmac_f32_dpp v85, v82, v168 row_ror:8 row_mask:0xf bank_mask:0xf
    s_add_u32 s12, s13, 36864
    v_cvt_pk_bf16_f32 v32, v32, v33
    v_cvt_pk_bf16_f32 v33, v34, v35
    v_cvt_pk_bf16_f32 v34, v36, v37
    v_cvt_pk_bf16_f32 v35, v38, v39
    buffer_store_dwordx4 v[32:35], v12, s[60:63], s12 offen offset:0 sc1
    v_fma_f32 v80, v163, v83, v113
    v_fma_f32 v81, v164, v84, v129
    v_fma_f32 v82, v165, v85, v145
    v_fmac_f32_dpp v80, v83, v166 row_ror:8 row_mask:0xf bank_mask:0xf
    v_fmac_f32_dpp v81, v84, v167 row_ror:8 row_mask:0xf bank_mask:0xf
    v_fmac_f32_dpp v82, v85, v168 row_ror:8 row_mask:0xf bank_mask:0xf
    v_fma_f32 v83, v163, v80, v114
    v_fma_f32 v84, v164, v81, v130
    v_fma_f32 v85, v165, v82, v146
    v_fmac_f32_dpp v83, v80, v166 row_ror:8 row_mask:0xf bank_mask:0xf
    v_fmac_f32_dpp v84, v81, v167 row_ror:8 row_mask:0xf bank_mask:0xf
    v_fmac_f32_dpp v85, v82, v168 row_ror:8 row_mask:0xf bank_mask:0xf
    v_fma_f32 v80, v163, v83, v115
    v_fma_f32 v81, v164, v84, v131
    v_fma_f32 v82, v165, v85, v147
    v_fmac_f32_dpp v80, v83, v166 row_ror:8 row_mask:0xf bank_mask:0xf
    v_fmac_f32_dpp v81, v84, v167 row_ror:8 row_mask:0xf bank_mask:0xf
    v_fmac_f32_dpp v82, v85, v168 row_ror:8 row_mask:0xf bank_mask:0xf
    s_add_u32 s12, s13, 55296
    v_cvt_pk_bf16_f32 v36, v40, v41
    v_cvt_pk_bf16_f32 v37, v42, v43
    v_cvt_pk_bf16_f32 v38, v44, v45
    v_cvt_pk_bf16_f32 v39, v46, v47
    buffer_store_dwordx4 v[36:39], v12, s[60:63], s12 offen offset:0 sc1
    v_fma_f32 v83, v163, v80, v116
    v_fma_f32 v84, v164, v81, v132
    v_fma_f32 v85, v165, v82, v148
    v_fmac_f32_dpp v83, v80, v166 row_ror:8 row_mask:0xf bank_mask:0xf
    v_fmac_f32_dpp v84, v81, v167 row_ror:8 row_mask:0xf bank_mask:0xf
    v_fmac_f32_dpp v85, v82, v168 row_ror:8 row_mask:0xf bank_mask:0xf
    v_fma_f32 v80, v163, v83, v117
    v_fma_f32 v81, v164, v84, v133
    v_fma_f32 v82, v165, v85, v149
    v_fmac_f32_dpp v80, v83, v166 row_ror:8 row_mask:0xf bank_mask:0xf
    v_fmac_f32_dpp v81, v84, v167 row_ror:8 row_mask:0xf bank_mask:0xf
    v_fmac_f32_dpp v82, v85, v168 row_ror:8 row_mask:0xf bank_mask:0xf
    v_fma_f32 v83, v163, v80, v118
    v_fma_f32 v84, v164, v81, v134
    v_fma_f32 v85, v165, v82, v150
    v_fmac_f32_dpp v83, v80, v166 row_ror:8 row_mask:0xf bank_mask:0xf
    v_fmac_f32_dpp v84, v81, v167 row_ror:8 row_mask:0xf bank_mask:0xf
    v_fmac_f32_dpp v85, v82, v168 row_ror:8 row_mask:0xf bank_mask:0xf
    s_add_u32 s12, s13, 0
    v_cvt_pk_bf16_f32 v48, v48, v49
    v_cvt_pk_bf16_f32 v49, v50, v51
    v_cvt_pk_bf16_f32 v50, v52, v53
    v_cvt_pk_bf16_f32 v51, v54, v55
    buffer_store_dwordx4 v[48:51], v12, s[60:63], s12 offen offset:512 sc1
    v_fma_f32 v80, v163, v83, v119
    v_fma_f32 v81, v164, v84, v135
    v_fma_f32 v82, v165, v85, v151
    v_fmac_f32_dpp v80, v83, v166 row_ror:8 row_mask:0xf bank_mask:0xf
    v_fmac_f32_dpp v81, v84, v167 row_ror:8 row_mask:0xf bank_mask:0xf
    v_fmac_f32_dpp v82, v85, v168 row_ror:8 row_mask:0xf bank_mask:0xf
    v_fma_f32 v83, v163, v80, v120
    v_fma_f32 v84, v164, v81, v136
    v_fma_f32 v85, v165, v82, v152
    v_fmac_f32_dpp v83, v80, v166 row_ror:8 row_mask:0xf bank_mask:0xf
    v_fmac_f32_dpp v84, v81, v167 row_ror:8 row_mask:0xf bank_mask:0xf
    v_fmac_f32_dpp v85, v82, v168 row_ror:8 row_mask:0xf bank_mask:0xf
    v_fma_f32 v80, v163, v83, v121
    v_fma_f32 v81, v164, v84, v137
    v_fma_f32 v82, v165, v85, v153
    v_fmac_f32_dpp v80, v83, v166 row_ror:8 row_mask:0xf bank_mask:0xf
    v_fmac_f32_dpp v81, v84, v167 row_ror:8 row_mask:0xf bank_mask:0xf
    v_fmac_f32_dpp v82, v85, v168 row_ror:8 row_mask:0xf bank_mask:0xf
    s_add_u32 s12, s13, 18432
    v_cvt_pk_bf16_f32 v52, v56, v57
    v_cvt_pk_bf16_f32 v53, v58, v59
    v_cvt_pk_bf16_f32 v54, v60, v61
    v_cvt_pk_bf16_f32 v55, v62, v63
    buffer_store_dwordx4 v[52:55], v12, s[60:63], s12 offen offset:512 sc1
    v_mul_f32 v89, v172, v80
    v_mul_f32 v90, v173, v81
    v_mul_f32 v91, v174, v82
    v_fmac_f32_dpp v89, v80, v175 row_ror:8 row_mask:0xf bank_mask:0xf
    v_fmac_f32_dpp v90, v81, v176 row_ror:8 row_mask:0xf bank_mask:0xf
    v_fmac_f32_dpp v91, v82, v177 row_ror:8 row_mask:0xf bank_mask:0xf
    s_add_u32 s12, s13, 36864
    v_cvt_pk_bf16_f32 v64, v64, v65
    v_cvt_pk_bf16_f32 v65, v66, v67
    v_cvt_pk_bf16_f32 v66, v68, v69
    v_cvt_pk_bf16_f32 v67, v70, v71
    buffer_store_dwordx4 v[64:67], v12, s[60:63], s12 offen offset:512 sc1
    s_add_u32 s12, s13, 55296
    v_cvt_pk_bf16_f32 v68, v72, v73
    v_cvt_pk_bf16_f32 v69, v74, v75
    v_cvt_pk_bf16_f32 v70, v76, v77
    v_cvt_pk_bf16_f32 v71, v78, v79
    buffer_store_dwordx4 v[68:71], v12, s[60:63], s12 offen offset:512 sc1
    s_branch L_scan
L_U:
    ds_read_b128 v[96:99], v100
    ds_read_b128 v[154:157], v247 offset:0
    ds_read_b128 v[158:161], v247 offset:4096
    ds_read_b128 v[162:165], v247 offset:8192
L_g1_50:
    s_waitcnt lgkmcnt(0)
    v_mfma_f32_32x32x16_bf16 v[106:121], v[96:99], v[154:157], v[106:121]
    ds_read_b128 v[182:185], v101
    ds_read_b128 v[186:189], v248 offset:0
    v_mfma_f32_32x32x16_bf16 v[122:137], v[96:99], v[158:161], v[122:137]
    ds_read_b128 v[190:193], v248 offset:4096
    ds_read_b128 v[194:197], v248 offset:8192
    v_mfma_f32_32x32x16_bf16 v[138:153], v[96:99], v[162:165], v[138:153]
    s_waitcnt lgkmcnt(0)
    v_mfma_f32_32x32x16_bf16 v[106:121], v[182:185], v[186:189], v[106:121]
    ds_read_b128 v[96:99], v102
    ds_read_b128 v[154:157], v249 offset:0
    v_mfma_f32_32x32x16_bf16 v[122:137], v[182:185], v[190:193], v[122:137]
    ds_read_b128 v[158:161], v249 offset:4096
    ds_read_b128 v[162:165], v249 offset:8192
    v_mfma_f32_32x32x16_bf16 v[138:153], v[182:185], v[194:197], v[138:153]
    s_mov_b32 s14, 45056
    s_cmp_eq_u32 s85, 90112
    s_cselect_b32 s14, 4294877184, s14
    s_waitcnt lgkmcnt(0)
    v_mfma_f32_32x32x16_bf16 v[106:121], v[96:99], v[154:157], v[106:121]
    ds_read_b128 v[182:185], v103
    ds_read_b128 v[186:189], v250 offset:0
    v_mfma_f32_32x32x16_bf16 v[122:137], v[96:99], v[158:161], v[122:137]
    ds_read_b128 v[190:193], v250 offset:4096
    ds_read_b128 v[194:197], v250 offset:8192
    v_add_u32 v100, s14, v100
    v_add_u32 v101, s14, v101
    v_add_u32 v102, s14, v102
    v_add_u32 v103, s14, v103
    v_add_u32 v247, s14, v247
    v_mfma_f32_32x32x16_bf16 v[138:153], v[96:99], v[162:165], v[138:153]
    v_add_u32 v248, s14, v248
    v_add_u32 v249, s14, v249
    v_add_u32 v250, s14, v250
    s_waitcnt lgkmcnt(0)
    s_barrier
    v_mfma_f32_32x32x16_bf16 v[106:121], v[182:185], v[186:189], v[106:121]
    s_cmp_eq_u32 s82, 8
    s_cbranch_scc1 L_g1x_51
    s_add_u32 s85, s85, s14
    s_add_u32 s82, s82, 1
    ds_read_b128 v[96:99], v100
    ds_read_b128 v[154:157], v247 offset:0
    v_mfma_f32_32x32x16_bf16 v[122:137], v[182:185], v[190:193], v[122:137]
    ds_read_b128 v[158:161], v247 offset:4096
    ds_read_b128 v[162:165], v247 offset:8192
    v_mfma_f32_32x32x16_bf16 v[138:153], v[182:185], v[194:197], v[138:153]
    s_branch L_g1_50
L_g1x_51:
    v_mfma_f32_32x32x16_bf16 v[122:137], v[182:185], v[190:193], v[122:137]
    v_mfma_f32_32x32x16_bf16 v[138:153], v[182:185], v[194:197], v[138:153]
    s_mul_i32 s10, s4, 7168
    s_add_u32 s10, s10, 135168
    v_add_u32 v13, s10, v221
    ds_read_b128 v[162:165], v13 offset:0
    ds_read_b128 v[166:169], v13 offset:1024
    ds_read_b128 v[170:173], v13 offset:2048
    ds_read_b128 v[174:177], v13 offset:3072
    ds_read_b128 v[178:181], v13 offset:4096
    ds_read_b128 v[182:185], v13 offset:5120
    ds_read_b128 v[186:189], v13 offset:6144
    s_waitcnt lgkmcnt(0)
    v_fma_f32 v80, v163, v106, v107
    v_fma_f32 v81, v164, v122, v123
    v_fma_f32 v82, v165, v138, v139
    v_fmac_f32_dpp v80, v106, v166 row_ror:8 row_mask:0xf bank_mask:0xf
    v_fmac_f32_dpp v81, v122, v167 row_ror:8 row_mask:0xf bank_mask:0xf
    v_fmac_f32_dpp v82, v138, v168 row_ror:8 row_mask:0xf bank_mask:0xf
    v_fma_f32 v83, v163, v80, v108
    v_fma_f32 v84, v164, v81, v124
    v_fma_f32 v85, v165, v82, v140
    v_fmac_f32_dpp v83, v80, v166 row_ror:8 row_mask:0xf bank_mask:0xf
    v_fmac_f32_dpp v84, v81, v167 row_ror:8 row_mask:0xf bank_mask:0xf
    v_fmac_f32_dpp v85, v82, v168 row_ror:8 row_mask:0xf bank_mask:0xf
    v_fma_f32 v80, v163, v83, v109
    v_fma_f32 v81, v164, v84, v125
    v_fma_f32 v82, v165, v85, v141
    v_fmac_f32_dpp v80, v83, v166 row_ror:8 row_mask:0xf bank_mask:0xf
    v_fmac_f32_dpp v81, v84, v167 row_ror:8 row_mask:0xf bank_mask:0xf
    v_fmac_f32_dpp v82, v85, v168 row_ror:8 row_mask:0xf bank_mask:0xf
    v_fma_f32 v83, v163, v80, v110
    v_fma_f32 v84, v164, v81, v126
    v_fma_f32 v85, v165, v82, v142
    v_fmac_f32_dpp v83, v80, v166 row_ror:8 row_mask:0xf bank_mask:0xf
    v_fmac_f32_dpp v84, v81, v167 row_ror:8 row_mask:0xf bank_mask:0xf
    v_fmac_f32_dpp v85, v82, v168 row_ror:8 row_mask:0xf bank_mask:0xf
    v_fma_f32 v80, v163, v83, v111
    v_fma_f32 v81, v164, v84, v127
    v_fma_f32 v82, v165, v85, v143
    v_fmac_f32_dpp v80, v83, v166 row_ror:8 row_mask:0xf bank_mask:0xf
    v_fmac_f32_dpp v81, v84, v167 row_ror:8 row_mask:0xf bank_mask:0xf
    v_fmac_f32_dpp v82, v85, v168 row_ror:8 row_mask:0xf bank_mask:0xf
    v_fma_f32 v83, v163, v80, v112
    v_fma_f32 v84, v164, v81, v128
    v_fma_f32 v85, v165, v82, v144
    v_fmac_f32_dpp v83, v80, v166 row_ror:8 row_mask:0xf bank_mask:0xf
    v_fmac_f32_dpp v84, v81, v167 row_ror:8 row_mask:0xf bank_mask:0xf
    v_fmac_f32_dpp v85, v82, v168 row_ror:8 row_mask:0xf bank_mask:0xf
    v_fma_f32 v80, v163, v83, v113
    v_fma_f32 v81, v164, v84, v129
    v_fma_f32 v82, v165, v85, v145
    v_fmac_f32_dpp v80, v83, v166 row_ror:8 row_mask:0xf bank_mask:0xf
    v_fmac_f32_dpp v81, v84, v167 row_ror:8 row_mask:0xf bank_mask:0xf
    v_fmac_f32_dpp v82, v85, v168 row_ror:8 row_mask:0xf bank_mask:0xf
    v_fma_f32 v83, v163, v80, v114
    v_fma_f32 v84, v164, v81, v130
    v_fma_f32 v85, v165, v82, v146
    v_fmac_f32_dpp v83, v80, v166 row_ror:8 row_mask:0xf bank_mask:0xf
    v_fmac_f32_dpp v84, v81, v167 row_ror:8 row_mask:0xf bank_mask:0xf
    v_fmac_f32_dpp v85, v82, v168 row_ror:8 row_mask:0xf bank_mask:0xf
    v_fma_f32 v80, v163, v83, v115
    v_fma_f32 v81, v164, v84, v131
    v_fma_f32 v82, v165, v85, v147
    v_fmac_f32_dpp v80, v83, v166 row_ror:8 row_mask:0xf bank_mask:0xf
    v_fmac_f32_dpp v81, v84, v167 row_ror:8 row_mask:0xf bank_mask:0xf
    v_fmac_f32_dpp v82, v85, v168 row_ror:8 row_mask:0xf bank_mask:0xf
    v_fma_f32 v83, v163, v80, v116
    v_fma_f32 v84, v164, v81, v132
    v_fma_f32 v85, v165, v82, v148
    v_fmac_f32_dpp v83, v80, v166 row_ror:8 row_mask:0xf bank_mask:0xf
    v_fmac_f32_dpp v84, v81, v167 row_ror:8 row_mask:0xf bank_mask:0xf
    v_fmac_f32_dpp v85, v82, v168 row_ror:8 row_mask:0xf bank_mask:0xf
    v_fma_f32 v80, v163, v83, v117
    v_fma_f32 v81, v164, v84, v133
    v_fma_f32 v82, v165, v85, v149
    v_fmac_f32_dpp v80, v83, v166 row_ror:8 row_mask:0xf bank_mask:0xf
    v_fmac_f32_dpp v81, v84, v167 row_ror:8 row_mask:0xf bank_mask:0xf
    v_fmac_f32_dpp v82, v85, v168 row_ror:8 row_mask:0xf bank_mask:0xf
    v_fma_f32 v83, v163, v80, v118
    v_fma_f32 v84, v164, v81, v134
    v_fma_f32 v85, v165, v82, v150
    v_fmac_f32_dpp v83, v80, v166 row_ror:8 row_mask:0xf bank_mask:0xf
    v_fmac_f32_dpp v84, v81, v167 row_ror:8 row_mask:0xf bank_mask:0xf
    v_fmac_f32_dpp v85, v82, v168 row_ror:8 row_mask:0xf bank_mask:0xf
    v_fma_f32 v80, v163, v83, v119
    v_fma_f32 v81, v164, v84, v135
    v_fma_f32 v82, v165, v85, v151
    v_fmac_f32_dpp v80, v83, v166 row_ror:8 row_mask:0xf bank_mask:0xf
    v_fmac_f32_dpp v81, v84, v167 row_ror:8 row_mask:0xf bank_mask:0xf
    v_fmac_f32_dpp v82, v85, v168 row_ror:8 row_mask:0xf bank_mask:0xf
    v_fma_f32 v83, v163, v80, v120
    v_fma_f32 v84, v164, v81, v136
    v_fma_f32 v85, v165, v82, v152
    v_fmac_f32_dpp v83, v80, v166 row_ror:8 row_mask:0xf bank_mask:0xf
    v_fmac_f32_dpp v84, v81, v167 row_ror:8 row_mask:0xf bank_mask:0xf
    v_fmac_f32_dpp v85, v82, v168 row_ror:8 row_mask:0xf bank_mask:0xf
    v_fma_f32 v80, v163, v83, v121
    v_fma_f32 v81, v164, v84, v137
    v_fma_f32 v82, v165, v85, v153
    v_fmac_f32_dpp v80, v83, v166 row_ror:8 row_mask:0xf bank_mask:0xf
    v_fmac_f32_dpp v81, v84, v167 row_ror:8 row_mask:0xf bank_mask:0xf
    v_fmac_f32_dpp v82, v85, v168 row_ror:8 row_mask:0xf bank_mask:0xf
    v_mul_f32 v89, v172, v80
    v_mul_f32 v90, v173, v81
    v_mul_f32 v91, v174, v82
    v_fmac_f32_dpp v89, v80, v175 row_ror:8 row_mask:0xf bank_mask:0xf
    v_fmac_f32_dpp v90, v81, v176 row_ror:8 row_mask:0xf bank_mask:0xf
    v_fmac_f32_dpp v91, v82, v177 row_ror:8 row_mask:0xf bank_mask:0xf
L_scan:
    s_lshl_b32 s10, s4, 1
    v_add_u32 v92, s10, v3
    v_mul_u32_u24 v12, 384, v92
    v_lshl_add_u32 v12, v2, 2, v12
    v_add_u32 v93, 65536, v12
    ds_write_b32 v93, v89 offset:2688
    ds_write_b32 v93, v90 offset:2816
    ds_write_b32 v93, v91 offset:2944
    s_waitcnt lgkmcnt(0)
    s_barrier
    ds_read_b32 v16, v93 offset:0
    ds_read_b32 v17, v93 offset:128
    ds_read_b32 v18, v93 offset:256
    ds_read_b32 v19, v93 offset:384
    ds_read_b32 v20, v93 offset:512
    ds_read_b32 v21, v93 offset:640
    ds_read_b32 v22, v93 offset:768
    ds_read_b32 v23, v93 offset:896
    ds_read_b32 v24, v93 offset:1024
    ds_read_b32 v25, v93 offset:1152
    ds_read_b32 v26, v93 offset:1280
    ds_read_b32 v27, v93 offset:1408
    ds_read_b32 v28, v93 offset:1536
    ds_read_b32 v29, v93 offset:1664
    ds_read_b32 v30, v93 offset:1792
    ds_read_b32 v31, v93 offset:1920
    ds_read_b32 v32, v93 offset:2048
    ds_read_b32 v33, v93 offset:2176
    ds_read_b32 v34, v93 offset:2304
    ds_read_b32 v35, v93 offset:2432
    ds_read_b32 v36, v93 offset:2560
    s_lshl_b32 s11, s84, 4
    s_add_u32 s11, s11, s5
    s_lshl_b32 s12, s11, 9
    s_add_u32 s12, s12, 131072
    v_lshl_add_u32 v14, v2, 4, s12
    v_mov_b32 v7, s99
    v_cmp_eq_u32 vcc, 7, v92
    v_mov_b32 v11, s9
    s_waitcnt lgkmcnt(15)
    v_cndmask_b32 v14, v7, v14, vcc
    v_fma_f32 v80, v178, v16, v19
    v_fma_f32 v81, v179, v17, v20
    v_fma_f32 v82, v180, v18, v21
    v_fmac_f32_dpp v80, v16, v181 row_ror:8 row_mask:0xf bank_mask:0xf
    v_fmac_f32_dpp v81, v17, v182 row_ror:8 row_mask:0xf bank_mask:0xf
    v_fmac_f32_dpp v82, v18, v183 row_ror:8 row_mask:0xf bank_mask:0xf
    s_waitcnt lgkmcnt(12)
    v_fma_f32 v83, v178, v80, v22
    v_fma_f32 v84, v179, v81, v23
    v_fma_f32 v85, v180, v82, v24
    v_fmac_f32_dpp v83, v80, v181 row_ror:8 row_mask:0xf bank_mask:0xf
    v_fmac_f32_dpp v84, v81, v182 row_ror:8 row_mask:0xf bank_mask:0xf
    v_fmac_f32_dpp v85, v82, v183 row_ror:8 row_mask:0xf bank_mask:0xf
    s_waitcnt lgkmcnt(9)
    v_fma_f32 v80, v178, v83, v25
    v_fma_f32 v81, v179, v84, v26
    v_fma_f32 v82, v180, v85, v27
    v_fmac_f32_dpp v80, v83, v181 row_ror:8 row_mask:0xf bank_mask:0xf
    v_fmac_f32_dpp v81, v84, v182 row_ror:8 row_mask:0xf bank_mask:0xf
    v_fmac_f32_dpp v82, v85, v183 row_ror:8 row_mask:0xf bank_mask:0xf
    s_waitcnt lgkmcnt(6)
    v_fma_f32 v83, v178, v80, v28
    v_fma_f32 v84, v179, v81, v29
    v_fma_f32 v85, v180, v82, v30
    v_fmac_f32_dpp v83, v80, v181 row_ror:8 row_mask:0xf bank_mask:0xf
    v_fmac_f32_dpp v84, v81, v182 row_ror:8 row_mask:0xf bank_mask:0xf
    v_fmac_f32_dpp v85, v82, v183 row_ror:8 row_mask:0xf bank_mask:0xf
    s_waitcnt lgkmcnt(3)
    v_fma_f32 v80, v178, v83, v31
    v_fma_f32 v81, v179, v84, v32
    v_fma_f32 v82, v180, v85, v33
    v_fmac_f32_dpp v80, v83, v181 row_ror:8 row_mask:0xf bank_mask:0xf
    v_fmac_f32_dpp v81, v84, v182 row_ror:8 row_mask:0xf bank_mask:0xf
    v_fmac_f32_dpp v82, v85, v183 row_ror:8 row_mask:0xf bank_mask:0xf
    s_waitcnt lgkmcnt(0)
    v_fma_f32 v86, v178, v80, v34
    v_fma_f32 v87, v179, v81, v35
    v_fma_f32 v88, v180, v82, v36
    v_fmac_f32_dpp v86, v80, v181 row_ror:8 row_mask:0xf bank_mask:0xf
    v_fmac_f32_dpp v87, v81, v182 row_ror:8 row_mask:0xf bank_mask:0xf
    v_fmac_f32_dpp v88, v82, v183 row_ror:8 row_mask:0xf bank_mask:0xf
    v_fma_f32 v8, v178, v86, v89
    v_fma_f32 v9, v179, v87, v90
    v_fma_f32 v10, v180, v88, v91
    v_fmac_f32_dpp v8, v86, v181 row_ror:8 row_mask:0xf bank_mask:0xf
    v_fmac_f32_dpp v9, v87, v182 row_ror:8 row_mask:0xf bank_mask:0xf
    v_fmac_f32_dpp v10, v88, v183 row_ror:8 row_mask:0xf bank_mask:0xf
    buffer_store_dwordx4 v[8:11], v14, s[60:63], 0 offen sc1
    v_mov_b32 v4, 75776
    v_mov_b32 v5, 1
    s_waitcnt vmcnt(1)
    s_mov_b64 exec, 1
    ds_add_rtn_u32 v6, v4, v5
    s_mov_b64 exec, -1
    s_waitcnt lgkmcnt(0)
    v_readfirstlane_b32 s10, v6
    s_nop 0
    s_cmp_lg_u32 s10, 3
    s_cbranch_scc1 L_nf_52
    s_lshl_b32 s10, s6, 4
    s_add_u32 s10, s10, s5
    s_lshl_b32 s10, s10, 7
    s_add_u32 s10, s10, 4096
    s_bitcmp1_b32 s90, 0
    s_cselect_b32 s10, s10, s99
    v_mov_b32 v4, s10
    v_mov_b32 v5, s9
    s_mov_b64 exec, 1
    buffer_store_dword v5, v4, s[60:63], 0 offen sc1
    s_mov_b64 exec, -1
L_nf_52:
    v_mul_f32_dpp v4, v106, v175 row_ror:8 row_mask:0xf bank_mask:0xf
    v_mul_f32_dpp v5, v122, v176 row_ror:8 row_mask:0xf bank_mask:0xf
    v_mul_f32_dpp v6, v138, v177 row_ror:8 row_mask:0xf bank_mask:0xf
    v_fma_f32 v106, v172, v106, v4
    v_fma_f32 v122, v173, v122, v5
    v_fma_f32 v138, v174, v138, v6
    v_mul_f32_dpp v7, v107, v175 row_ror:8 row_mask:0xf bank_mask:0xf
    v_mul_f32_dpp v8, v123, v176 row_ror:8 row_mask:0xf bank_mask:0xf
    v_mul_f32_dpp v9, v139, v177 row_ror:8 row_mask:0xf bank_mask:0xf
    v_fma_f32 v107, v172, v107, v7
    v_fma_f32 v123, v173, v123, v8
    v_fma_f32 v139, v174, v139, v9
    v_mul_f32_dpp v4, v108, v175 row_ror:8 row_mask:0xf bank_mask:0xf
    v_mul_f32_dpp v5, v124, v176 row_ror:8 row_mask:0xf bank_mask:0xf
    v_mul_f32_dpp v6, v140, v177 row_ror:8 row_mask:0xf bank_mask:0xf
    v_fma_f32 v108, v172, v108, v4
    v_fma_f32 v124, v173, v124, v5
    v_fma_f32 v140, v174, v140, v6
    v_mul_f32_dpp v7, v109, v175 row_ror:8 row_mask:0xf bank_mask:0xf
    v_mul_f32_dpp v8, v125, v176 row_ror:8 row_mask:0xf bank_mask:0xf
    v_mul_f32_dpp v9, v141, v177 row_ror:8 row_mask:0xf bank_mask:0xf
    v_fma_f32 v109, v172, v109, v7
    v_fma_f32 v125, v173, v125, v8
    v_fma_f32 v141, v174, v141, v9
    v_mul_f32_dpp v4, v110, v175 row_ror:8 row_mask:0xf bank_mask:0xf
    v_mul_f32_dpp v5, v126, v176 row_ror:8 row_mask:0xf bank_mask:0xf
    v_mul_f32_dpp v6, v142, v177 row_ror:8 row_mask:0xf bank_mask:0xf
    v_fma_f32 v110, v172, v110, v4
    v_fma_f32 v126, v173, v126, v5
    v_fma_f32 v142, v174, v142, v6
    v_mul_f32_dpp v7, v111, v175 row_ror:8 row_mask:0xf bank_mask:0xf
    v_mul_f32_dpp v8, v127, v176 row_ror:8 row_mask:0xf bank_mask:0xf
    v_mul_f32_dpp v9, v143, v177 row_ror:8 row_mask:0xf bank_mask:0xf
    v_fma_f32 v111, v172, v111, v7
    v_fma_f32 v127, v173, v127, v8
    v_fma_f32 v143, v174, v143, v9
    v_mul_f32_dpp v4, v112, v175 row_ror:8 row_mask:0xf bank_mask:0xf
    v_mul_f32_dpp v5, v128, v176 row_ror:8 row_mask:0xf bank_mask:0xf
    v_mul_f32_dpp v6, v144, v177 row_ror:8 row_mask:0xf bank_mask:0xf
    v_fma_f32 v112, v172, v112, v4
    v_fma_f32 v128, v173, v128, v5
    v_fma_f32 v144, v174, v144, v6
    v_mul_f32_dpp v7, v113, v175 row_ror:8 row_mask:0xf bank_mask:0xf
    v_mul_f32_dpp v8, v129, v176 row_ror:8 row_mask:0xf bank_mask:0xf
    v_mul_f32_dpp v9, v145, v177 row_ror:8 row_mask:0xf bank_mask:0xf
    v_fma_f32 v113, v172, v113, v7
    v_fma_f32 v129, v173, v129, v8
    v_fma_f32 v145, v174, v145, v9
    v_mul_f32_dpp v4, v114, v175 row_ror:8 row_mask:0xf bank_mask:0xf
    v_mul_f32_dpp v5, v130, v176 row_ror:8 row_mask:0xf bank_mask:0xf
    v_mul_f32_dpp v6, v146, v177 row_ror:8 row_mask:0xf bank_mask:0xf
    v_fma_f32 v114, v172, v114, v4
    v_fma_f32 v130, v173, v130, v5
    v_fma_f32 v146, v174, v146, v6
    v_mul_f32_dpp v7, v115, v175 row_ror:8 row_mask:0xf bank_mask:0xf
    v_mul_f32_dpp v8, v131, v176 row_ror:8 row_mask:0xf bank_mask:0xf
    v_mul_f32_dpp v9, v147, v177 row_ror:8 row_mask:0xf bank_mask:0xf
    v_fma_f32 v115, v172, v115, v7
    v_fma_f32 v131, v173, v131, v8
    v_fma_f32 v147, v174, v147, v9
    v_mul_f32_dpp v4, v116, v175 row_ror:8 row_mask:0xf bank_mask:0xf
    v_mul_f32_dpp v5, v132, v176 row_ror:8 row_mask:0xf bank_mask:0xf
    v_mul_f32_dpp v6, v148, v177 row_ror:8 row_mask:0xf bank_mask:0xf
    v_fma_f32 v116, v172, v116, v4
    v_fma_f32 v132, v173, v132, v5
    v_fma_f32 v148, v174, v148, v6
    v_mul_f32_dpp v7, v117, v175 row_ror:8 row_mask:0xf bank_mask:0xf
    v_mul_f32_dpp v8, v133, v176 row_ror:8 row_mask:0xf bank_mask:0xf
    v_mul_f32_dpp v9, v149, v177 row_ror:8 row_mask:0xf bank_mask:0xf
    v_fma_f32 v117, v172, v117, v7
    v_fma_f32 v133, v173, v133, v8
    v_fma_f32 v149, v174, v149, v9
    v_mul_f32_dpp v4, v118, v175 row_ror:8 row_mask:0xf bank_mask:0xf
    v_mul_f32_dpp v5, v134, v176 row_ror:8 row_mask:0xf bank_mask:0xf
    v_mul_f32_dpp v6, v150, v177 row_ror:8 row_mask:0xf bank_mask:0xf
    v_fma_f32 v118, v172, v118, v4
    v_fma_f32 v134, v173, v134, v5
    v_fma_f32 v150, v174, v150, v6
    v_mul_f32_dpp v7, v119, v175 row_ror:8 row_mask:0xf bank_mask:0xf
    v_mul_f32_dpp v8, v135, v176 row_ror:8 row_mask:0xf bank_mask:0xf
    v_mul_f32_dpp v9, v151, v177 row_ror:8 row_mask:0xf bank_mask:0xf
    v_fma_f32 v119, v172, v119, v7
    v_fma_f32 v135, v173, v135, v8
    v_fma_f32 v151, v174, v151, v9
    v_mul_f32_dpp v4, v120, v175 row_ror:8 row_mask:0xf bank_mask:0xf
    v_mul_f32_dpp v5, v136, v176 row_ror:8 row_mask:0xf bank_mask:0xf
    v_mul_f32_dpp v6, v152, v177 row_ror:8 row_mask:0xf bank_mask:0xf
    v_fma_f32 v120, v172, v120, v4
    v_fma_f32 v136, v173, v136, v5
    v_fma_f32 v152, v174, v152, v6
    v_mul_f32_dpp v7, v121, v175 row_ror:8 row_mask:0xf bank_mask:0xf
    v_mul_f32_dpp v8, v137, v176 row_ror:8 row_mask:0xf bank_mask:0xf
    v_mul_f32_dpp v9, v153, v177 row_ror:8 row_mask:0xf bank_mask:0xf
    v_fma_f32 v121, v172, v121, v7
    v_fma_f32 v137, v173, v137, v8
    v_fma_f32 v153, v174, v153, v9
    v_lshrrev_b32 v4, 4, v0
    v_and_b32 v5, 15, v0
    s_lshl_b32 s10, s22, 3
    s_mul_i32 s14, s8, 72
    s_and_b32 s15, s4, 3
    s_lshl_b32 s15, s15, 3
    s_add_u32 s15, s15, s14
    v_add_u32 v6, 0, v4
    v_add_u32 v7, s10, v6
    v_xor_b32 v7, v7, v5
    v_add_u32 v6, s15, v6
    v_mul_u32_u24 v6, 1152, v6
    v_lshl_add_u32 v202, v7, 4, v6
    v_add_u32 v6, 4, v4
    v_add_u32 v7, s10, v6
    v_xor_b32 v7, v7, v5
    v_add_u32 v6, s15, v6
    v_mul_u32_u24 v6, 1152, v6
    v_lshl_add_u32 v203, v7, 4, v6
    s_lshl_b32 s10, s22, 2
    s_mul_i32 s14, s8, 72
    v_lshrrev_b32 v4, 4, v0
    v_and_b32 v5, 15, v0
    v_add_u32 v6, s10, v4
    v_xor_b32 v7, v6, v5
    s_add_u32 s14, s14, 64
    v_add_u32 v6, s14, v6
    v_mul_u32_u24 v6, 1152, v6
    v_lshl_add_u32 v204, v7, 4, v6
    s_bitcmp1_b32 s4, 1
    s_cselect_b32 s32, s68, s64
    s_cselect_b32 s33, s69, s65
    s_mov_b32 s34, 663552
    s_mov_b32 s35, 0x20000
    s_cselect_b32 s28, 18432, 0
    s_lshl_b32 s10, s22, 10
    s_add_u32 s28, s28, s10
    s_add_u32 s28, s28, 16384
    v_and_b32 v6, 15, v2
    v_mul_u32_u24 v7, 18432, v3
    v_lshl_add_u32 v7, v2, 8, v7
    s_lshl_b32 s10, s23, 2
    s_add_u32 s12, s10, 0
    v_xor_b32 v8, s12, v6
    v_lshl_add_u32 v247, v8, 4, v7
    s_add_u32 s12, s10, 1
    v_xor_b32 v8, s12, v6
    v_lshl_add_u32 v248, v8, 4, v7
    s_add_u32 s12, s10, 2
    v_xor_b32 v8, s12, v6
    v_lshl_add_u32 v249, v8, 4, v7
    s_add_u32 s12, s10, 3
    v_xor_b32 v8, s12, v6
    v_lshl_add_u32 v250, v8, 4, v7
    s_lshl_b32 s10, s23, 13
    s_add_u32 s12, s10, 116736
    v_add_u32 v193, s12, v235
    v_xor_b32 v194, 64, v193
    s_lshl_b32 s10, s23, 12
    s_add_u32 s10, s10, 40960
    v_add_u32 v196, s10, v235
    v_xor_b32 v197, 64, v196
    s_mov_b32 s12, 32768
    s_cmp_ge_u32 s4, 4
    s_cselect_b32 s12, s12, 57344
    s_lshl_b32 s10, s23, 11
    s_add_u32 s10, s10, s12
    v_add_u32 v199, s10, v235
    v_xor_b32 v200, 64, v199
    s_lshl_b32 s10, s23, 10
    s_add_u32 s12, s10, 149504
    v_add_u32 v195, s12, v236
    s_add_u32 s12, s10, 153600
    v_add_u32 v198, s12, v236
    s_lshl_b32 s10, s23, 8
    s_add_u32 s10, s10, 157696
    v_add_u32 v201, s10, v236
    v_lshlrev_b32 v11, 2, v2
    v_add_u32 v11, 73728, v11
    s_mul_i32 s10, s4, 7680
    s_add_u32 s10, s10, 81920
    v_mul_u32_u24 v4, 80, v2
    v_lshl_add_u32 v4, v3, 5, v4
    v_add_u32 v12, s10, v4
    v_and_b32 v6, 3, v0
    v_bfe_u32 v7, v0, 2, 2
    v_bfe_u32 v8, v0, 4, 1
    v_lshl_add_u32 v7, v3, 3, v7
    v_mul_u32_u24 v7, 80, v7
    v_lshl_add_u32 v7, v8, 5, v7
    v_lshl_add_u32 v7, v6, 3, v7
    v_add_u32 v13, s10, v7
    s_lshl_b32 s10, s5, 2
    s_add_u32 s10, s10, s4
    s_mul_i32 s10, s10, 73728
    s_mul_i32 s11, s84, 6144
    s_add_u32 s10, s10, s11
    s_add_u32 s29, s10, 10485760
    s_cmp_lg_u32 s4, 0
    s_cbranch_scc1 L_np_53
    s_mov_b32 s92, 0
L_poll_54:
    s_mov_b64 exec, s[100:101]
    buffer_load_dword v227, v222, s[60:63], 0 offen sc1
    s_mov_b64 exec, 0xff
    buffer_load_dword v228, v223, s[60:63], 0 offen sc1
    s_waitcnt vmcnt(0)
    s_mov_b64 s[10:11], 0
    s_mov_b64 exec, s[100:101]
    v_cmp_ne_u32 vcc, s9, v227
    s_nop 0
    s_or_b64 s[10:11], s[10:11], vcc
    s_mov_b64 exec, 0xff
    v_cmp_ne_u32 vcc, s9, v228
    s_nop 0
    s_or_b64 s[10:11], s[10:11], vcc
    s_mov_b64 exec, -1
    s_cmp_eq_u64 s[10:11], 0
    s_cbranch_scc1 L_pollq_55
    s_add_u32 s92, s92, 1
    s_cmp_gt_u32 s92, 20000
    s_cbranch_scc1 L_pollq_55
    s_sleep 2
    s_branch L_poll_54
L_pollq_55:
L_np_53:
    s_lshl_b32 s10, s8, 3
    s_add_u32 s10, s10, s4
    s_mul_i32 s12, s10, 36864
    s_add_u32 s12, s12, 1048576
    s_add_u32 s14, s12, s44
    s_add_u32 s15, s12, s45
    s_lshr_b32 s12, s10, 2
    s_lshl_b32 s12, s12, 10
    s_and_b32 s13, s10, 3
    s_lshl_b32 s13, s13, 7
    s_add_u32 s12, s12, s13
    s_add_u32 s12, s12, 327680
    v_lshlrev_b32 v14, 3, v2
    v_lshlrev_b32 v15, 2, v2
    s_waitcnt lgkmcnt(0)
    s_barrier
    ds_read_b32 v40, v11 offset:0
    ds_read_b32 v41, v11 offset:128
    ds_read_b32 v42, v11 offset:256
    ds_read_b32 v43, v11 offset:384
    ds_read_b32 v44, v11 offset:512
    ds_read_b32 v45, v11 offset:640
    ds_read_b32 v46, v11 offset:768
    ds_read_b32 v47, v11 offset:896
    ds_read_b32 v48, v11 offset:1024
    ds_read_b32 v49, v11 offset:1152
    ds_read_b32 v50, v11 offset:1280
    ds_read_b32 v51, v11 offset:1408
    buffer_load_dwordx2 v[96:97], v205, s[60:63], s14 offen sc1
    buffer_load_dwordx2 v[98:99], v205, s[60:63], s14 offen offset:512 sc1
    buffer_load_dwordx2 v[100:101], v14, s[60:63], s15 offen sc1
    buffer_load_dword v104, v15, s[60:63], s12 offen sc1
    s_waitcnt lgkmcnt(0)
    v_add_f32 v40, v40, v46
    v_add_f32 v41, v41, v47
    v_add_f32 v42, v42, v48
    v_add_f32 v43, v43, v49
    v_add_f32 v44, v44, v50
    v_add_f32 v45, v45, v51
    v_add_f32 v40, v40, v43
    v_add_f32 v41, v41, v44
    v_add_f32 v42, v42, v45
    v_fma_f32 v83, v184, v40, v86
    v_fma_f32 v84, v185, v41, v87
    v_fma_f32 v85, v186, v42, v88
    v_fmac_f32_dpp v83, v40, v187 row_ror:8 row_mask:0xf bank_mask:0xf
    v_fmac_f32_dpp v84, v41, v188 row_ror:8 row_mask:0xf bank_mask:0xf
    v_fmac_f32_dpp v85, v42, v189 row_ror:8 row_mask:0xf bank_mask:0xf
    v_fmac_f32 v106, v163, v83
    v_fmac_f32 v122, v164, v84
    v_fmac_f32 v138, v165, v85
    v_fmac_f32_dpp v106, v83, v169 row_ror:8 row_mask:0xf bank_mask:0xf
    v_fmac_f32_dpp v122, v84, v170 row_ror:8 row_mask:0xf bank_mask:0xf
    v_fmac_f32_dpp v138, v85, v171 row_ror:8 row_mask:0xf bank_mask:0xf
    v_fmac_f32 v107, v163, v106
    v_fmac_f32 v123, v164, v122
    v_fmac_f32 v139, v165, v138
    v_fmac_f32_dpp v107, v106, v169 row_ror:8 row_mask:0xf bank_mask:0xf
    v_fmac_f32_dpp v123, v122, v170 row_ror:8 row_mask:0xf bank_mask:0xf
    v_fmac_f32_dpp v139, v138, v171 row_ror:8 row_mask:0xf bank_mask:0xf
    v_cvt_pk_bf16_f32 v16, v106, v107
    v_cvt_pk_bf16_f32 v24, v122, v123
    v_cvt_pk_bf16_f32 v32, v138, v139
    v_fmac_f32 v108, v163, v107
    v_fmac_f32 v124, v164, v123
    v_fmac_f32 v140, v165, v139
    v_fmac_f32_dpp v108, v107, v169 row_ror:8 row_mask:0xf bank_mask:0xf
    v_fmac_f32_dpp v124, v123, v170 row_ror:8 row_mask:0xf bank_mask:0xf
    v_fmac_f32_dpp v140, v139, v171 row_ror:8 row_mask:0xf bank_mask:0xf
    v_fmac_f32 v109, v163, v108
    v_fmac_f32 v125, v164, v124
    v_fmac_f32 v141, v165, v140
    v_fmac_f32_dpp v109, v108, v169 row_ror:8 row_mask:0xf bank_mask:0xf
    v_fmac_f32_dpp v125, v124, v170 row_ror:8 row_mask:0xf bank_mask:0xf
    v_fmac_f32_dpp v141, v140, v171 row_ror:8 row_mask:0xf bank_mask:0xf
    v_cvt_pk_bf16_f32 v17, v108, v109
    v_cvt_pk_bf16_f32 v25, v124, v125
    v_cvt_pk_bf16_f32 v33, v140, v141
    v_fmac_f32 v110, v163, v109
    v_fmac_f32 v126, v164, v125
    v_fmac_f32 v142, v165, v141
    v_fmac_f32_dpp v110, v109, v169 row_ror:8 row_mask:0xf bank_mask:0xf
    v_fmac_f32_dpp v126, v125, v170 row_ror:8 row_mask:0xf bank_mask:0xf
    v_fmac_f32_dpp v142, v141, v171 row_ror:8 row_mask:0xf bank_mask:0xf
    v_fmac_f32 v111, v163, v110
    v_fmac_f32 v127, v164, v126
    v_fmac_f32 v143, v165, v142
    v_fmac_f32_dpp v111, v110, v169 row_ror:8 row_mask:0xf bank_mask:0xf
    v_fmac_f32_dpp v127, v126, v170 row_ror:8 row_mask:0xf bank_mask:0xf
    v_fmac_f32_dpp v143, v142, v171 row_ror:8 row_mask:0xf bank_mask:0xf
    v_cvt_pk_bf16_f32 v18, v110, v111
    v_cvt_pk_bf16_f32 v26, v126, v127
    v_cvt_pk_bf16_f32 v34, v142, v143
    v_fmac_f32 v112, v163, v111
    v_fmac_f32 v128, v164, v127
    v_fmac_f32 v144, v165, v143
    v_fmac_f32_dpp v112, v111, v169 row_ror:8 row_mask:0xf bank_mask:0xf
    v_fmac_f32_dpp v128, v127, v170 row_ror:8 row_mask:0xf bank_mask:0xf
    v_fmac_f32_dpp v144, v143, v171 row_ror:8 row_mask:0xf bank_mask:0xf
    v_fmac_f32 v113, v163, v112
    v_fmac_f32 v129, v164, v128
    v_fmac_f32 v145, v165, v144
    v_fmac_f32_dpp v113, v112, v169 row_ror:8 row_mask:0xf bank_mask:0xf
    v_fmac_f32_dpp v129, v128, v170 row_ror:8 row_mask:0xf bank_mask:0xf
    v_fmac_f32_dpp v145, v144, v171 row_ror:8 row_mask:0xf bank_mask:0xf
    v_cvt_pk_bf16_f32 v19, v112, v113
    v_cvt_pk_bf16_f32 v27, v128, v129
    v_cvt_pk_bf16_f32 v35, v144, v145
    ds_write_b128 v12, v[16:19] offset:0
    ds_write_b128 v12, v[24:27] offset:2560
    ds_write_b128 v12, v[32:35] offset:5120
    v_fmac_f32 v114, v163, v113
    v_fmac_f32 v130, v164, v129
    v_fmac_f32 v146, v165, v145
    v_fmac_f32_dpp v114, v113, v169 row_ror:8 row_mask:0xf bank_mask:0xf
    v_fmac_f32_dpp v130, v129, v170 row_ror:8 row_mask:0xf bank_mask:0xf
    v_fmac_f32_dpp v146, v145, v171 row_ror:8 row_mask:0xf bank_mask:0xf
    v_fmac_f32 v115, v163, v114
    v_fmac_f32 v131, v164, v130
    v_fmac_f32 v147, v165, v146
    v_fmac_f32_dpp v115, v114, v169 row_ror:8 row_mask:0xf bank_mask:0xf
    v_fmac_f32_dpp v131, v130, v170 row_ror:8 row_mask:0xf bank_mask:0xf
    v_fmac_f32_dpp v147, v146, v171 row_ror:8 row_mask:0xf bank_mask:0xf
    v_cvt_pk_bf16_f32 v20, v114, v115
    v_cvt_pk_bf16_f32 v28, v130, v131
    v_cvt_pk_bf16_f32 v36, v146, v147
    v_fmac_f32 v116, v163, v115
    v_fmac_f32 v132, v164, v131
    v_fmac_f32 v148, v165, v147
    v_fmac_f32_dpp v116, v115, v169 row_ror:8 row_mask:0xf bank_mask:0xf
    v_fmac_f32_dpp v132, v131, v170 row_ror:8 row_mask:0xf bank_mask:0xf
    v_fmac_f32_dpp v148, v147, v171 row_ror:8 row_mask:0xf bank_mask:0xf
    v_fmac_f32 v117, v163, v116
    v_fmac_f32 v133, v164, v132
    v_fmac_f32 v149, v165, v148
    v_fmac_f32_dpp v117, v116, v169 row_ror:8 row_mask:0xf bank_mask:0xf
    v_fmac_f32_dpp v133, v132, v170 row_ror:8 row_mask:0xf bank_mask:0xf
    v_fmac_f32_dpp v149, v148, v171 row_ror:8 row_mask:0xf bank_mask:0xf
    v_cvt_pk_bf16_f32 v21, v116, v117
    v_cvt_pk_bf16_f32 v29, v132, v133
    v_cvt_pk_bf16_f32 v37, v148, v149
    v_fmac_f32 v118, v163, v117
    v_fmac_f32 v134, v164, v133
    v_fmac_f32 v150, v165, v149
    v_fmac_f32_dpp v118, v117, v169 row_ror:8 row_mask:0xf bank_mask:0xf
    v_fmac_f32_dpp v134, v133, v170 row_ror:8 row_mask:0xf bank_mask:0xf
    v_fmac_f32_dpp v150, v149, v171 row_ror:8 row_mask:0xf bank_mask:0xf
    v_fmac_f32 v119, v163, v118
    v_fmac_f32 v135, v164, v134
    v_fmac_f32 v151, v165, v150
    v_fmac_f32_dpp v119, v118, v169 row_ror:8 row_mask:0xf bank_mask:0xf
    v_fmac_f32_dpp v135, v134, v170 row_ror:8 row_mask:0xf bank_mask:0xf
    v_fmac_f32_dpp v151, v150, v171 row_ror:8 row_mask:0xf bank_mask:0xf
    v_cvt_pk_bf16_f32 v22, v118, v119
    v_cvt_pk_bf16_f32 v30, v134, v135
    v_cvt_pk_bf16_f32 v38, v150, v151
    v_fmac_f32 v120, v163, v119
    v_fmac_f32 v136, v164, v135
    v_fmac_f32 v152, v165, v151
    v_fmac_f32_dpp v120, v119, v169 row_ror:8 row_mask:0xf bank_mask:0xf
    v_fmac_f32_dpp v136, v135, v170 row_ror:8 row_mask:0xf bank_mask:0xf
    v_fmac_f32_dpp v152, v151, v171 row_ror:8 row_mask:0xf bank_mask:0xf
    v_fmac_f32 v121, v163, v120
    v_fmac_f32 v137, v164, v136
    v_fmac_f32 v153, v165, v152
    v_fmac_f32_dpp v121, v120, v169 row_ror:8 row_mask:0xf bank_mask:0xf
    v_fmac_f32_dpp v137, v136, v170 row_ror:8 row_mask:0xf bank_mask:0xf
    v_fmac_f32_dpp v153, v152, v171 row_ror:8 row_mask:0xf bank_mask:0xf
    v_cvt_pk_bf16_f32 v23, v120, v121
    v_cvt_pk_bf16_f32 v31, v136, v137
    v_cvt_pk_bf16_f32 v39, v152, v153
    ds_write_b128 v12, v[20:23] offset:16
    ds_write_b128 v12, v[28:31] offset:2576
    ds_write_b128 v12, v[36:39] offset:5136
    s_waitcnt lgkmcnt(0)
    ds_read_b64_tr_b16 v[106:107], v13 offset:0
    ds_read_b64_tr_b16 v[108:109], v13 offset:320
    ds_read_b64_tr_b16 v[110:111], v13 offset:1280
    ds_read_b64_tr_b16 v[112:113], v13 offset:1600
    ds_read_b64_tr_b16 v[114:115], v13 offset:2560
    ds_read_b64_tr_b16 v[116:117], v13 offset:2880
    ds_read_b64_tr_b16 v[118:119], v13 offset:3840
    ds_read_b64_tr_b16 v[120:121], v13 offset:4160
    ds_read_b64_tr_b16 v[122:123], v13 offset:5120
    ds_read_b64_tr_b16 v[124:125], v13 offset:5440
    ds_read_b64_tr_b16 v[126:127], v13 offset:6400
    ds_read_b64_tr_b16 v[128:129], v13 offset:6720
    s_branch L_p2c
L_Aonly:
    s_cmp_eq_u32 s15, 27
    s_cbranch_scc1 L_idleA
    s_cmp_ge_u32 s6, 9
    s_cbranch_scc1 L_V
L_T:
    ds_read_b128 v[80:83], v198 offset:0
    ds_read_b128 v[84:87], v198 offset:4096
    ds_read_b64_tr_b16 v[88:89], v104 offset:0
    ds_read_b64_tr_b16 v[90:91], v104 offset:1024
    ds_read_b64_tr_b16 v[92:93], v105 offset:0
    ds_read_b64_tr_b16 v[94:95], v105 offset:1024
L_g1_56:
    s_waitcnt lgkmcnt(0)
    v_mfma_f32_32x32x16_bf16 v[16:31], v[88:91], v[80:83], v[16:31]
    ds_read_b128 v[166:169], v199 offset:0
    ds_read_b128 v[170:173], v199 offset:4096
    v_mfma_f32_32x32x16_bf16 v[32:47], v[88:91], v[84:87], v[32:47]
    ds_read_b64_tr_b16 v[174:175], v104 offset:4096
    ds_read_b64_tr_b16 v[176:177], v104 offset:5120
    v_mfma_f32_32x32x16_bf16 v[48:63], v[92:95], v[80:83], v[48:63]
    ds_read_b64_tr_b16 v[178:179], v105 offset:4096
    ds_read_b64_tr_b16 v[180:181], v105 offset:5120
    v_mfma_f32_32x32x16_bf16 v[64:79], v[92:95], v[84:87], v[64:79]
    s_waitcnt lgkmcnt(0)
    v_mfma_f32_32x32x16_bf16 v[16:31], v[174:177], v[166:169], v[16:31]
    ds_read_b128 v[80:83], v200 offset:0
    ds_read_b128 v[84:87], v200 offset:4096
    v_mfma_f32_32x32x16_bf16 v[32:47], v[174:177], v[170:173], v[32:47]
    ds_read_b64_tr_b16 v[88:89], v104 offset:8192
    ds_read_b64_tr_b16 v[90:91], v104 offset:9216
    v_mfma_f32_32x32x16_bf16 v[48:63], v[178:181], v[166:169], v[48:63]
    ds_read_b64_tr_b16 v[92:93], v105 offset:8192
    ds_read_b64_tr_b16 v[94:95], v105 offset:9216
    v_mfma_f32_32x32x16_bf16 v[64:79], v[178:181], v[170:173], v[64:79]
    s_mov_b32 s14, 45056
    s_cmp_eq_u32 s85, 90112
    s_cselect_b32 s14, 4294877184, s14
    s_waitcnt lgkmcnt(0)
    v_mfma_f32_32x32x16_bf16 v[16:31], v[88:91], v[80:83], v[16:31]
    ds_read_b128 v[166:169], v201 offset:0
    ds_read_b128 v[170:173], v201 offset:4096
    v_mfma_f32_32x32x16_bf16 v[32:47], v[88:91], v[84:87], v[32:47]
    ds_read_b64_tr_b16 v[174:175], v104 offset:12288
    ds_read_b64_tr_b16 v[176:177], v104 offset:13312
    v_mfma_f32_32x32x16_bf16 v[48:63], v[92:95], v[80:83], v[48:63]
    ds_read_b64_tr_b16 v[178:179], v105 offset:12288
    ds_read_b64_tr_b16 v[180:181], v105 offset:13312
    v_add_u32 v198, s14, v198
    v_add_u32 v199, s14, v199
    v_add_u32 v200, s14, v200
    v_add_u32 v201, s14, v201
    v_add_u32 v104, s14, v104
    v_mfma_f32_32x32x16_bf16 v[64:79], v[92:95], v[84:87], v[64:79]
    v_add_u32 v105, s14, v105
    s_waitcnt lgkmcnt(0)
    s_barrier
    v_mfma_f32_32x32x16_bf16 v[16:31], v[174:177], v[166:169], v[16:31]
    s_cmp_eq_u32 s82, 8
    s_cbranch_scc1 L_g1x_57
    s_add_u32 s85, s85, s14
    s_add_u32 s82, s82, 1
    ds_read_b128 v[80:83], v198 offset:0
    ds_read_b128 v[84:87], v198 offset:4096
    v_mfma_f32_32x32x16_bf16 v[32:47], v[174:177], v[170:173], v[32:47]
    ds_read_b64_tr_b16 v[88:89], v104 offset:0
    ds_read_b64_tr_b16 v[90:91], v104 offset:1024
    v_mfma_f32_32x32x16_bf16 v[48:63], v[178:181], v[166:169], v[48:63]
    ds_read_b64_tr_b16 v[92:93], v105 offset:0
    ds_read_b64_tr_b16 v[94:95], v105 offset:1024
    v_mfma_f32_32x32x16_bf16 v[64:79], v[178:181], v[170:173], v[64:79]
    s_branch L_g1_56
L_g1x_57:
    v_mfma_f32_32x32x16_bf16 v[32:47], v[174:177], v[170:173], v[32:47]
    v_mfma_f32_32x32x16_bf16 v[48:63], v[178:181], v[166:169], v[48:63]
    v_mfma_f32_32x32x16_bf16 v[64:79], v[178:181], v[170:173], v[64:79]
    s_lshl_b32 s12, s5, 1
    s_add_u32 s12, s12, s80
    s_mul_i32 s12, s12, 73728
    s_mov_b32 s13, 4157440
    s_cmp_lt_u32 s15, 9
    s_cselect_b32 s10, 0x3eae1a93, 1.0
    s_cselect_b32 s13, 1048576, s13
    s_mov_b32 s11, s10
    s_add_u32 s13, s13, s12
    s_lshl_b32 s12, s15, 12
    s_add_u32 s13, s13, s12
    s_add_u32 s12, s13, 36864
    v_pk_mul_f32 v[16:17], v[16:17], s[10:11]
    v_pk_mul_f32 v[18:19], v[18:19], s[10:11]
    v_cvt_pk_bf16_f32 v16, v16, v17
    v_cvt_pk_bf16_f32 v17, v18, v19
    buffer_store_dwordx2 v[16:17], v205, s[60:63], s13 offen offset:0 sc1
    v_pk_mul_f32 v[20:21], v[20:21], s[10:11]
    v_pk_mul_f32 v[22:23], v[22:23], s[10:11]
    v_cvt_pk_bf16_f32 v18, v20, v21
    v_cvt_pk_bf16_f32 v19, v22, v23
    buffer_store_dwordx2 v[18:19], v205, s[60:63], s13 offen offset:512 sc1
    v_pk_mul_f32 v[24:25], v[24:25], s[10:11]
    v_pk_mul_f32 v[26:27], v[26:27], s[10:11]
    v_cvt_pk_bf16_f32 v20, v24, v25
    v_cvt_pk_bf16_f32 v21, v26, v27
    buffer_store_dwordx2 v[20:21], v205, s[60:63], s13 offen offset:1024 sc1
    v_pk_mul_f32 v[28:29], v[28:29], s[10:11]
    v_pk_mul_f32 v[30:31], v[30:31], s[10:11]
    v_cvt_pk_bf16_f32 v22, v28, v29
    v_cvt_pk_bf16_f32 v23, v30, v31
    buffer_store_dwordx2 v[22:23], v205, s[60:63], s13 offen offset:1536 sc1
    v_pk_mul_f32 v[32:33], v[32:33], s[10:11]
    v_pk_mul_f32 v[34:35], v[34:35], s[10:11]
    v_cvt_pk_bf16_f32 v32, v32, v33
    v_cvt_pk_bf16_f32 v33, v34, v35
    buffer_store_dwordx2 v[32:33], v205, s[60:63], s12 offen offset:0 sc1
    v_pk_mul_f32 v[36:37], v[36:37], s[10:11]
    v_pk_mul_f32 v[38:39], v[38:39], s[10:11]
    v_cvt_pk_bf16_f32 v34, v36, v37
    v_cvt_pk_bf16_f32 v35, v38, v39
    buffer_store_dwordx2 v[34:35], v205, s[60:63], s12 offen offset:512 sc1
    v_pk_mul_f32 v[40:41], v[40:41], s[10:11]
    v_pk_mul_f32 v[42:43], v[42:43], s[10:11]
    v_cvt_pk_bf16_f32 v36, v40, v41
    v_cvt_pk_bf16_f32 v37, v42, v43
    buffer_store_dwordx2 v[36:37], v205, s[60:63], s12 offen offset:1024 sc1
    v_pk_mul_f32 v[44:45], v[44:45], s[10:11]
    v_pk_mul_f32 v[46:47], v[46:47], s[10:11]
    v_cvt_pk_bf16_f32 v38, v44, v45
    v_cvt_pk_bf16_f32 v39, v46, v47
    buffer_store_dwordx2 v[38:39], v205, s[60:63], s12 offen offset:1536 sc1
    v_pk_mul_f32 v[48:49], v[48:49], s[10:11]
    v_pk_mul_f32 v[50:51], v[50:51], s[10:11]
    v_cvt_pk_bf16_f32 v48, v48, v49
    v_cvt_pk_bf16_f32 v49, v50, v51
    buffer_store_dwordx2 v[48:49], v205, s[60:63], s13 offen offset:2048 sc1
    v_pk_mul_f32 v[52:53], v[52:53], s[10:11]
    v_pk_mul_f32 v[54:55], v[54:55], s[10:11]
    v_cvt_pk_bf16_f32 v50, v52, v53
    v_cvt_pk_bf16_f32 v51, v54, v55
    buffer_store_dwordx2 v[50:51], v205, s[60:63], s13 offen offset:2560 sc1
    v_pk_mul_f32 v[56:57], v[56:57], s[10:11]
    v_pk_mul_f32 v[58:59], v[58:59], s[10:11]
    v_cvt_pk_bf16_f32 v52, v56, v57
    v_cvt_pk_bf16_f32 v53, v58, v59
    buffer_store_dwordx2 v[52:53], v205, s[60:63], s13 offen offset:3072 sc1
    v_pk_mul_f32 v[60:61], v[60:61], s[10:11]
    v_pk_mul_f32 v[62:63], v[62:63], s[10:11]
    v_cvt_pk_bf16_f32 v54, v60, v61
    v_cvt_pk_bf16_f32 v55, v62, v63
    buffer_store_dwordx2 v[54:55], v205, s[60:63], s13 offen offset:3584 sc1
    v_pk_mul_f32 v[64:65], v[64:65], s[10:11]
    v_pk_mul_f32 v[66:67], v[66:67], s[10:11]
    v_cvt_pk_bf16_f32 v64, v64, v65
    v_cvt_pk_bf16_f32 v65, v66, v67
    buffer_store_dwordx2 v[64:65], v205, s[60:63], s12 offen offset:2048 sc1
    v_pk_mul_f32 v[68:69], v[68:69], s[10:11]
    v_pk_mul_f32 v[70:71], v[70:71], s[10:11]
    v_cvt_pk_bf16_f32 v66, v68, v69
    v_cvt_pk_bf16_f32 v67, v70, v71
    buffer_store_dwordx2 v[66:67], v205, s[60:63], s12 offen offset:2560 sc1
    v_pk_mul_f32 v[72:73], v[72:73], s[10:11]
    v_pk_mul_f32 v[74:75], v[74:75], s[10:11]
    v_cvt_pk_bf16_f32 v68, v72, v73
    v_cvt_pk_bf16_f32 v69, v74, v75
    buffer_store_dwordx2 v[68:69], v205, s[60:63], s12 offen offset:3072 sc1
    v_pk_mul_f32 v[76:77], v[76:77], s[10:11]
    v_pk_mul_f32 v[78:79], v[78:79], s[10:11]
    v_cvt_pk_bf16_f32 v70, v76, v77
    v_cvt_pk_bf16_f32 v71, v78, v79
    buffer_store_dwordx2 v[70:71], v205, s[60:63], s12 offen offset:3584 sc1
    s_branch L_doneA
L_V:
    ds_read_b128 v[80:83], v198 offset:0
    ds_read_b128 v[84:87], v198 offset:4096
    ds_read_b64_tr_b16 v[88:89], v104 offset:0
    ds_read_b64_tr_b16 v[90:91], v104 offset:1024
    ds_read_b64_tr_b16 v[92:93], v105 offset:0
    ds_read_b64_tr_b16 v[94:95], v105 offset:1024
L_g1_58:
    s_waitcnt lgkmcnt(0)
    v_mfma_f32_32x32x16_bf16 v[16:31], v[80:83], v[88:91], v[16:31]
    ds_read_b128 v[166:169], v199 offset:0
    ds_read_b128 v[170:173], v199 offset:4096
    v_mfma_f32_32x32x16_bf16 v[32:47], v[84:87], v[88:91], v[32:47]
    ds_read_b64_tr_b16 v[174:175], v104 offset:4096
    ds_read_b64_tr_b16 v[176:177], v104 offset:5120
    v_mfma_f32_32x32x16_bf16 v[48:63], v[80:83], v[92:95], v[48:63]
    ds_read_b64_tr_b16 v[178:179], v105 offset:4096
    ds_read_b64_tr_b16 v[180:181], v105 offset:5120
    v_mfma_f32_32x32x16_bf16 v[64:79], v[84:87], v[92:95], v[64:79]
    s_waitcnt lgkmcnt(0)
    v_mfma_f32_32x32x16_bf16 v[16:31], v[166:169], v[174:177], v[16:31]
    ds_read_b128 v[80:83], v200 offset:0
    ds_read_b128 v[84:87], v200 offset:4096
    v_mfma_f32_32x32x16_bf16 v[32:47], v[170:173], v[174:177], v[32:47]
    ds_read_b64_tr_b16 v[88:89], v104 offset:8192
    ds_read_b64_tr_b16 v[90:91], v104 offset:9216
    v_mfma_f32_32x32x16_bf16 v[48:63], v[166:169], v[178:181], v[48:63]
    ds_read_b64_tr_b16 v[92:93], v105 offset:8192
    ds_read_b64_tr_b16 v[94:95], v105 offset:9216
    v_mfma_f32_32x32x16_bf16 v[64:79], v[170:173], v[178:181], v[64:79]
    s_mov_b32 s14, 45056
    s_cmp_eq_u32 s85, 90112
    s_cselect_b32 s14, 4294877184, s14
    s_waitcnt lgkmcnt(0)
    v_mfma_f32_32x32x16_bf16 v[16:31], v[80:83], v[88:91], v[16:31]
    ds_read_b128 v[166:169], v201 offset:0
    ds_read_b128 v[170:173], v201 offset:4096
    v_mfma_f32_32x32x16_bf16 v[32:47], v[84:87], v[88:91], v[32:47]
    ds_read_b64_tr_b16 v[174:175], v104 offset:12288
    ds_read_b64_tr_b16 v[176:177], v104 offset:13312
    v_mfma_f32_32x32x16_bf16 v[48:63], v[80:83], v[92:95], v[48:63]
    ds_read_b64_tr_b16 v[178:179], v105 offset:12288
    ds_read_b64_tr_b16 v[180:181], v105 offset:13312
    v_add_u32 v198, s14, v198
    v_add_u32 v199, s14, v199
    v_add_u32 v200, s14, v200
    v_add_u32 v201, s14, v201
    v_add_u32 v104, s14, v104
    v_mfma_f32_32x32x16_bf16 v[64:79], v[84:87], v[92:95], v[64:79]
    v_add_u32 v105, s14, v105
    s_waitcnt lgkmcnt(0)
    s_barrier
    v_mfma_f32_32x32x16_bf16 v[16:31], v[166:169], v[174:177], v[16:31]
    s_cmp_eq_u32 s82, 8
    s_cbranch_scc1 L_g1x_59
    s_add_u32 s85, s85, s14
    s_add_u32 s82, s82, 1
    ds_read_b128 v[80:83], v198 offset:0
    ds_read_b128 v[84:87], v198 offset:4096
    v_mfma_f32_32x32x16_bf16 v[32:47], v[170:173], v[174:177], v[32:47]
    ds_read_b64_tr_b16 v[88:89], v104 offset:0
    ds_read_b64_tr_b16 v[90:91], v104 offset:1024
    v_mfma_f32_32x32x16_bf16 v[48:63], v[166:169], v[178:181], v[48:63]
    ds_read_b64_tr_b16 v[92:93], v105 offset:0
    ds_read_b64_tr_b16 v[94:95], v105 offset:1024
    v_mfma_f32_32x32x16_bf16 v[64:79], v[170:173], v[178:181], v[64:79]
    s_branch L_g1_58
L_g1x_59:
    v_mfma_f32_32x32x16_bf16 v[32:47], v[170:173], v[174:177], v[32:47]
    v_mfma_f32_32x32x16_bf16 v[48:63], v[166:169], v[178:181], v[48:63]
    v_mfma_f32_32x32x16_bf16 v[64:79], v[170:173], v[178:181], v[64:79]
    s_lshl_b32 s12, s5, 1
    s_add_u32 s12, s12, s80
    s_mul_i32 s12, s12, 73728
    s_lshl_b32 s13, s15, 10
    s_add_u32 s13, s13, 7321600
    s_add_u32 s13, s13, s12
    v_mul_u32_u24 v12, 9216, v3
    v_lshl_add_u32 v12, v2, 4, v12
    s_add_u32 s12, s13, 0
    v_cvt_pk_bf16_f32 v16, v16, v17
    v_cvt_pk_bf16_f32 v17, v18, v19
    v_cvt_pk_bf16_f32 v18, v20, v21
    v_cvt_pk_bf16_f32 v19, v22, v23
    buffer_store_dwordx4 v[16:19], v12, s[60:63], s12 offen offset:0 sc1
    s_add_u32 s12, s13, 18432
    v_cvt_pk_bf16_f32 v20, v24, v25
    v_cvt_pk_bf16_f32 v21, v26, v27
    v_cvt_pk_bf16_f32 v22, v28, v29
    v_cvt_pk_bf16_f32 v23, v30, v31
    buffer_store_dwordx4 v[20:23], v12, s[60:63], s12 offen offset:0 sc1
    s_add_u32 s12, s13, 36864
    v_cvt_pk_bf16_f32 v32, v32, v33
    v_cvt_pk_bf16_f32 v33, v34, v35
    v_cvt_pk_bf16_f32 v34, v36, v37
    v_cvt_pk_bf16_f32 v35, v38, v39
    buffer_store_dwordx4 v[32:35], v12, s[60:63], s12 offen offset:0 sc1
    s_add_u32 s12, s13, 55296
    v_cvt_pk_bf16_f32 v36, v40, v41
    v_cvt_pk_bf16_f32 v37, v42, v43
    v_cvt_pk_bf16_f32 v38, v44, v45
    v_cvt_pk_bf16_f32 v39, v46, v47
    buffer_store_dwordx4 v[36:39], v12, s[60:63], s12 offen offset:0 sc1
    s_add_u32 s12, s13, 0
    v_cvt_pk_bf16_f32 v48, v48, v49
    v_cvt_pk_bf16_f32 v49, v50, v51
    v_cvt_pk_bf16_f32 v50, v52, v53
    v_cvt_pk_bf16_f32 v51, v54, v55
    buffer_store_dwordx4 v[48:51], v12, s[60:63], s12 offen offset:512 sc1
    s_add_u32 s12, s13, 18432
    v_cvt_pk_bf16_f32 v52, v56, v57
    v_cvt_pk_bf16_f32 v53, v58, v59
    v_cvt_pk_bf16_f32 v54, v60, v61
    v_cvt_pk_bf16_f32 v55, v62, v63
    buffer_store_dwordx4 v[52:55], v12, s[60:63], s12 offen offset:512 sc1
    s_add_u32 s12, s13, 36864
    v_cvt_pk_bf16_f32 v64, v64, v65
    v_cvt_pk_bf16_f32 v65, v66, v67
    v_cvt_pk_bf16_f32 v66, v68, v69
    v_cvt_pk_bf16_f32 v67, v70, v71
    buffer_store_dwordx4 v[64:67], v12, s[60:63], s12 offen offset:512 sc1
    s_add_u32 s12, s13, 55296
    v_cvt_pk_bf16_f32 v68, v72, v73
    v_cvt_pk_bf16_f32 v69, v74, v75
    v_cvt_pk_bf16_f32 v70, v76, v77
    v_cvt_pk_bf16_f32 v71, v78, v79
    buffer_store_dwordx4 v[68:71], v12, s[60:63], s12 offen offset:512 sc1
    s_branch L_doneA
L_idleA:
    s_barrier
    s_barrier
    s_barrier
    s_barrier
    s_barrier
    s_barrier
    s_barrier
    s_barrier
    s_barrier
L_doneA:
    s_branch L_p2
L_p2:
    s_waitcnt vmcnt(0) lgkmcnt(0)
    s_barrier
    s_lshl_b32 s10, s6, 4
    s_add_u32 s10, s10, s5
    s_lshl_b32 s10, s10, 7
    s_add_u32 s10, s10, 4096
    s_bitcmp1_b32 s90, 0
    s_cselect_b32 s10, s10, s99
    s_cmp_eq_u32 s4, 4
    s_cselect_b32 s10, s10, s99
    v_mov_b32 v4, s10
    v_mov_b32 v5, s9
    s_mov_b64 exec, 1
    buffer_store_dword v5, v4, s[60:63], 0 offen sc1
    s_mov_b64 exec, -1
    v_lshrrev_b32 v4, 4, v0
    v_and_b32 v5, 15, v0
    s_lshl_b32 s10, s22, 3
    s_mul_i32 s14, s8, 72
    s_and_b32 s15, s4, 3
    s_lshl_b32 s15, s15, 3
    s_add_u32 s15, s15, s14
    v_add_u32 v6, 0, v4
    v_add_u32 v7, s10, v6
    v_xor_b32 v7, v7, v5
    v_add_u32 v6, s15, v6
    v_mul_u32_u24 v6, 1152, v6
    v_lshl_add_u32 v202, v7, 4, v6
    v_add_u32 v6, 4, v4
    v_add_u32 v7, s10, v6
    v_xor_b32 v7, v7, v5
    v_add_u32 v6, s15, v6
    v_mul_u32_u24 v6, 1152, v6
    v_lshl_add_u32 v203, v7, 4, v6
    s_lshl_b32 s10, s22, 2
    s_mul_i32 s14, s8, 72
    v_lshrrev_b32 v4, 4, v0
    v_and_b32 v5, 15, v0
    v_add_u32 v6, s10, v4
    v_xor_b32 v7, v6, v5
    s_add_u32 s14, s14, 64
    v_add_u32 v6, s14, v6
    v_mul_u32_u24 v6, 1152, v6
    v_lshl_add_u32 v204, v7, 4, v6
    s_bitcmp1_b32 s4, 1
    s_cselect_b32 s32, s68, s64
    s_cselect_b32 s33, s69, s65
    s_mov_b32 s34, 663552
    s_mov_b32 s35, 0x20000
    s_cselect_b32 s28, 18432, 0
    s_lshl_b32 s10, s22, 10
    s_add_u32 s28, s28, s10
    s_add_u32 s28, s28, 16384
    v_and_b32 v6, 15, v2
    v_mul_u32_u24 v7, 18432, v3
    v_lshl_add_u32 v7, v2, 8, v7
    s_lshl_b32 s10, s23, 2
    s_add_u32 s12, s10, 0
    v_xor_b32 v8, s12, v6
    v_lshl_add_u32 v247, v8, 4, v7
    s_add_u32 s12, s10, 1
    v_xor_b32 v8, s12, v6
    v_lshl_add_u32 v248, v8, 4, v7
    s_add_u32 s12, s10, 2
    v_xor_b32 v8, s12, v6
    v_lshl_add_u32 v249, v8, 4, v7
    s_add_u32 s12, s10, 3
    v_xor_b32 v8, s12, v6
    v_lshl_add_u32 v250, v8, 4, v7
    s_lshl_b32 s10, s23, 13
    s_add_u32 s12, s10, 116736
    v_add_u32 v193, s12, v235
    v_xor_b32 v194, 64, v193
    s_lshl_b32 s10, s23, 12
    s_add_u32 s10, s10, 40960
    v_add_u32 v196, s10, v235
    v_xor_b32 v197, 64, v196
    s_mov_b32 s12, 32768
    s_cmp_ge_u32 s4, 4
    s_cselect_b32 s12, s12, 57344
    s_lshl_b32 s10, s23, 11
    s_add_u32 s10, s10, s12
    v_add_u32 v199, s10, v235
    v_xor_b32 v200, 64, v199
    s_lshl_b32 s10, s23, 10
    s_add_u32 s12, s10, 149504
    v_add_u32 v195, s12, v236
    s_add_u32 s12, s10, 153600
    v_add_u32 v198, s12, v236
    s_lshl_b32 s10, s23, 8
    s_add_u32 s10, s10, 157696
    v_add_u32 v201, s10, v236
    s_cmp_lg_u32 s4, 4
    s_cbranch_scc1 L_np_60
    s_mov_b32 s92, 0
L_poll_61:
    s_mov_b64 exec, s[100:101]
    buffer_load_dword v227, v222, s[60:63], 0 offen sc1
    s_mov_b64 exec, 0xff
    buffer_load_dword v228, v223, s[60:63], 0 offen sc1
    s_waitcnt vmcnt(0)
    s_mov_b64 s[10:11], 0
    s_mov_b64 exec, s[100:101]
    v_cmp_ne_u32 vcc, s9, v227
    s_nop 0
    s_or_b64 s[10:11], s[10:11], vcc
    s_mov_b64 exec, 0xff
    v_cmp_ne_u32 vcc, s9, v228
    s_nop 0
    s_or_b64 s[10:11], s[10:11], vcc
    s_mov_b64 exec, -1
    s_cmp_eq_u64 s[10:11], 0
    s_cbranch_scc1 L_pollq_62
    s_add_u32 s92, s92, 1
    s_cmp_gt_u32 s92, 20000
    s_cbranch_scc1 L_pollq_62
    s_sleep 2
    s_branch L_poll_61
L_pollq_62:
L_np_60:
    s_waitcnt lgkmcnt(0)
    s_barrier
    s_lshl_b32 s10, s8, 3
    s_add_u32 s10, s10, s4
    s_mul_i32 s12, s10, 36864
    s_add_u32 s12, s12, 1048576
    s_add_u32 s14, s12, s44
    s_add_u32 s15, s12, s45
    s_lshr_b32 s12, s10, 2
    s_lshl_b32 s12, s12, 10
    s_and_b32 s13, s10, 3
    s_lshl_b32 s13, s13, 7
    s_add_u32 s12, s12, s13
    s_add_u32 s12, s12, 327680
    v_lshlrev_b32 v14, 3, v2
    v_lshlrev_b32 v15, 2, v2
    buffer_load_dwordx2 v[96:97], v205, s[60:63], s14 offen sc1
    buffer_load_dwordx2 v[98:99], v205, s[60:63], s14 offen offset:512 sc1
    buffer_load_dwordx2 v[100:101], v14, s[60:63], s15 offen sc1
    buffer_load_dword v104, v15, s[60:63], s12 offen sc1
    s_add_u32 s10, s4, 0
    s_mul_i32 s94, s10, 36864
    s_add_u32 m0, s93, 0
    s_nop 0
    buffer_load_dwordx4 v210, s[60:63], s94 offen sc1 lds
    s_add_u32 m0, s93, 1024
    s_nop 0
    buffer_load_dwordx4 v211, s[60:63], s94 offen sc1 lds
    s_add_u32 m0, s93, 2048
    s_mov_b64 exec, 0xffffff
    buffer_load_dwordx4 v212, s[60:63], s94 offen sc1 lds
    s_mov_b64 exec, -1
L_p2c:
    v_mov_b32 v16, 0
    v_mov_b32 v17, 0
    v_mov_b32 v18, 0
    v_mov_b32 v19, 0
    v_mov_b32 v20, 0
    v_mov_b32 v21, 0
    v_mov_b32 v22, 0
    v_mov_b32 v23, 0
    v_mov_b32 v24, 0
    v_mov_b32 v25, 0
    v_mov_b32 v26, 0
    v_mov_b32 v27, 0
    v_mov_b32 v28, 0
    v_mov_b32 v29, 0
    v_mov_b32 v30, 0
    v_mov_b32 v31, 0
    s_cmp_ge_u32 s4, 4
    s_cselect_b32 s31, 2, 1
    s_bitcmp1_b32 s90, 1
    s_cselect_b32 s31, s31, 0
    s_bitcmp1_b32 s7, 0
    s_cselect_b64 s[10:11], -1, 0
    s_mov_b64 s[12:13], 0xffffffff
    v_mov_b32 v4, 159744
    s_waitcnt vmcnt(0)
    v_cndmask_b32 v6, v100, 0, s[10:11]
    v_cndmask_b32 v7, 0, v101, s[10:11]
    v_cndmask_b32 v100, 0, v6, s[12:13]
    v_cndmask_b32 v101, 0, v7, s[12:13]
    v_cndmask_b32 v102, v6, 0, s[12:13]
    v_cndmask_b32 v103, v7, 0, s[12:13]
    s_barrier
    ds_read2st64_b64 v[64:67], v205 offset0:0 offset1:1
    ds_read2st64_b64 v[72:75], v206 offset0:0 offset1:5
    ds_read2st64_b64 v[68:71], v205 offset0:5 offset1:6
    ds_read_b128 v[80:83], v207 offset:0
    ds_write_b32 v4, v16
    s_add_u32 s10, s4, 8
    s_mul_i32 s94, s10, 36864
    s_add_u32 m0, s93, 20480
    s_nop 0
    buffer_load_dwordx4 v210, s[60:63], s94 offen sc1 lds
    s_add_u32 m0, s93, 21504
    s_nop 0
    buffer_load_dwordx4 v211, s[60:63], s94 offen sc1 lds
    s_waitcnt lgkmcnt(3)
    v_mfma_f32_32x32x16_bf16 v[32:47], v[64:67], v[96:99], 0
    v_mfma_f32_32x32x8_bf16 v[32:47], v[72:73], v[100:101], v[32:47]
    s_add_u32 m0, s93, 22528
    s_mov_b64 exec, 0xffffff
    buffer_load_dwordx4 v212, s[60:63], s94 offen sc1 lds
    s_mov_b64 exec, -1
    buffer_load_dword v227, v222, s[60:63], 0 offen sc1
    s_setprio 3
    s_nop 5
    v_exp_f32 v32, v32
    v_exp_f32 v33, v33
    s_waitcnt lgkmcnt(0)
    ds_read_b128 v[84:87], v208 offset:0
    v_exp_f32 v34, v34
    v_exp_f32 v35, v35
    ds_read2st64_b64 v[64:67], v205 offset0:10 offset1:11
    v_exp_f32 v36, v36
    v_exp_f32 v37, v37
    v_mfma_f32_32x32x16_bf16 v[48:63], v[68:71], v[96:99], 0
    v_exp_f32 v38, v38
    v_exp_f32 v39, v39
    ds_read_b128 v[88:91], v207 offset:2560
    v_exp_f32 v40, v40
    v_exp_f32 v41, v41
    v_mfma_f32_32x32x8_bf16 v[48:63], v[74:75], v[100:101], v[48:63]
    v_exp_f32 v42, v42
    v_exp_f32 v43, v43
    v_exp_f32 v44, v44
    v_exp_f32 v45, v45
    v_smfmac_f32_32x32x32_bf16 v[16:31], v[80:83], v[32:39], v209
    v_exp_f32 v46, v46
    s_cmp_lg_u32 s31, 1
    s_cbranch_scc1 L_role_63
    s_add_u32 s10, s29, 0
    buffer_store_dwordx4 v[106:109], v221, s[60:63], s10 offen offset:0 sc1
    s_add_u32 s10, s29, 0
    buffer_store_dwordx4 v[110:113], v221, s[60:63], s10 offen offset:1024 sc1
L_role_63:
    v_exp_f32 v47, v47
    v_exp_f32 v48, v48
    v_exp_f32 v49, v49
    s_waitcnt lgkmcnt(0)
    v_smfmac_f32_32x32x32_bf16 v[16:31], v[84:87], v[40:47], v209
    ds_read_b128 v[92:95], v208 offset:2560
    v_exp_f32 v50, v50
    v_exp_f32 v51, v51
    ds_read2st64_b64 v[68:71], v205 offset0:15 offset1:16
    v_exp_f32 v52, v52
    v_exp_f32 v53, v53
    v_mfma_f32_32x32x16_bf16 v[32:47], v[64:67], v[96:99], 0
    v_exp_f32 v54, v54
    v_exp_f32 v55, v55
    ds_read_b128 v[80:83], v207 offset:5120
    v_exp_f32 v56, v56
    v_exp_f32 v57, v57
    v_mfma_f32_32x32x8_bf16 v[32:47], v[72:73], v[102:103], v[32:47]
    v_exp_f32 v58, v58
    v_exp_f32 v59, v59
    v_exp_f32 v60, v60
    v_exp_f32 v61, v61
    v_smfmac_f32_32x32x32_bf16 v[16:31], v[88:91], v[48:55], v209
    v_exp_f32 v62, v62
    s_cmp_lg_u32 s31, 1
    s_cbranch_scc1 L_role_64
    s_add_u32 s10, s29, 0
    buffer_store_dwordx4 v[114:117], v221, s[60:63], s10 offen offset:2048 sc1
    s_add_u32 s10, s29, 0
    buffer_store_dwordx4 v[118:121], v221, s[60:63], s10 offen offset:3072 sc1
L_role_64:
    v_exp_f32 v63, v63
    s_setprio 2
    v_exp_f32 v32, v32
    v_exp_f32 v33, v33
    s_waitcnt lgkmcnt(0)
    v_smfmac_f32_32x32x32_bf16 v[16:31], v[92:95], v[56:63], v209
    ds_read_b128 v[84:87], v208 offset:5120
    v_exp_f32 v34, v34
    v_exp_f32 v35, v35
    ds_read2st64_b64 v[64:67], v205 offset0:20 offset1:21
    v_exp_f32 v36, v36
    v_exp_f32 v37, v37
    v_mfma_f32_32x32x16_bf16 v[48:63], v[68:71], v[96:99], 0
    v_exp_f32 v38, v38
    v_exp_f32 v39, v39
    ds_read_b128 v[88:91], v207 offset:7680
    v_exp_f32 v40, v40
    v_exp_f32 v41, v41
    v_mfma_f32_32x32x8_bf16 v[48:63], v[74:75], v[102:103], v[48:63]
    v_exp_f32 v42, v42
    v_exp_f32 v43, v43
    ds_read2st64_b64 v[76:79], v206 offset0:20 offset1:25
    v_exp_f32 v44, v44
    v_exp_f32 v45, v45
    v_smfmac_f32_32x32x32_bf16 v[16:31], v[80:83], v[32:39], v209
    v_exp_f32 v46, v46
    s_cmp_lg_u32 s31, 1
    s_cbranch_scc1 L_role_65
    s_add_u32 s10, s29, 4096
    buffer_store_dwordx4 v[122:125], v221, s[60:63], s10 offen offset:0 sc1
    s_add_u32 s10, s29, 4096
    buffer_store_dwordx4 v[126:129], v221, s[60:63], s10 offen offset:1024 sc1
L_role_65:
    v_exp_f32 v47, v47
    v_exp_f32 v48, v48
    v_exp_f32 v49, v49
    s_waitcnt lgkmcnt(0)
    v_smfmac_f32_32x32x32_bf16 v[16:31], v[84:87], v[40:47], v209
    ds_read_b128 v[92:95], v208 offset:7680
    v_exp_f32 v50, v50
    v_exp_f32 v51, v51
    ds_read2st64_b64 v[68:71], v205 offset0:25 offset1:26
    v_exp_f32 v52, v52
    v_exp_f32 v53, v53
    v_mfma_f32_32x32x16_bf16 v[32:47], v[64:67], v[96:99], 0
    v_exp_f32 v54, v54
    v_exp_f32 v55, v55
    ds_read_b128 v[80:83], v207 offset:10240
    v_exp_f32 v56, v56
    v_exp_f32 v57, v57
    v_mfma_f32_32x32x8_bf16 v[32:47], v[76:77], v[100:101], v[32:47]
    v_exp_f32 v58, v58
    v_exp_f32 v59, v59
    v_exp_f32 v60, v60
    v_exp_f32 v61, v61
    v_smfmac_f32_32x32x32_bf16 v[16:31], v[88:91], v[48:55], v209
    v_exp_f32 v62, v62
    v_exp_f32 v63, v63
    s_setprio 1
    v_exp_f32 v32, v32
    v_exp_f32 v33, v33
    s_waitcnt lgkmcnt(0)
    v_smfmac_f32_32x32x32_bf16 v[16:31], v[92:95], v[56:63], v209
    ds_read_b128 v[84:87], v208 offset:10240
    v_exp_f32 v34, v34
    v_exp_f32 v35, v35
    ds_read2st64_b64 v[64:67], v205 offset0:30 offset1:31
    v_exp_f32 v36, v36
    v_exp_f32 v37, v37
    v_mfma_f32_32x32x16_bf16 v[48:63], v[68:71], v[96:99], 0
    v_exp_f32 v38, v38
    v_exp_f32 v39, v39
    ds_read_b128 v[88:91], v207 offset:12800
    v_exp_f32 v40, v40
    v_exp_f32 v41, v41
    v_mfma_f32_32x32x8_bf16 v[48:63], v[78:79], v[100:101], v[48:63]
    v_exp_f32 v42, v42
    v_exp_f32 v43, v43
    v_exp_f32 v44, v44
    v_exp_f32 v45, v45
    v_smfmac_f32_32x32x32_bf16 v[16:31], v[80:83], v[32:39], v209
    v_exp_f32 v46, v46
    v_exp_f32 v47, v47
    s_setprio 0
    v_exp_f32 v48, v48
    v_exp_f32 v49, v49
    s_waitcnt lgkmcnt(0)
    v_smfmac_f32_32x32x32_bf16 v[16:31], v[84:87], v[40:47], v209
    ds_read_b128 v[92:95], v208 offset:12800
    v_exp_f32 v50, v50
    v_exp_f32 v51, v51
    ds_read2st64_b64 v[68:71], v205 offset0:35 offset1:36
    v_exp_f32 v52, v52
    v_exp_f32 v53, v53
    v_mfma_f32_32x32x16_bf16 v[32:47], v[64:67], v[96:99], 0
    v_exp_f32 v54, v54
    v_exp_f32 v55, v55
    ds_read_b128 v[80:83], v207 offset:15360
    v_exp_f32 v56, v56
    v_exp_f32 v57, v57
    v_mfma_f32_32x32x8_bf16 v[32:47], v[76:77], v[102:103], v[32:47]
    v_exp_f32 v58, v58
    v_exp_f32 v59, v59
    v_exp_f32 v60, v60
    v_exp_f32 v61, v61
    v_smfmac_f32_32x32x32_bf16 v[16:31], v[88:91], v[48:55], v209
    v_exp_f32 v62, v62
    v_exp_f32 v63, v63
    s_waitcnt vmcnt(0) lgkmcnt(0)
    s_cmp_lg_u32 s4, 4
    s_cbranch_scc1 L_chk_66
    v_cmp_ne_u32 vcc, s9, v227
    s_nop 0
    s_cmp_eq_u64 vcc, 0
    s_cbranch_scc1 L_chk_66
    s_mov_b32 s92, 0
L_poll_67:
    s_mov_b64 exec, -1
    buffer_load_dword v227, v222, s[60:63], 0 offen sc1
    s_waitcnt vmcnt(0)
    s_mov_b64 s[10:11], 0
    s_mov_b64 exec, -1
    v_cmp_ne_u32 vcc, s9, v227
    s_nop 0
    s_or_b64 s[10:11], s[10:11], vcc
    s_mov_b64 exec, -1
    s_cmp_eq_u64 s[10:11], 0
    s_cbranch_scc1 L_pollq_68
    s_add_u32 s92, s92, 1
    s_cmp_gt_u32 s92, 20000
    s_cbranch_scc1 L_pollq_68
    s_sleep 2
    s_branch L_poll_67
L_pollq_68:
L_chk_66:
    s_barrier
    s_setprio 3
    v_exp_f32 v32, v32
    v_exp_f32 v33, v33
    s_waitcnt lgkmcnt(0)
    v_smfmac_f32_32x32x32_bf16 v[16:31], v[92:95], v[56:63], v209
    ds_read_b128 v[84:87], v208 offset:15360
    v_exp_f32 v34, v34
    v_exp_f32 v35, v35
    ds_read2st64_b64 v[64:67], v205 offset0:40 offset1:41
    v_exp_f32 v36, v36
    v_exp_f32 v37, v37
    v_mfma_f32_32x32x16_bf16 v[48:63], v[68:71], v[96:99], 0
    v_exp_f32 v38, v38
    v_exp_f32 v39, v39
    ds_read_b128 v[88:91], v207 offset:17920
    v_exp_f32 v40, v40
    v_exp_f32 v41, v41
    v_mfma_f32_32x32x8_bf16 v[48:63], v[78:79], v[102:103], v[48:63]
    v_exp_f32 v42, v42
    v_exp_f32 v43, v43
    ds_read2st64_b64 v[72:75], v206 offset0:40 offset1:45
    v_exp_f32 v44, v44
    v_exp_f32 v45, v45
    v_smfmac_f32_32x32x32_bf16 v[16:31], v[80:83], v[32:39], v209
    s_lshl_b32 s10, s84, 4
    s_add_u32 s10, s10, s5
    s_lshl_b32 s10, s10, 7
    s_add_u32 s10, s10, 36864
    s_bitcmp1_b32 s90, 1
    s_cselect_b32 s10, s10, s99
    s_cmp_eq_u32 s4, 4
    s_cselect_b32 s10, s10, s99
    v_exp_f32 v46, v46
    v_mov_b32 v4, s10
    v_mov_b32 v5, s9
    s_mov_b64 exec, 1
    buffer_store_dword v5, v4, s[60:63], 0 offen sc1
    s_mov_b64 exec, -1
    v_exp_f32 v47, v47
    v_exp_f32 v48, v48
    v_exp_f32 v49, v49
    s_waitcnt lgkmcnt(0)
    v_smfmac_f32_32x32x32_bf16 v[16:31], v[84:87], v[40:47], v209
    ds_read_b128 v[92:95], v208 offset:17920
    v_exp_f32 v50, v50
    v_exp_f32 v51, v51
    ds_read2st64_b64 v[68:71], v205 offset0:45 offset1:46
    v_exp_f32 v52, v52
    v_exp_f32 v53, v53
    v_mfma_f32_32x32x16_bf16 v[32:47], v[64:67], v[96:99], 0
    v_exp_f32 v54, v54
    v_exp_f32 v55, v55
    ds_read_b128 v[80:83], v207 offset:20480
    v_exp_f32 v56, v56
    v_exp_f32 v57, v57
    v_mfma_f32_32x32x8_bf16 v[32:47], v[72:73], v[100:101], v[32:47]
    v_exp_f32 v58, v58
    v_exp_f32 v59, v59
    v_exp_f32 v60, v60
    v_exp_f32 v61, v61
    v_smfmac_f32_32x32x32_bf16 v[16:31], v[88:91], v[48:55], v209
    s_add_u32 s94, s94, 294912
    s_add_u32 m0, s93, 40960
    v_exp_f32 v62, v62
    buffer_load_dwordx4 v210, s[60:63], s94 offen sc1 lds
    v_exp_f32 v63, v63
    v_exp_f32 v32, v32
    v_exp_f32 v33, v33
    s_waitcnt lgkmcnt(0)
    v_smfmac_f32_32x32x32_bf16 v[16:31], v[92:95], v[56:63], v209
    ds_read_b128 v[84:87], v208 offset:20480
    v_exp_f32 v34, v34
    v_exp_f32 v35, v35
    ds_read2st64_b64 v[64:67], v205 offset0:50 offset1:51
    v_exp_f32 v36, v36
    v_exp_f32 v37, v37
    v_mfma_f32_32x32x16_bf16 v[48:63], v[68:71], v[96:99], 0
    v_exp_f32 v38, v38
    v_exp_f32 v39, v39
    ds_read_b128 v[88:91], v207 offset:23040
    v_exp_f32 v40, v40
    v_exp_f32 v41, v41
    v_mfma_f32_32x32x8_bf16 v[48:63], v[74:75], v[100:101], v[48:63]
    v_exp_f32 v42, v42
    v_exp_f32 v43, v43
    v_exp_f32 v44, v44
    v_exp_f32 v45, v45
    v_smfmac_f32_32x32x32_bf16 v[16:31], v[80:83], v[32:39], v209
    s_add_u32 m0, s93, 41984
    v_exp_f32 v46, v46
    buffer_load_dwordx4 v211, s[60:63], s94 offen sc1 lds
    v_exp_f32 v47, v47
    v_exp_f32 v48, v48
    v_exp_f32 v49, v49
    s_waitcnt lgkmcnt(0)
    v_smfmac_f32_32x32x32_bf16 v[16:31], v[84:87], v[40:47], v209
    ds_read_b128 v[92:95], v208 offset:23040
    v_exp_f32 v50, v50
    v_exp_f32 v51, v51
    ds_read2st64_b64 v[68:71], v205 offset0:55 offset1:56
    v_exp_f32 v52, v52
    v_exp_f32 v53, v53
    v_mfma_f32_32x32x16_bf16 v[32:47], v[64:67], v[96:99], 0
    v_exp_f32 v54, v54
    v_exp_f32 v55, v55
    ds_read_b128 v[80:83], v207 offset:25600
    v_exp_f32 v56, v56
    v_exp_f32 v57, v57
    v_mfma_f32_32x32x8_bf16 v[32:47], v[72:73], v[102:103], v[32:47]
    v_exp_f32 v58, v58
    v_exp_f32 v59, v59
    v_exp_f32 v60, v60
    v_exp_f32 v61, v61
    v_smfmac_f32_32x32x32_bf16 v[16:31], v[88:91], v[48:55], v209
    s_add_u32 m0, s93, 43008
    v_exp_f32 v62, v62
    s_mov_b64 exec, 0xffffff
    buffer_load_dwordx4 v212, s[60:63], s94 offen sc1 lds
    s_mov_b64 exec, -1
    v_exp_f32 v63, v63
    s_setprio 2
    v_exp_f32 v32, v32
    v_exp_f32 v33, v33
    s_waitcnt lgkmcnt(0)
    v_smfmac_f32_32x32x32_bf16 v[16:31], v[92:95], v[56:63], v209
    ds_read_b128 v[84:87], v208 offset:25600
    v_exp_f32 v34, v34
    v_exp_f32 v35, v35
    ds_read2st64_b64 v[64:67], v205 offset0:60 offset1:61
    v_exp_f32 v36, v36
    v_exp_f32 v37, v37
    v_mfma_f32_32x32x16_bf16 v[48:63], v[68:71], v[96:99], 0
    v_exp_f32 v38, v38
    v_exp_f32 v39, v39
    ds_read_b128 v[88:91], v207 offset:28160
    v_exp_f32 v40, v40
    v_exp_f32 v41, v41
    v_mfma_f32_32x32x8_bf16 v[48:63], v[74:75], v[102:103], v[48:63]
    v_exp_f32 v42, v42
    v_exp_f32 v43, v43
    ds_read2st64_b64 v[76:79], v206 offset0:60 offset1:65
    v_exp_f32 v44, v44
    v_exp_f32 v45, v45
    v_smfmac_f32_32x32x32_bf16 v[16:31], v[80:83], v[32:39], v209
    s_mul_i32 s30, s4, 3072
    s_add_u32 m0, s30, 61440
    s_mov_b32 s14, 0
    v_exp_f32 v46, v46
    buffer_load_dwordx4 v213, s[64:67], s14 offen lds
    v_exp_f32 v47, v47
    v_exp_f32 v48, v48
    v_exp_f32 v49, v49
    s_waitcnt lgkmcnt(0)
    v_smfmac_f32_32x32x32_bf16 v[16:31], v[84:87], v[40:47], v209
    ds_read_b128 v[92:95], v208 offset:28160
    v_exp_f32 v50, v50
    v_exp_f32 v51, v51
    ds_read2st64_b64 v[68:71], v205 offset0:65 offset1:66
    v_exp_f32 v52, v52
    v_exp_f32 v53, v53
    v_mfma_f32_32x32x16_bf16 v[32:47], v[64:67], v[96:99], 0
    v_exp_f32 v54, v54
    v_exp_f32 v55, v55
    ds_read_b128 v[80:83], v207 offset:30720
    v_exp_f32 v56, v56
    v_exp_f32 v57, v57
    v_mfma_f32_32x32x8_bf16 v[32:47], v[76:77], v[100:101], v[32:47]
    v_exp_f32 v58, v58
    v_exp_f32 v59, v59
    v_exp_f32 v60, v60
    v_exp_f32 v61, v61
    v_smfmac_f32_32x32x32_bf16 v[16:31], v[88:91], v[48:55], v209
    s_add_u32 m0, s30, 62464
    s_mov_b32 s14, 0
    v_exp_f32 v62, v62
    buffer_load_dwordx4 v214, s[64:67], s14 offen lds
    v_exp_f32 v63, v63
    s_setprio 1
    v_exp_f32 v32, v32
    v_exp_f32 v33, v33
    s_waitcnt lgkmcnt(0)
    v_smfmac_f32_32x32x32_bf16 v[16:31], v[92:95], v[56:63], v209
    ds_read_b128 v[84:87], v208 offset:30720
    v_exp_f32 v34, v34
    v_exp_f32 v35, v35
    ds_read2st64_b64 v[64:67], v205 offset0:70 offset1:71
    v_exp_f32 v36, v36
    v_exp_f32 v37, v37
    v_mfma_f32_32x32x16_bf16 v[48:63], v[68:71], v[96:99], 0
    v_exp_f32 v38, v38
    v_exp_f32 v39, v39
    ds_read_b128 v[88:91], v207 offset:33280
    v_exp_f32 v40, v40
    v_exp_f32 v41, v41
    v_mfma_f32_32x32x8_bf16 v[48:63], v[78:79], v[100:101], v[48:63]
    v_exp_f32 v42, v42
    v_exp_f32 v43, v43
    v_exp_f32 v44, v44
    v_exp_f32 v45, v45
    v_smfmac_f32_32x32x32_bf16 v[16:31], v[80:83], v[32:39], v209
    s_add_u32 m0, s30, 63488
    s_mov_b32 s14, 0
    v_exp_f32 v46, v46
    buffer_load_dwordx4 v215, s[64:67], s14 offen lds
    v_exp_f32 v47, v47
    s_setprio 0
    v_exp_f32 v48, v48
    v_exp_f32 v49, v49
    s_waitcnt lgkmcnt(0)
    v_smfmac_f32_32x32x32_bf16 v[16:31], v[84:87], v[40:47], v209
    ds_read_b128 v[92:95], v208 offset:33280
    v_exp_f32 v50, v50
    v_exp_f32 v51, v51
    ds_read2st64_b64 v[68:71], v205 offset0:75 offset1:76
    v_exp_f32 v52, v52
    v_exp_f32 v53, v53
    v_mfma_f32_32x32x16_bf16 v[32:47], v[64:67], v[96:99], 0
    v_exp_f32 v54, v54
    v_exp_f32 v55, v55
    ds_read_b128 v[80:83], v207 offset:35840
    v_exp_f32 v56, v56
    v_exp_f32 v57, v57
    v_mfma_f32_32x32x8_bf16 v[32:47], v[76:77], v[102:103], v[32:47]
    v_exp_f32 v58, v58
    v_exp_f32 v59, v59
    v_exp_f32 v60, v60
    v_exp_f32 v61, v61
    v_smfmac_f32_32x32x32_bf16 v[16:31], v[88:91], v[48:55], v209
    s_add_u32 m0, s30, 89088
    s_mov_b32 s14, 0
    v_exp_f32 v62, v62
    buffer_load_dwordx4 v213, s[68:71], s14 offen lds
    v_exp_f32 v63, v63
    s_waitcnt vmcnt(4)
    s_barrier
    s_setprio 3
    v_exp_f32 v32, v32
    v_exp_f32 v33, v33
    s_waitcnt lgkmcnt(0)
    v_smfmac_f32_32x32x32_bf16 v[16:31], v[92:95], v[56:63], v209
    ds_read_b128 v[84:87], v208 offset:35840
    v_exp_f32 v34, v34
    v_exp_f32 v35, v35
    ds_read2st64_b64 v[64:67], v205 offset0:80 offset1:81
    v_exp_f32 v36, v36
    v_exp_f32 v37, v37
    v_mfma_f32_32x32x16_bf16 v[48:63], v[68:71], v[96:99], 0
    v_exp_f32 v38, v38
    v_exp_f32 v39, v39
    ds_read_b128 v[88:91], v207 offset:38400
    v_exp_f32 v40, v40
    v_exp_f32 v41, v41
    v_mfma_f32_32x32x8_bf16 v[48:63], v[78:79], v[102:103], v[48:63]
    v_exp_f32 v42, v42
    v_exp_f32 v43, v43
    ds_read2st64_b64 v[72:75], v206 offset0:80 offset1:85
    v_exp_f32 v44, v44
    v_exp_f32 v45, v45
    v_smfmac_f32_32x32x32_bf16 v[16:31], v[80:83], v[32:39], v209
    s_add_u32 s94, s94, 294912
    s_add_u32 m0, s93, 0
    v_exp_f32 v46, v46
    buffer_load_dwordx4 v210, s[60:63], s94 offen sc1 lds
    v_exp_f32 v47, v47
    v_exp_f32 v48, v48
    v_exp_f32 v49, v49
    s_waitcnt lgkmcnt(0)
    v_smfmac_f32_32x32x32_bf16 v[16:31], v[84:87], v[40:47], v209
    ds_read_b128 v[92:95], v208 offset:38400
    v_exp_f32 v50, v50
    v_exp_f32 v51, v51
    ds_read2st64_b64 v[68:71], v205 offset0:85 offset1:86
    v_exp_f32 v52, v52
    v_exp_f32 v53, v53
    v_mfma_f32_32x32x16_bf16 v[32:47], v[64:67], v[96:99], 0
    v_exp_f32 v54, v54
    v_exp_f32 v55, v55
    ds_read_b128 v[80:83], v207 offset:40960
    v_exp_f32 v56, v56
    v_exp_f32 v57, v57
    v_mfma_f32_32x32x8_bf16 v[32:47], v[72:73], v[100:101], v[32:47]
    v_exp_f32 v58, v58
    v_exp_f32 v59, v59
    v_exp_f32 v60, v60
    v_exp_f32 v61, v61
    v_smfmac_f32_32x32x32_bf16 v[16:31], v[88:91], v[48:55], v209
    s_add_u32 m0, s93, 1024
    v_exp_f32 v62, v62
    buffer_load_dwordx4 v211, s[60:63], s94 offen sc1 lds
    v_exp_f32 v63, v63
    v_exp_f32 v32, v32
    v_exp_f32 v33, v33
    s_waitcnt lgkmcnt(0)
    v_smfmac_f32_32x32x32_bf16 v[16:31], v[92:95], v[56:63], v209
    ds_read_b128 v[84:87], v208 offset:40960
    v_exp_f32 v34, v34
    v_exp_f32 v35, v35
    ds_read2st64_b64 v[64:67], v205 offset0:90 offset1:91
    v_exp_f32 v36, v36
    v_exp_f32 v37, v37
    v_mfma_f32_32x32x16_bf16 v[48:63], v[68:71], v[96:99], 0
    v_exp_f32 v38, v38
    v_exp_f32 v39, v39
    ds_read_b128 v[88:91], v207 offset:43520
    v_exp_f32 v40, v40
    v_exp_f32 v41, v41
    v_mfma_f32_32x32x8_bf16 v[48:63], v[74:75], v[100:101], v[48:63]
    v_exp_f32 v42, v42
    v_exp_f32 v43, v43
    v_exp_f32 v44, v44
    v_exp_f32 v45, v45
    v_smfmac_f32_32x32x32_bf16 v[16:31], v[80:83], v[32:39], v209
    s_add_u32 m0, s93, 2048
    v_exp_f32 v46, v46
    s_mov_b64 exec, 0xffffff
    buffer_load_dwordx4 v212, s[60:63], s94 offen sc1 lds
    s_mov_b64 exec, -1
    v_exp_f32 v47, v47
    v_exp_f32 v48, v48
    v_exp_f32 v49, v49
    s_waitcnt lgkmcnt(0)
    v_smfmac_f32_32x32x32_bf16 v[16:31], v[84:87], v[40:47], v209
    ds_read_b128 v[92:95], v208 offset:43520
    v_exp_f32 v50, v50
    v_exp_f32 v51, v51
    ds_read2st64_b64 v[68:71], v205 offset0:95 offset1:96
    v_exp_f32 v52, v52
    v_exp_f32 v53, v53
    v_mfma_f32_32x32x16_bf16 v[32:47], v[64:67], v[96:99], 0
    v_exp_f32 v54, v54
    v_exp_f32 v55, v55
    ds_read_b128 v[80:83], v207 offset:46080
    v_exp_f32 v56, v56
    v_exp_f32 v57, v57
    v_mfma_f32_32x32x8_bf16 v[32:47], v[72:73], v[102:103], v[32:47]
    v_exp_f32 v58, v58
    v_exp_f32 v59, v59
    v_exp_f32 v60, v60
    v_exp_f32 v61, v61
    v_smfmac_f32_32x32x32_bf16 v[16:31], v[88:91], v[48:55], v209
    v_exp_f32 v62, v62
    buffer_load_dword v228, v224, s[60:63], 0 offen sc1
    v_exp_f32 v63, v63
    s_setprio 2
    v_exp_f32 v32, v32
    v_exp_f32 v33, v33
    s_waitcnt lgkmcnt(0)
    v_smfmac_f32_32x32x32_bf16 v[16:31], v[92:95], v[56:63], v209
    ds_read_b128 v[84:87], v208 offset:46080
    v_exp_f32 v34, v34
    v_exp_f32 v35, v35
    ds_read2st64_b64 v[64:67], v205 offset0:100 offset1:101
    v_exp_f32 v36, v36
    v_exp_f32 v37, v37
    v_mfma_f32_32x32x16_bf16 v[48:63], v[68:71], v[96:99], 0
    v_exp_f32 v38, v38
    v_exp_f32 v39, v39
    ds_read_b128 v[88:91], v207 offset:48640
    v_exp_f32 v40, v40
    v_exp_f32 v41, v41
    v_mfma_f32_32x32x8_bf16 v[48:63], v[74:75], v[102:103], v[48:63]
    v_exp_f32 v42, v42
    v_exp_f32 v43, v43
    ds_read2st64_b64 v[76:79], v206 offset0:100 offset1:105
    v_exp_f32 v44, v44
    v_exp_f32 v45, v45
    v_smfmac_f32_32x32x32_bf16 v[16:31], v[80:83], v[32:39], v209
    s_add_u32 m0, s30, 90112
    s_mov_b32 s14, 0
    v_exp_f32 v46, v46
    buffer_load_dwordx4 v214, s[68:71], s14 offen lds
    v_exp_f32 v47, v47
    v_exp_f32 v48, v48
    v_exp_f32 v49, v49
    s_waitcnt lgkmcnt(0)
    v_smfmac_f32_32x32x32_bf16 v[16:31], v[84:87], v[40:47], v209
    ds_read_b128 v[92:95], v208 offset:48640
    v_exp_f32 v50, v50
    v_exp_f32 v51, v51
    ds_read2st64_b64 v[68:71], v205 offset0:105 offset1:106
    v_exp_f32 v52, v52
    v_exp_f32 v53, v53
    v_mfma_f32_32x32x16_bf16 v[32:47], v[64:67], v[96:99], 0
    v_exp_f32 v54, v54
    v_exp_f32 v55, v55
    ds_read_b128 v[80:83], v207 offset:51200
    v_exp_f32 v56, v56
    v_exp_f32 v57, v57
    v_mfma_f32_32x32x8_bf16 v[32:47], v[76:77], v[100:101], v[32:47]
    v_exp_f32 v58, v58
    v_exp_f32 v59, v59
    v_exp_f32 v60, v60
    v_exp_f32 v61, v61
    v_smfmac_f32_32x32x32_bf16 v[16:31], v[88:91], v[48:55], v209
    s_add_u32 m0, s30, 91136
    s_mov_b32 s14, 0
    v_exp_f32 v62, v62
    buffer_load_dwordx4 v215, s[68:71], s14 offen lds
    v_exp_f32 v63, v63
    s_setprio 1
    v_exp_f32 v32, v32
    v_exp_f32 v33, v33
    s_waitcnt lgkmcnt(0)
    v_smfmac_f32_32x32x32_bf16 v[16:31], v[92:95], v[56:63], v209
    ds_read_b128 v[84:87], v208 offset:51200
    v_exp_f32 v34, v34
    v_exp_f32 v35, v35
    ds_read2st64_b64 v[64:67], v205 offset0:110 offset1:111
    v_exp_f32 v36, v36
    v_exp_f32 v37, v37
    v_mfma_f32_32x32x16_bf16 v[48:63], v[68:71], v[96:99], 0
    v_exp_f32 v38, v38
    v_exp_f32 v39, v39
    ds_read_b128 v[88:91], v207 offset:53760
    v_exp_f32 v40, v40
    v_exp_f32 v41, v41
    v_mfma_f32_32x32x8_bf16 v[48:63], v[78:79], v[100:101], v[48:63]
    v_exp_f32 v42, v42
    v_exp_f32 v43, v43
    v_exp_f32 v44, v44
    v_exp_f32 v45, v45
    v_smfmac_f32_32x32x32_bf16 v[16:31], v[80:83], v[32:39], v209
    s_add_u32 m0, s96, 61440
    s_mov_b32 s14, 0
    v_exp_f32 v46, v46
    buffer_load_dwordx4 v216, s[72:75], s14 offen lds
    v_exp_f32 v47, v47
    s_setprio 0
    v_exp_f32 v48, v48
    v_exp_f32 v49, v49
    s_waitcnt lgkmcnt(0)
    v_smfmac_f32_32x32x32_bf16 v[16:31], v[84:87], v[40:47], v209
    ds_read_b128 v[92:95], v208 offset:53760
    v_exp_f32 v50, v50
    v_exp_f32 v51, v51
    ds_read2st64_b64 v[68:71], v205 offset0:115 offset1:116
    v_exp_f32 v52, v52
    v_exp_f32 v53, v53
    v_mfma_f32_32x32x16_bf16 v[32:47], v[64:67], v[96:99], 0
    v_exp_f32 v54, v54
    v_exp_f32 v55, v55
    ds_read_b128 v[80:83], v207 offset:56320
    v_exp_f32 v56, v56
    v_exp_f32 v57, v57
    v_mfma_f32_32x32x8_bf16 v[32:47], v[76:77], v[102:103], v[32:47]
    v_exp_f32 v58, v58
    v_exp_f32 v59, v59
    v_exp_f32 v60, v60
    v_exp_f32 v61, v61
    v_smfmac_f32_32x32x32_bf16 v[16:31], v[88:91], v[48:55], v209
    s_mul_i32 s15, s23, 165888
    s_add_u32 s15, s15, 0
    s_lshl_b32 s10, s23, 10
    s_add_u32 m0, s10, 149504
    v_exp_f32 v62, v62
    buffer_load_dwordx4 v218, s[76:79], s15 offen lds
    v_exp_f32 v63, v63
    s_waitcnt vmcnt(4)
    s_cmp_lg_u32 s4, 4
    s_cbranch_scc1 L_chk_69
    v_cmp_ne_u32 vcc, s9, v228
    s_nop 0
    s_cmp_eq_u64 vcc, 0
    s_cbranch_scc1 L_chk_69
    s_mov_b32 s92, 0
L_poll_70:
    s_mov_b64 exec, 0x1fff
    buffer_load_dword v228, v224, s[60:63], 0 offen sc1
    s_waitcnt vmcnt(0)
    s_mov_b64 s[10:11], 0
    s_mov_b64 exec, 0x1fff
    v_cmp_ne_u32 vcc, s9, v228
    s_nop 0
    s_or_b64 s[10:11], s[10:11], vcc
    s_mov_b64 exec, -1
    s_cmp_eq_u64 s[10:11], 0
    s_cbranch_scc1 L_pollq_71
    s_add_u32 s92, s92, 1
    s_cmp_gt_u32 s92, 20000
    s_cbranch_scc1 L_pollq_71
    s_sleep 2
    s_branch L_poll_70
L_pollq_71:
L_chk_69:
    s_barrier
    s_setprio 3
    v_exp_f32 v32, v32
    v_exp_f32 v33, v33
    s_waitcnt lgkmcnt(0)
    v_smfmac_f32_32x32x32_bf16 v[16:31], v[92:95], v[56:63], v209
    ds_read_b128 v[84:87], v208 offset:56320
    v_exp_f32 v34, v34
    v_exp_f32 v35, v35
    ds_read2st64_b64 v[64:67], v205 offset0:0 offset1:1
    v_exp_f32 v36, v36
    v_exp_f32 v37, v37
    v_mfma_f32_32x32x16_bf16 v[48:63], v[68:71], v[96:99], 0
    v_exp_f32 v38, v38
    v_exp_f32 v39, v39
    ds_read_b128 v[88:91], v207 offset:58880
    v_exp_f32 v40, v40
    v_exp_f32 v41, v41
    v_mfma_f32_32x32x8_bf16 v[48:63], v[78:79], v[102:103], v[48:63]
    v_exp_f32 v42, v42
    v_exp_f32 v43, v43
    ds_read2st64_b64 v[72:75], v206 offset0:0 offset1:5
    v_exp_f32 v44, v44
    v_exp_f32 v45, v45
    v_smfmac_f32_32x32x32_bf16 v[16:31], v[80:83], v[32:39], v209
    s_add_u32 s94, s94, 294912
    s_add_u32 m0, s93, 20480
    v_exp_f32 v46, v46
    buffer_load_dwordx4 v210, s[60:63], s94 offen sc1 lds
    v_exp_f32 v47, v47
    v_exp_f32 v48, v48
    v_exp_f32 v49, v49
    s_waitcnt lgkmcnt(0)
    v_smfmac_f32_32x32x32_bf16 v[16:31], v[84:87], v[40:47], v209
    ds_read_b128 v[92:95], v208 offset:58880
    v_exp_f32 v50, v50
    v_exp_f32 v51, v51
    ds_read2st64_b64 v[68:71], v205 offset0:5 offset1:6
    v_exp_f32 v52, v52
    v_exp_f32 v53, v53
    v_mfma_f32_32x32x16_bf16 v[32:47], v[64:67], v[96:99], 0
    v_exp_f32 v54, v54
    v_exp_f32 v55, v55
    ds_read_b128 v[80:83], v207 offset:0
    v_exp_f32 v56, v56
    v_exp_f32 v57, v57
    v_mfma_f32_32x32x8_bf16 v[32:47], v[72:73], v[100:101], v[32:47]
    v_exp_f32 v58, v58
    v_exp_f32 v59, v59
    v_exp_f32 v60, v60
    v_exp_f32 v61, v61
    v_smfmac_f32_32x32x32_bf16 v[16:31], v[88:91], v[48:55], v209
    s_add_u32 m0, s93, 21504
    v_exp_f32 v62, v62
    buffer_load_dwordx4 v211, s[60:63], s94 offen sc1 lds
    v_exp_f32 v63, v63
    v_exp_f32 v32, v32
    v_exp_f32 v33, v33
    s_waitcnt lgkmcnt(0)
    v_smfmac_f32_32x32x32_bf16 v[16:31], v[92:95], v[56:63], v209
    ds_read_b128 v[84:87], v208 offset:0
    v_exp_f32 v34, v34
    v_exp_f32 v35, v35
    ds_read2st64_b64 v[64:67], v205 offset0:10 offset1:11
    v_exp_f32 v36, v36
    v_exp_f32 v37, v37
    v_mfma_f32_32x32x16_bf16 v[48:63], v[68:71], v[96:99], 0
    v_exp_f32 v38, v38
    v_exp_f32 v39, v39
    ds_read_b128 v[88:91], v207 offset:2560
    v_exp_f32 v40, v40
    v_exp_f32 v41, v41
    v_mfma_f32_32x32x8_bf16 v[48:63], v[74:75], v[100:101], v[48:63]
    v_exp_f32 v42, v42
    v_exp_f32 v43, v43
    v_exp_f32 v44, v44
    v_exp_f32 v45, v45
    v_smfmac_f32_32x32x32_bf16 v[16:31], v[80:83], v[32:39], v209
    s_add_u32 m0, s93, 22528
    v_exp_f32 v46, v46
    s_mov_b64 exec, 0xffffff
    buffer_load_dwordx4 v212, s[60:63], s94 offen sc1 lds
    s_mov_b64 exec, -1
    v_exp_f32 v47, v47
    v_exp_f32 v48, v48
    v_exp_f32 v49, v49
    s_waitcnt lgkmcnt(0)
    v_smfmac_f32_32x32x32_bf16 v[16:31], v[84:87], v[40:47], v209
    ds_read_b128 v[92:95], v208 offset:2560
    v_exp_f32 v50, v50
    v_exp_f32 v51, v51
    ds_read2st64_b64 v[68:71], v205 offset0:15 offset1:16
    v_exp_f32 v52, v52
    v_exp_f32 v53, v53
    v_mfma_f32_32x32x16_bf16 v[32:47], v[64:67], v[96:99], 0
    v_exp_f32 v54, v54
    v_exp_f32 v55, v55
    ds_read_b128 v[80:83], v207 offset:5120
    v_exp_f32 v56, v56
    v_exp_f32 v57, v57
    v_mfma_f32_32x32x8_bf16 v[32:47], v[72:73], v[102:103], v[32:47]
    v_exp_f32 v58, v58
    v_exp_f32 v59, v59
    v_exp_f32 v60, v60
    v_exp_f32 v61, v61
    v_smfmac_f32_32x32x32_bf16 v[16:31], v[88:91], v[48:55], v209
    s_mul_i32 s10, s23, 6144
    s_add_u32 s24, s95, s10
    s_lshl_b32 s10, s23, 12
    s_add_u32 s25, s95, s10
    s_add_u32 s3, s24, 0
    v_exp_f32 v62, v62
    buffer_load_dwordx4 v[106:109], v221, s[60:63], s3 offen offset:0 sc1
    s_and_b32 s10, s7, 3
    s_lshl_b32 s10, s10, 3
    s_add_u32 s10, s10, s4
    s_cmp_ge_u32 s10, 7
    s_cselect_b32 s52, s68, s64
    s_cselect_b32 s53, s69, s65
    s_cmp_ge_u32 s10, 14
    s_cselect_b32 s52, s76, s52
    s_cselect_b32 s53, s77, s53
    s_mov_b32 s54, 663552
    s_mov_b32 s55, 0x20000
    s_lshl_b64 exec, 0xffff, 0
    buffer_load_dword v255, v226, s[52:55], 0 offen
    s_mov_b64 exec, -1
    v_exp_f32 v63, v63
    s_setprio 2
    v_exp_f32 v32, v32
    v_exp_f32 v33, v33
    s_waitcnt lgkmcnt(0)
    v_smfmac_f32_32x32x32_bf16 v[16:31], v[92:95], v[56:63], v209
    ds_read_b128 v[84:87], v208 offset:5120
    v_exp_f32 v34, v34
    v_exp_f32 v35, v35
    ds_read2st64_b64 v[64:67], v205 offset0:20 offset1:21
    v_exp_f32 v36, v36
    v_exp_f32 v37, v37
    v_mfma_f32_32x32x16_bf16 v[48:63], v[68:71], v[96:99], 0
    v_exp_f32 v38, v38
    v_exp_f32 v39, v39
    ds_read_b128 v[88:91], v207 offset:7680
    v_exp_f32 v40, v40
    v_exp_f32 v41, v41
    v_mfma_f32_32x32x8_bf16 v[48:63], v[74:75], v[102:103], v[48:63]
    v_exp_f32 v42, v42
    v_exp_f32 v43, v43
    ds_read2st64_b64 v[76:79], v206 offset0:20 offset1:25
    v_exp_f32 v44, v44
    v_exp_f32 v45, v45
    v_smfmac_f32_32x32x32_bf16 v[16:31], v[80:83], v[32:39], v209
    v_exp_f32 v46, v46
    buffer_load_dwordx4 v[110:113], v221, s[60:63], s3 offen offset:1024 sc1
    s_lshl_b64 exec, 0xffff, 16
    buffer_load_dword v255, v226, s[52:55], 0 offen
    s_mov_b64 exec, -1
    v_exp_f32 v47, v47
    v_exp_f32 v48, v48
    v_exp_f32 v49, v49
    s_waitcnt lgkmcnt(0)
    v_smfmac_f32_32x32x32_bf16 v[16:31], v[84:87], v[40:47], v209
    ds_read_b128 v[92:95], v208 offset:7680
    v_exp_f32 v50, v50
    v_exp_f32 v51, v51
    ds_read2st64_b64 v[68:71], v205 offset0:25 offset1:26
    v_exp_f32 v52, v52
    v_exp_f32 v53, v53
    v_mfma_f32_32x32x16_bf16 v[32:47], v[64:67], v[96:99], 0
    v_exp_f32 v54, v54
    v_exp_f32 v55, v55
    ds_read_b128 v[80:83], v207 offset:10240
    v_exp_f32 v56, v56
    v_exp_f32 v57, v57
    v_mfma_f32_32x32x8_bf16 v[32:47], v[76:77], v[100:101], v[32:47]
    v_exp_f32 v58, v58
    v_exp_f32 v59, v59
    v_exp_f32 v60, v60
    v_exp_f32 v61, v61
    v_smfmac_f32_32x32x32_bf16 v[16:31], v[88:91], v[48:55], v209
    v_exp_f32 v62, v62
    buffer_load_dwordx4 v[114:117], v221, s[60:63], s3 offen offset:2048 sc1
    v_exp_f32 v63, v63
    s_setprio 1
    v_exp_f32 v32, v32
    v_exp_f32 v33, v33
    s_waitcnt lgkmcnt(0)
    v_smfmac_f32_32x32x32_bf16 v[16:31], v[92:95], v[56:63], v209
    ds_read_b128 v[84:87], v208 offset:10240
    v_exp_f32 v34, v34
    v_exp_f32 v35, v35
    ds_read2st64_b64 v[64:67], v205 offset0:30 offset1:31
    v_exp_f32 v36, v36
    v_exp_f32 v37, v37
    v_mfma_f32_32x32x16_bf16 v[48:63], v[68:71], v[96:99], 0
    v_exp_f32 v38, v38
    v_exp_f32 v39, v39
    ds_read_b128 v[88:91], v207 offset:12800
    v_exp_f32 v40, v40
    v_exp_f32 v41, v41
    v_mfma_f32_32x32x8_bf16 v[48:63], v[78:79], v[100:101], v[48:63]
    v_exp_f32 v42, v42
    v_exp_f32 v43, v43
    v_exp_f32 v44, v44
    v_exp_f32 v45, v45
    v_smfmac_f32_32x32x32_bf16 v[16:31], v[80:83], v[32:39], v209
    v_exp_f32 v46, v46
    buffer_load_dwordx4 v[118:121], v221, s[60:63], s3 offen offset:3072 sc1
    v_exp_f32 v47, v47
    s_setprio 0
    v_exp_f32 v48, v48
    v_exp_f32 v49, v49
    s_waitcnt lgkmcnt(0)
    v_smfmac_f32_32x32x32_bf16 v[16:31], v[84:87], v[40:47], v209
    ds_read_b128 v[92:95], v208 offset:12800
    v_exp_f32 v50, v50
    v_exp_f32 v51, v51
    ds_read2st64_b64 v[68:71], v205 offset0:35 offset1:36
    v_exp_f32 v52, v52
    v_exp_f32 v53, v53
    v_mfma_f32_32x32x16_bf16 v[32:47], v[64:67], v[96:99], 0
    v_exp_f32 v54, v54
    v_exp_f32 v55, v55
    ds_read_b128 v[80:83], v207 offset:15360
    v_exp_f32 v56, v56
    v_exp_f32 v57, v57
    v_mfma_f32_32x32x8_bf16 v[32:47], v[76:77], v[102:103], v[32:47]
    v_exp_f32 v58, v58
    v_exp_f32 v59, v59
    v_exp_f32 v60, v60
    v_exp_f32 v61, v61
    v_smfmac_f32_32x32x32_bf16 v[16:31], v[88:91], v[48:55], v209
    s_add_u32 s3, s24, 4096
    v_exp_f32 v62, v62
    buffer_load_dwordx4 v[122:125], v221, s[60:63], s3 offen offset:0 sc1
    v_exp_f32 v63, v63
    s_waitcnt vmcnt(7)
    s_barrier
    s_setprio 3
    v_exp_f32 v32, v32
    v_exp_f32 v33, v33
    s_waitcnt lgkmcnt(0)
    v_smfmac_f32_32x32x32_bf16 v[16:31], v[92:95], v[56:63], v209
    ds_read_b128 v[84:87], v208 offset:15360
    v_exp_f32 v34, v34
    v_exp_f32 v35, v35
    ds_read2st64_b64 v[64:67], v205 offset0:40 offset1:41
    v_exp_f32 v36, v36
    v_exp_f32 v37, v37
    v_mfma_f32_32x32x16_bf16 v[48:63], v[68:71], v[96:99], 0
    v_exp_f32 v38, v38
    v_exp_f32 v39, v39
    ds_read_b128 v[88:91], v207 offset:17920
    v_exp_f32 v40, v40
    v_exp_f32 v41, v41
    v_mfma_f32_32x32x8_bf16 v[48:63], v[78:79], v[102:103], v[48:63]
    v_exp_f32 v42, v42
    v_exp_f32 v43, v43
    ds_read2st64_b64 v[72:75], v206 offset0:40 offset1:45
    v_exp_f32 v44, v44
    v_exp_f32 v45, v45
    v_smfmac_f32_32x32x32_bf16 v[16:31], v[80:83], v[32:39], v209
    s_add_u32 s94, s94, 294912
    s_add_u32 m0, s93, 40960
    v_exp_f32 v46, v46
    buffer_load_dwordx4 v210, s[60:63], s94 offen sc1 lds
    v_exp_f32 v47, v47
    v_exp_f32 v48, v48
    v_exp_f32 v49, v49
    s_waitcnt lgkmcnt(0)
    v_smfmac_f32_32x32x32_bf16 v[16:31], v[84:87], v[40:47], v209
    ds_read_b128 v[92:95], v208 offset:17920
    v_exp_f32 v50, v50
    v_exp_f32 v51, v51
    ds_read2st64_b64 v[68:71], v205 offset0:45 offset1:46
    v_exp_f32 v52, v52
    v_exp_f32 v53, v53
    v_mfma_f32_32x32x16_bf16 v[32:47], v[64:67], v[96:99], 0
    v_exp_f32 v54, v54
    v_exp_f32 v55, v55
    ds_read_b128 v[80:83], v207 offset:20480
    v_exp_f32 v56, v56
    v_exp_f32 v57, v57
    v_mfma_f32_32x32x8_bf16 v[32:47], v[72:73], v[100:101], v[32:47]
    v_exp_f32 v58, v58
    v_exp_f32 v59, v59
    v_exp_f32 v60, v60
    v_exp_f32 v61, v61
    v_smfmac_f32_32x32x32_bf16 v[16:31], v[88:91], v[48:55], v209
    s_add_u32 m0, s93, 41984
    v_exp_f32 v62, v62
    buffer_load_dwordx4 v211, s[60:63], s94 offen sc1 lds
    v_exp_f32 v63, v63
    v_exp_f32 v32, v32
    v_exp_f32 v33, v33
    s_waitcnt lgkmcnt(0)
    v_smfmac_f32_32x32x32_bf16 v[16:31], v[92:95], v[56:63], v209
    ds_read_b128 v[84:87], v208 offset:20480
    v_exp_f32 v34, v34
    v_exp_f32 v35, v35
    ds_read2st64_b64 v[64:67], v205 offset0:50 offset1:51
    v_exp_f32 v36, v36
    v_exp_f32 v37, v37
    v_mfma_f32_32x32x16_bf16 v[48:63], v[68:71], v[96:99], 0
    v_exp_f32 v38, v38
    v_exp_f32 v39, v39
    ds_read_b128 v[88:91], v207 offset:23040
    v_exp_f32 v40, v40
    v_exp_f32 v41, v41
    v_mfma_f32_32x32x8_bf16 v[48:63], v[74:75], v[100:101], v[48:63]
    v_exp_f32 v42, v42
    v_exp_f32 v43, v43
    v_exp_f32 v44, v44
    v_exp_f32 v45, v45
    v_smfmac_f32_32x32x32_bf16 v[16:31], v[80:83], v[32:39], v209
    s_add_u32 m0, s93, 43008
    v_exp_f32 v46, v46
    s_mov_b64 exec, 0xffffff
    buffer_load_dwordx4 v212, s[60:63], s94 offen sc1 lds
    s_mov_b64 exec, -1
    v_exp_f32 v47, v47
    v_exp_f32 v48, v48
    v_exp_f32 v49, v49
    s_waitcnt lgkmcnt(0)
    v_smfmac_f32_32x32x32_bf16 v[16:31], v[84:87], v[40:47], v209
    ds_read_b128 v[92:95], v208 offset:23040
    v_exp_f32 v50, v50
    v_exp_f32 v51, v51
    ds_read2st64_b64 v[68:71], v205 offset0:55 offset1:56
    v_exp_f32 v52, v52
    v_exp_f32 v53, v53
    v_mfma_f32_32x32x16_bf16 v[32:47], v[64:67], v[96:99], 0
    v_exp_f32 v54, v54
    v_exp_f32 v55, v55
    ds_read_b128 v[80:83], v207 offset:25600
    v_exp_f32 v56, v56
    v_exp_f32 v57, v57
    v_mfma_f32_32x32x8_bf16 v[32:47], v[72:73], v[102:103], v[32:47]
    v_exp_f32 v58, v58
    v_exp_f32 v59, v59
    v_exp_f32 v60, v60
    v_exp_f32 v61, v61
    v_smfmac_f32_32x32x32_bf16 v[16:31], v[88:91], v[48:55], v209
    v_exp_f32 v62, v62
    buffer_load_dwordx4 v[126:129], v221, s[60:63], s3 offen offset:1024 sc1
    s_lshl_b64 exec, 0xffff, 32
    buffer_load_dword v255, v226, s[52:55], 0 offen
    s_mov_b64 exec, -1
    v_exp_f32 v63, v63
    s_setprio 2
    v_exp_f32 v32, v32
    v_exp_f32 v33, v33
    s_waitcnt lgkmcnt(0)
    v_smfmac_f32_32x32x32_bf16 v[16:31], v[92:95], v[56:63], v209
    ds_read_b128 v[84:87], v208 offset:25600
    v_exp_f32 v34, v34
    v_exp_f32 v35, v35
    ds_read2st64_b64 v[64:67], v205 offset0:60 offset1:61
    v_exp_f32 v36, v36
    v_exp_f32 v37, v37
    v_mfma_f32_32x32x16_bf16 v[48:63], v[68:71], v[96:99], 0
    v_exp_f32 v38, v38
    v_exp_f32 v39, v39
    ds_read_b128 v[88:91], v207 offset:28160
    v_exp_f32 v40, v40
    v_exp_f32 v41, v41
    v_mfma_f32_32x32x8_bf16 v[48:63], v[74:75], v[102:103], v[48:63]
    v_exp_f32 v42, v42
    v_exp_f32 v43, v43
    ds_read2st64_b64 v[76:79], v206 offset0:60 offset1:65
    v_exp_f32 v44, v44
    v_exp_f32 v45, v45
    v_smfmac_f32_32x32x32_bf16 v[16:31], v[80:83], v[32:39], v209
    s_add_u32 s3, s25, 24576
    v_exp_f32 v46, v46
    buffer_load_dwordx4 v[130:133], v221, s[60:63], s3 offen offset:0 sc1
    s_lshl_b64 exec, 0xffff, 48
    buffer_load_dword v255, v226, s[52:55], 0 offen
    s_mov_b64 exec, -1
    v_exp_f32 v47, v47
    v_exp_f32 v48, v48
    v_exp_f32 v49, v49
    s_waitcnt lgkmcnt(0)
    v_smfmac_f32_32x32x32_bf16 v[16:31], v[84:87], v[40:47], v209
    ds_read_b128 v[92:95], v208 offset:28160
    v_exp_f32 v50, v50
    v_exp_f32 v51, v51
    ds_read2st64_b64 v[68:71], v205 offset0:65 offset1:66
    v_exp_f32 v52, v52
    v_exp_f32 v53, v53
    v_mfma_f32_32x32x16_bf16 v[32:47], v[64:67], v[96:99], 0
    v_exp_f32 v54, v54
    v_exp_f32 v55, v55
    ds_read_b128 v[80:83], v207 offset:30720
    v_exp_f32 v56, v56
    v_exp_f32 v57, v57
    v_mfma_f32_32x32x8_bf16 v[32:47], v[76:77], v[100:101], v[32:47]
    v_exp_f32 v58, v58
    v_exp_f32 v59, v59
    v_exp_f32 v60, v60
    v_exp_f32 v61, v61
    v_smfmac_f32_32x32x32_bf16 v[16:31], v[88:91], v[48:55], v209
    v_exp_f32 v62, v62
    buffer_load_dwordx4 v[134:137], v221, s[60:63], s3 offen offset:1024 sc1
    v_exp_f32 v63, v63
    s_setprio 1
    v_exp_f32 v32, v32
    v_exp_f32 v33, v33
    s_waitcnt lgkmcnt(0)
    v_smfmac_f32_32x32x32_bf16 v[16:31], v[92:95], v[56:63], v209
    ds_read_b128 v[84:87], v208 offset:30720
    v_exp_f32 v34, v34
    v_exp_f32 v35, v35
    ds_read2st64_b64 v[64:67], v205 offset0:70 offset1:71
    v_exp_f32 v36, v36
    v_exp_f32 v37, v37
    v_mfma_f32_32x32x16_bf16 v[48:63], v[68:71], v[96:99], 0
    v_exp_f32 v38, v38
    v_exp_f32 v39, v39
    ds_read_b128 v[88:91], v207 offset:33280
    v_exp_f32 v40, v40
    v_exp_f32 v41, v41
    v_mfma_f32_32x32x8_bf16 v[48:63], v[78:79], v[100:101], v[48:63]
    v_exp_f32 v42, v42
    v_exp_f32 v43, v43
    v_exp_f32 v44, v44
    v_exp_f32 v45, v45
    v_smfmac_f32_32x32x32_bf16 v[16:31], v[80:83], v[32:39], v209
    v_exp_f32 v46, v46
    buffer_load_dwordx4 v[138:141], v221, s[60:63], s3 offen offset:2048 sc1
    v_exp_f32 v47, v47
    s_setprio 0
    v_exp_f32 v48, v48
    v_exp_f32 v49, v49
    s_waitcnt lgkmcnt(0)
    v_smfmac_f32_32x32x32_bf16 v[16:31], v[84:87], v[40:47], v209
    ds_read_b128 v[92:95], v208 offset:33280
    v_exp_f32 v50, v50
    v_exp_f32 v51, v51
    ds_read2st64_b64 v[68:71], v205 offset0:75 offset1:76
    v_exp_f32 v52, v52
    v_exp_f32 v53, v53
    v_mfma_f32_32x32x16_bf16 v[32:47], v[64:67], v[96:99], 0
    v_exp_f32 v54, v54
    v_exp_f32 v55, v55
    ds_read_b128 v[80:83], v207 offset:35840
    v_exp_f32 v56, v56
    v_exp_f32 v57, v57
    v_mfma_f32_32x32x8_bf16 v[32:47], v[76:77], v[102:103], v[32:47]
    v_exp_f32 v58, v58
    v_exp_f32 v59, v59
    v_exp_f32 v60, v60
    v_exp_f32 v61, v61
    v_smfmac_f32_32x32x32_bf16 v[16:31], v[88:91], v[48:55], v209
    v_exp_f32 v62, v62
    buffer_load_dwordx4 v[142:145], v221, s[60:63], s3 offen offset:3072 sc1
    v_exp_f32 v63, v63
    s_waitcnt vmcnt(7)
    s_barrier
    s_setprio 3
    v_exp_f32 v32, v32
    v_exp_f32 v33, v33
    s_waitcnt lgkmcnt(0)
    v_smfmac_f32_32x32x32_bf16 v[16:31], v[92:95], v[56:63], v209
    ds_read_b128 v[84:87], v208 offset:35840
    v_exp_f32 v34, v34
    v_exp_f32 v35, v35
    ds_read2st64_b64 v[64:67], v205 offset0:80 offset1:81
    v_exp_f32 v36, v36
    v_exp_f32 v37, v37
    v_mfma_f32_32x32x16_bf16 v[48:63], v[68:71], v[96:99], 0
    v_exp_f32 v38, v38
    v_exp_f32 v39, v39
    ds_read_b128 v[88:91], v207 offset:38400
    v_exp_f32 v40, v40
    v_exp_f32 v41, v41
    v_mfma_f32_32x32x8_bf16 v[48:63], v[78:79], v[102:103], v[48:63]
    v_exp_f32 v42, v42
    v_exp_f32 v43, v43
    ds_read2st64_b64 v[72:75], v206 offset0:80 offset1:85
    v_exp_f32 v44, v44
    v_exp_f32 v45, v45
    v_smfmac_f32_32x32x32_bf16 v[16:31], v[80:83], v[32:39], v209
    s_add_u32 s94, s94, 294912
    s_add_u32 m0, s93, 0
    v_exp_f32 v46, v46
    buffer_load_dwordx4 v210, s[60:63], s94 offen sc1 lds
    v_exp_f32 v47, v47
    v_exp_f32 v48, v48
    v_exp_f32 v49, v49
    s_waitcnt lgkmcnt(0)
    v_smfmac_f32_32x32x32_bf16 v[16:31], v[84:87], v[40:47], v209
    ds_read_b128 v[92:95], v208 offset:38400
    v_exp_f32 v50, v50
    v_exp_f32 v51, v51
    ds_read2st64_b64 v[68:71], v205 offset0:85 offset1:86
    v_exp_f32 v52, v52
    v_exp_f32 v53, v53
    v_mfma_f32_32x32x16_bf16 v[32:47], v[64:67], v[96:99], 0
    v_exp_f32 v54, v54
    v_exp_f32 v55, v55
    ds_read_b128 v[80:83], v207 offset:40960
    v_exp_f32 v56, v56
    v_exp_f32 v57, v57
    v_mfma_f32_32x32x8_bf16 v[32:47], v[72:73], v[100:101], v[32:47]
    v_exp_f32 v58, v58
    v_exp_f32 v59, v59
    v_exp_f32 v60, v60
    v_exp_f32 v61, v61
    v_smfmac_f32_32x32x32_bf16 v[16:31], v[88:91], v[48:55], v209
    s_add_u32 m0, s93, 1024
    v_exp_f32 v62, v62
    buffer_load_dwordx4 v211, s[60:63], s94 offen sc1 lds
    v_exp_f32 v63, v63
    v_exp_f32 v32, v32
    v_exp_f32 v33, v33
    s_waitcnt lgkmcnt(0)
    v_smfmac_f32_32x32x32_bf16 v[16:31], v[92:95], v[56:63], v209
    ds_read_b128 v[84:87], v208 offset:40960
    v_exp_f32 v34, v34
    v_exp_f32 v35, v35
    ds_read2st64_b64 v[64:67], v205 offset0:90 offset1:91
    v_exp_f32 v36, v36
    v_exp_f32 v37, v37
    v_mfma_f32_32x32x16_bf16 v[48:63], v[68:71], v[96:99], 0
    v_exp_f32 v38, v38
    v_exp_f32 v39, v39
    ds_read_b128 v[88:91], v207 offset:43520
    v_exp_f32 v40, v40
    v_exp_f32 v41, v41
    v_mfma_f32_32x32x8_bf16 v[48:63], v[74:75], v[100:101], v[48:63]
    v_exp_f32 v42, v42
    v_exp_f32 v43, v43
    v_exp_f32 v44, v44
    v_exp_f32 v45, v45
    v_smfmac_f32_32x32x32_bf16 v[16:31], v[80:83], v[32:39], v209
    s_add_u32 m0, s93, 2048
    v_exp_f32 v46, v46
    s_mov_b64 exec, 0xffffff
    buffer_load_dwordx4 v212, s[60:63], s94 offen sc1 lds
    s_mov_b64 exec, -1
    v_exp_f32 v47, v47
    v_exp_f32 v48, v48
    v_exp_f32 v49, v49
    s_waitcnt lgkmcnt(0)
    v_smfmac_f32_32x32x32_bf16 v[16:31], v[84:87], v[40:47], v209
    ds_read_b128 v[92:95], v208 offset:43520
    v_exp_f32 v50, v50
    v_exp_f32 v51, v51
    ds_read2st64_b64 v[68:71], v205 offset0:95 offset1:96
    v_exp_f32 v52, v52
    v_exp_f32 v53, v53
    v_mfma_f32_32x32x16_bf16 v[32:47], v[64:67], v[96:99], 0
    v_exp_f32 v54, v54
    v_exp_f32 v55, v55
    ds_read_b128 v[80:83], v207 offset:46080
    v_exp_f32 v56, v56
    v_exp_f32 v57, v57
    v_mfma_f32_32x32x8_bf16 v[32:47], v[72:73], v[102:103], v[32:47]
    v_exp_f32 v58, v58
    v_exp_f32 v59, v59
    v_exp_f32 v60, v60
    v_exp_f32 v61, v61
    v_smfmac_f32_32x32x32_bf16 v[16:31], v[88:91], v[48:55], v209
    s_add_u32 s3, s25, 40960
    v_exp_f32 v62, v62
    buffer_load_dwordx4 v[146:149], v221, s[60:63], s3 offen offset:0 sc1
    s_mul_i32 s15, s23, 165888
    s_add_u32 s15, s15, 82944
    s_lshl_b32 s10, s23, 10
    s_add_u32 m0, s10, 153600
    s_nop 0
    buffer_load_dwordx4 v218, s[76:79], s15 offen lds
    v_exp_f32 v63, v63
    s_setprio 2
    v_exp_f32 v32, v32
    v_exp_f32 v33, v33
    s_waitcnt lgkmcnt(0)
    v_smfmac_f32_32x32x32_bf16 v[16:31], v[92:95], v[56:63], v209
    ds_read_b128 v[84:87], v208 offset:46080
    v_exp_f32 v34, v34
    v_exp_f32 v35, v35
    ds_read2st64_b64 v[64:67], v205 offset0:100 offset1:101
    v_exp_f32 v36, v36
    v_exp_f32 v37, v37
    v_mfma_f32_32x32x16_bf16 v[48:63], v[68:71], v[96:99], 0
    v_exp_f32 v38, v38
    v_exp_f32 v39, v39
    ds_read_b128 v[88:91], v207 offset:48640
    v_exp_f32 v40, v40
    v_exp_f32 v41, v41
    v_mfma_f32_32x32x8_bf16 v[48:63], v[74:75], v[102:103], v[48:63]
    v_exp_f32 v42, v42
    v_exp_f32 v43, v43
    ds_read2st64_b64 v[76:79], v206 offset0:100 offset1:105
    v_exp_f32 v44, v44
    v_exp_f32 v45, v45
    v_smfmac_f32_32x32x32_bf16 v[16:31], v[80:83], v[32:39], v209
    v_exp_f32 v46, v46
    buffer_load_dwordx4 v[150:153], v221, s[60:63], s3 offen offset:1024 sc1
    s_mul_i32 s15, s4, 82944
    s_lshl_b32 s10, s4, 7
    s_add_u32 m0, s10, 157696
    s_mov_b64 exec, 0xff
    buffer_load_dwordx4 v220, s[76:79], s15 offen lds
    s_mov_b64 exec, -1
    v_exp_f32 v47, v47
    v_exp_f32 v48, v48
    v_exp_f32 v49, v49
    s_waitcnt lgkmcnt(0)
    v_smfmac_f32_32x32x32_bf16 v[16:31], v[84:87], v[40:47], v209
    ds_read_b128 v[92:95], v208 offset:48640
    v_exp_f32 v50, v50
    v_exp_f32 v51, v51
    ds_read2st64_b64 v[68:71], v205 offset0:105 offset1:106
    v_exp_f32 v52, v52
    v_exp_f32 v53, v53
    v_mfma_f32_32x32x16_bf16 v[32:47], v[64:67], v[96:99], 0
    v_exp_f32 v54, v54
    v_exp_f32 v55, v55
    ds_read_b128 v[80:83], v207 offset:51200
    v_exp_f32 v56, v56
    v_exp_f32 v57, v57
    v_mfma_f32_32x32x8_bf16 v[32:47], v[76:77], v[100:101], v[32:47]
    v_exp_f32 v58, v58
    v_exp_f32 v59, v59
    v_exp_f32 v60, v60
    v_exp_f32 v61, v61
    v_smfmac_f32_32x32x32_bf16 v[16:31], v[88:91], v[48:55], v209
    v_exp_f32 v62, v62
    buffer_load_dwordx4 v[154:157], v221, s[60:63], s3 offen offset:2048 sc1
    v_exp_f32 v63, v63
    s_setprio 1
    v_exp_f32 v32, v32
    v_exp_f32 v33, v33
    s_waitcnt lgkmcnt(0)
    v_smfmac_f32_32x32x32_bf16 v[16:31], v[92:95], v[56:63], v209
    ds_read_b128 v[84:87], v208 offset:51200
    v_exp_f32 v34, v34
    v_exp_f32 v35, v35
    ds_read2st64_b64 v[64:67], v205 offset0:110 offset1:111
    v_exp_f32 v36, v36
    v_exp_f32 v37, v37
    v_mfma_f32_32x32x16_bf16 v[48:63], v[68:71], v[96:99], 0
    v_exp_f32 v38, v38
    v_exp_f32 v39, v39
    ds_read_b128 v[88:91], v207 offset:53760
    v_exp_f32 v40, v40
    v_exp_f32 v41, v41
    v_mfma_f32_32x32x8_bf16 v[48:63], v[78:79], v[100:101], v[48:63]
    v_exp_f32 v42, v42
    v_exp_f32 v43, v43
    v_exp_f32 v44, v44
    v_exp_f32 v45, v45
    v_smfmac_f32_32x32x32_bf16 v[16:31], v[80:83], v[32:39], v209
    v_exp_f32 v46, v46
    buffer_load_dwordx4 v[158:161], v221, s[60:63], s3 offen offset:3072 sc1
    v_exp_f32 v47, v47
    s_setprio 0
    v_exp_f32 v48, v48
    v_exp_f32 v49, v49
    s_waitcnt lgkmcnt(0)
    v_smfmac_f32_32x32x32_bf16 v[16:31], v[84:87], v[40:47], v209
    ds_read_b128 v[92:95], v208 offset:53760
    v_exp_f32 v50, v50
    v_exp_f32 v51, v51
    ds_read2st64_b64 v[68:71], v205 offset0:115 offset1:116
    v_exp_f32 v52, v52
    v_exp_f32 v53, v53
    v_mfma_f32_32x32x16_bf16 v[32:47], v[64:67], v[96:99], 0
    v_exp_f32 v54, v54
    v_exp_f32 v55, v55
    ds_read_b128 v[80:83], v207 offset:56320
    v_exp_f32 v56, v56
    v_exp_f32 v57, v57
    v_mfma_f32_32x32x8_bf16 v[32:47], v[76:77], v[102:103], v[32:47]
    v_exp_f32 v58, v58
    v_exp_f32 v59, v59
    v_exp_f32 v60, v60
    v_exp_f32 v61, v61
    v_smfmac_f32_32x32x32_bf16 v[16:31], v[88:91], v[48:55], v209
    s_add_u32 s3, s25, 57344
    v_exp_f32 v62, v62
    buffer_load_dwordx4 v[162:165], v221, s[60:63], s3 offen offset:0 sc1
    v_exp_f32 v63, v63
    s_waitcnt vmcnt(7)
    s_barrier
    s_setprio 3
    v_exp_f32 v32, v32
    v_exp_f32 v33, v33
    s_waitcnt lgkmcnt(0)
    v_smfmac_f32_32x32x32_bf16 v[16:31], v[92:95], v[56:63], v209
    ds_read_b128 v[84:87], v208 offset:56320
    v_exp_f32 v34, v34
    v_exp_f32 v35, v35
    ds_read2st64_b64 v[64:67], v205 offset0:0 offset1:1
    v_exp_f32 v36, v36
    v_exp_f32 v37, v37
    v_mfma_f32_32x32x16_bf16 v[48:63], v[68:71], v[96:99], 0
    v_exp_f32 v38, v38
    v_exp_f32 v39, v39
    ds_read_b128 v[88:91], v207 offset:58880
    v_exp_f32 v40, v40
    v_exp_f32 v41, v41
    v_mfma_f32_32x32x8_bf16 v[48:63], v[78:79], v[102:103], v[48:63]
    v_exp_f32 v42, v42
    v_exp_f32 v43, v43
    ds_read2st64_b64 v[72:75], v206 offset0:0 offset1:5
    v_exp_f32 v44, v44
    v_exp_f32 v45, v45
    v_smfmac_f32_32x32x32_bf16 v[16:31], v[80:83], v[32:39], v209
    s_add_u32 s94, s94, 294912
    s_add_u32 m0, s93, 20480
    v_exp_f32 v46, v46
    buffer_load_dwordx4 v210, s[60:63], s94 offen sc1 lds
    v_exp_f32 v47, v47
    v_exp_f32 v48, v48
    v_exp_f32 v49, v49
    s_waitcnt lgkmcnt(0)
    v_smfmac_f32_32x32x32_bf16 v[16:31], v[84:87], v[40:47], v209
    ds_read_b128 v[92:95], v208 offset:58880
    v_exp_f32 v50, v50
    v_exp_f32 v51, v51
    ds_read2st64_b64 v[68:71], v205 offset0:5 offset1:6
    v_exp_f32 v52, v52
    v_exp_f32 v53, v53
    v_mfma_f32_32x32x16_bf16 v[32:47], v[64:67], v[96:99], 0
    v_exp_f32 v54, v54
    v_exp_f32 v55, v55
    ds_read_b128 v[80:83], v207 offset:0
    v_exp_f32 v56, v56
    v_exp_f32 v57, v57
    v_mfma_f32_32x32x8_bf16 v[32:47], v[72:73], v[100:101], v[32:47]
    v_exp_f32 v58, v58
    v_exp_f32 v59, v59
    v_exp_f32 v60, v60
    v_exp_f32 v61, v61
    v_smfmac_f32_32x32x32_bf16 v[16:31], v[88:91], v[48:55], v209
    s_add_u32 m0, s93, 21504
    v_exp_f32 v62, v62
    buffer_load_dwordx4 v211, s[60:63], s94 offen sc1 lds
    v_exp_f32 v63, v63
    v_exp_f32 v32, v32
    v_exp_f32 v33, v33
    s_waitcnt lgkmcnt(0)
    v_smfmac_f32_32x32x32_bf16 v[16:31], v[92:95], v[56:63], v209
    ds_read_b128 v[84:87], v208 offset:0
    v_exp_f32 v34, v34
    v_exp_f32 v35, v35
    ds_read2st64_b64 v[64:67], v205 offset0:10 offset1:11
    v_exp_f32 v36, v36
    v_exp_f32 v37, v37
    v_mfma_f32_32x32x16_bf16 v[48:63], v[68:71], v[96:99], 0
    v_exp_f32 v38, v38
    v_exp_f32 v39, v39
    ds_read_b128 v[88:91], v207 offset:2560
    v_exp_f32 v40, v40
    v_exp_f32 v41, v41
    v_mfma_f32_32x32x8_bf16 v[48:63], v[74:75], v[100:101], v[48:63]
    v_exp_f32 v42, v42
    v_exp_f32 v43, v43
    v_exp_f32 v44, v44
    v_exp_f32 v45, v45
    v_smfmac_f32_32x32x32_bf16 v[16:31], v[80:83], v[32:39], v209
    s_add_u32 m0, s93, 22528
    v_exp_f32 v46, v46
    s_mov_b64 exec, 0xffffff
    buffer_load_dwordx4 v212, s[60:63], s94 offen sc1 lds
    s_mov_b64 exec, -1
    v_exp_f32 v47, v47
    v_exp_f32 v48, v48
    v_exp_f32 v49, v49
    s_waitcnt lgkmcnt(0)
    v_smfmac_f32_32x32x32_bf16 v[16:31], v[84:87], v[40:47], v209
    ds_read_b128 v[92:95], v208 offset:2560
    v_exp_f32 v50, v50
    v_exp_f32 v51, v51
    ds_read2st64_b64 v[68:71], v205 offset0:15 offset1:16
    v_exp_f32 v52, v52
    v_exp_f32 v53, v53
    v_mfma_f32_32x32x16_bf16 v[32:47], v[64:67], v[96:99], 0
    v_exp_f32 v54, v54
    v_exp_f32 v55, v55
    ds_read_b128 v[80:83], v207 offset:5120
    v_exp_f32 v56, v56
    v_exp_f32 v57, v57
    v_mfma_f32_32x32x8_bf16 v[32:47], v[72:73], v[102:103], v[32:47]
    v_exp_f32 v58, v58
    v_exp_f32 v59, v59
    v_exp_f32 v60, v60
    v_exp_f32 v61, v61
    v_smfmac_f32_32x32x32_bf16 v[16:31], v[88:91], v[48:55], v209
    v_exp_f32 v62, v62
    buffer_load_dwordx4 v[166:169], v221, s[60:63], s3 offen offset:1024 sc1
    s_lshl_b32 s13, s7, 8
    s_lshr_b32 s10, s7, 1
    s_lshl_b32 s10, s10, 9
    s_add_u32 s13, s13, s10
    s_add_u32 s13, s13, 328192
    s_lshl_b32 s10, s22, 7
    s_add_u32 s10, s13, s10
    buffer_load_dword v105, v15, s[60:63], s10 offen sc1
    v_exp_f32 v63, v63
    s_setprio 2
    v_exp_f32 v32, v32
    v_exp_f32 v33, v33
    s_waitcnt lgkmcnt(0)
    v_smfmac_f32_32x32x32_bf16 v[16:31], v[92:95], v[56:63], v209
    ds_read_b128 v[84:87], v208 offset:5120
    v_exp_f32 v34, v34
    v_exp_f32 v35, v35
    ds_read2st64_b64 v[64:67], v205 offset0:20 offset1:21
    v_exp_f32 v36, v36
    v_exp_f32 v37, v37
    v_mfma_f32_32x32x16_bf16 v[48:63], v[68:71], v[96:99], 0
    v_exp_f32 v38, v38
    v_exp_f32 v39, v39
    ds_read_b128 v[88:91], v207 offset:7680
    v_exp_f32 v40, v40
    v_exp_f32 v41, v41
    v_mfma_f32_32x32x8_bf16 v[48:63], v[74:75], v[102:103], v[48:63]
    v_exp_f32 v42, v42
    v_exp_f32 v43, v43
    ds_read2st64_b64 v[76:79], v206 offset0:20 offset1:25
    v_exp_f32 v44, v44
    v_exp_f32 v45, v45
    v_smfmac_f32_32x32x32_bf16 v[16:31], v[80:83], v[32:39], v209
    v_exp_f32 v46, v46
    buffer_load_dwordx4 v[170:173], v221, s[60:63], s3 offen offset:2048 sc1
    v_exp_f32 v47, v47
    v_exp_f32 v48, v48
    v_exp_f32 v49, v49
    s_waitcnt lgkmcnt(0)
    v_smfmac_f32_32x32x32_bf16 v[16:31], v[84:87], v[40:47], v209
    ds_read_b128 v[92:95], v208 offset:7680
    v_exp_f32 v50, v50
    v_exp_f32 v51, v51
    ds_read2st64_b64 v[68:71], v205 offset0:25 offset1:26
    v_exp_f32 v52, v52
    v_exp_f32 v53, v53
    v_mfma_f32_32x32x16_bf16 v[32:47], v[64:67], v[96:99], 0
    v_exp_f32 v54, v54
    v_exp_f32 v55, v55
    ds_read_b128 v[80:83], v207 offset:10240
    v_exp_f32 v56, v56
    v_exp_f32 v57, v57
    v_mfma_f32_32x32x8_bf16 v[32:47], v[76:77], v[100:101], v[32:47]
    v_exp_f32 v58, v58
    v_exp_f32 v59, v59
    v_exp_f32 v60, v60
    v_exp_f32 v61, v61
    v_smfmac_f32_32x32x32_bf16 v[16:31], v[88:91], v[48:55], v209
    v_exp_f32 v62, v62
    buffer_load_dwordx4 v[174:177], v221, s[60:63], s3 offen offset:3072 sc1
    v_exp_f32 v63, v63
    s_setprio 1
    v_exp_f32 v32, v32
    v_exp_f32 v33, v33
    s_waitcnt lgkmcnt(0)
    v_smfmac_f32_32x32x32_bf16 v[16:31], v[92:95], v[56:63], v209
    ds_read_b128 v[84:87], v208 offset:10240
    v_exp_f32 v34, v34
    v_exp_f32 v35, v35
    ds_read2st64_b64 v[64:67], v205 offset0:30 offset1:31
    v_exp_f32 v36, v36
    v_exp_f32 v37, v37
    v_mfma_f32_32x32x16_bf16 v[48:63], v[68:71], v[96:99], 0
    v_exp_f32 v38, v38
    v_exp_f32 v39, v39
    ds_read_b128 v[88:91], v207 offset:12800
    v_exp_f32 v40, v40
    v_exp_f32 v41, v41
    v_mfma_f32_32x32x8_bf16 v[48:63], v[78:79], v[100:101], v[48:63]
    v_exp_f32 v42, v42
    v_exp_f32 v43, v43
    v_exp_f32 v44, v44
    v_exp_f32 v45, v45
    v_smfmac_f32_32x32x32_bf16 v[16:31], v[80:83], v[32:39], v209
    s_add_u32 s15, s97, 0
    s_add_u32 m0, s98, 116736
    v_exp_f32 v46, v46
    buffer_load_dwordx4 v217, s[76:79], s15 offen lds
    v_exp_f32 v47, v47
    s_setprio 0
    v_exp_f32 v48, v48
    v_exp_f32 v49, v49
    s_waitcnt lgkmcnt(0)
    v_smfmac_f32_32x32x32_bf16 v[16:31], v[84:87], v[40:47], v209
    ds_read_b128 v[92:95], v208 offset:12800
    v_exp_f32 v50, v50
    v_exp_f32 v51, v51
    ds_read2st64_b64 v[68:71], v205 offset0:35 offset1:36
    v_exp_f32 v52, v52
    v_exp_f32 v53, v53
    v_mfma_f32_32x32x16_bf16 v[32:47], v[64:67], v[96:99], 0
    v_exp_f32 v54, v54
    v_exp_f32 v55, v55
    ds_read_b128 v[80:83], v207 offset:15360
    v_exp_f32 v56, v56
    v_exp_f32 v57, v57
    v_mfma_f32_32x32x8_bf16 v[32:47], v[76:77], v[102:103], v[32:47]
    v_exp_f32 v58, v58
    v_exp_f32 v59, v59
    v_exp_f32 v60, v60
    v_exp_f32 v61, v61
    v_smfmac_f32_32x32x32_bf16 v[16:31], v[88:91], v[48:55], v209
    s_add_u32 s15, s97, 9216
    s_add_u32 m0, s98, 117760
    v_exp_f32 v62, v62
    buffer_load_dwordx4 v217, s[76:79], s15 offen lds
    v_exp_f32 v63, v63
    s_waitcnt vmcnt(6)
    s_barrier
    s_setprio 3
    v_exp_f32 v32, v32
    v_exp_f32 v33, v33
    s_waitcnt lgkmcnt(0)
    v_smfmac_f32_32x32x32_bf16 v[16:31], v[92:95], v[56:63], v209
    ds_read_b128 v[84:87], v208 offset:15360
    v_exp_f32 v34, v34
    v_exp_f32 v35, v35
    ds_read2st64_b64 v[64:67], v205 offset0:40 offset1:41
    v_exp_f32 v36, v36
    v_exp_f32 v37, v37
    v_mfma_f32_32x32x16_bf16 v[48:63], v[68:71], v[96:99], 0
    v_exp_f32 v38, v38
    v_exp_f32 v39, v39
    ds_read_b128 v[88:91], v207 offset:17920
    v_exp_f32 v40, v40
    v_exp_f32 v41, v41
    v_mfma_f32_32x32x8_bf16 v[48:63], v[78:79], v[102:103], v[48:63]
    v_exp_f32 v42, v42
    v_exp_f32 v43, v43
    ds_read2st64_b64 v[72:75], v206 offset0:40 offset1:45
    v_exp_f32 v44, v44
    v_exp_f32 v45, v45
    v_smfmac_f32_32x32x32_bf16 v[16:31], v[80:83], v[32:39], v209
    s_add_u32 s15, s97, 20736
    s_add_u32 m0, s98, 118784
    v_exp_f32 v46, v46
    buffer_load_dwordx4 v217, s[76:79], s15 offen lds
    v_exp_f32 v47, v47
    v_exp_f32 v48, v48
    v_exp_f32 v49, v49
    s_waitcnt lgkmcnt(0)
    v_smfmac_f32_32x32x32_bf16 v[16:31], v[84:87], v[40:47], v209
    ds_read_b128 v[92:95], v208 offset:17920
    v_exp_f32 v50, v50
    v_exp_f32 v51, v51
    ds_read2st64_b64 v[68:71], v205 offset0:45 offset1:46
    v_exp_f32 v52, v52
    v_exp_f32 v53, v53
    v_mfma_f32_32x32x16_bf16 v[32:47], v[64:67], v[96:99], 0
    v_exp_f32 v54, v54
    v_exp_f32 v55, v55
    ds_read_b128 v[80:83], v207 offset:20480
    v_exp_f32 v56, v56
    v_exp_f32 v57, v57
    v_mfma_f32_32x32x8_bf16 v[32:47], v[72:73], v[100:101], v[32:47]
    v_exp_f32 v58, v58
    v_exp_f32 v59, v59
    v_exp_f32 v60, v60
    v_exp_f32 v61, v61
    v_smfmac_f32_32x32x32_bf16 v[16:31], v[88:91], v[48:55], v209
    s_add_u32 s15, s97, 29952
    s_add_u32 m0, s98, 119808
    v_exp_f32 v62, v62
    buffer_load_dwordx4 v217, s[76:79], s15 offen lds
    v_exp_f32 v63, v63
    v_exp_f32 v32, v32
    v_exp_f32 v33, v33
    s_waitcnt lgkmcnt(0)
    v_smfmac_f32_32x32x32_bf16 v[16:31], v[92:95], v[56:63], v209
    ds_read_b128 v[84:87], v208 offset:20480
    v_exp_f32 v34, v34
    v_exp_f32 v35, v35
    ds_read2st64_b64 v[64:67], v205 offset0:50 offset1:51
    v_exp_f32 v36, v36
    v_exp_f32 v37, v37
    v_mfma_f32_32x32x16_bf16 v[48:63], v[68:71], v[96:99], 0
    v_exp_f32 v38, v38
    v_exp_f32 v39, v39
    ds_read_b128 v[88:91], v207 offset:23040
    v_exp_f32 v40, v40
    v_exp_f32 v41, v41
    v_mfma_f32_32x32x8_bf16 v[48:63], v[74:75], v[100:101], v[48:63]
    v_exp_f32 v42, v42
    v_exp_f32 v43, v43
    v_exp_f32 v44, v44
    v_exp_f32 v45, v45
    v_smfmac_f32_32x32x32_bf16 v[16:31], v[80:83], v[32:39], v209
    s_lshl_b32 s10, s23, 3
    s_add_u32 s10, s10, s22
    s_mul_i32 s15, s10, 20736
    s_add_u32 s15, s15, 82944
    s_lshl_b32 s10, s4, 11
    s_add_u32 m0, s10, 40960
    v_exp_f32 v46, v46
    buffer_load_dwordx4 v217, s[76:79], s15 offen lds
    v_exp_f32 v47, v47
    v_exp_f32 v48, v48
    v_exp_f32 v49, v49
    s_waitcnt lgkmcnt(0)
    v_smfmac_f32_32x32x32_bf16 v[16:31], v[84:87], v[40:47], v209
    ds_read_b128 v[92:95], v208 offset:23040
    v_exp_f32 v50, v50
    v_exp_f32 v51, v51
    ds_read2st64_b64 v[68:71], v205 offset0:55 offset1:56
    v_exp_f32 v52, v52
    v_exp_f32 v53, v53
    v_mfma_f32_32x32x16_bf16 v[32:47], v[64:67], v[96:99], 0
    v_exp_f32 v54, v54
    v_exp_f32 v55, v55
    ds_read_b128 v[80:83], v207 offset:25600
    v_exp_f32 v56, v56
    v_exp_f32 v57, v57
    v_mfma_f32_32x32x8_bf16 v[32:47], v[72:73], v[102:103], v[32:47]
    v_exp_f32 v58, v58
    v_exp_f32 v59, v59
    v_exp_f32 v60, v60
    v_exp_f32 v61, v61
    v_smfmac_f32_32x32x32_bf16 v[16:31], v[88:91], v[48:55], v209
    s_lshl_b32 s10, s23, 3
    s_add_u32 s10, s10, s22
    s_mul_i32 s15, s10, 20736
    s_add_u32 s15, s15, 92160
    s_lshl_b32 s10, s4, 11
    s_add_u32 m0, s10, 41984
    v_exp_f32 v62, v62
    buffer_load_dwordx4 v217, s[76:79], s15 offen lds
    v_exp_f32 v63, v63
    v_exp_f32 v32, v32
    v_exp_f32 v33, v33
    s_waitcnt lgkmcnt(0)
    v_smfmac_f32_32x32x32_bf16 v[16:31], v[92:95], v[56:63], v209
    ds_read_b128 v[84:87], v208 offset:25600
    v_exp_f32 v34, v34
    v_exp_f32 v35, v35
    ds_read2st64_b64 v[64:67], v205 offset0:60 offset1:61
    v_exp_f32 v36, v36
    v_exp_f32 v37, v37
    v_mfma_f32_32x32x16_bf16 v[48:63], v[68:71], v[96:99], 0
    v_exp_f32 v38, v38
    v_exp_f32 v39, v39
    ds_read_b128 v[88:91], v207 offset:28160
    v_exp_f32 v40, v40
    v_exp_f32 v41, v41
    v_mfma_f32_32x32x8_bf16 v[48:63], v[74:75], v[102:103], v[48:63]
    v_exp_f32 v42, v42
    v_exp_f32 v43, v43
    ds_read2st64_b64 v[76:79], v206 offset0:60 offset1:65
    v_exp_f32 v44, v44
    v_exp_f32 v45, v45
    v_smfmac_f32_32x32x32_bf16 v[16:31], v[80:83], v[32:39], v209
    v_exp_f32 v46, v46
    v_lshrrev_b32 v4, 1, v237
    buffer_load_dwordx2 v[178:179], v4, s[48:51], 0 offen
    global_load_dwordx2 v[184:185], v240, s[38:39]
    buffer_load_dword v190, v243, s[60:63], s13 offen sc1
    v_exp_f32 v47, v47
    v_exp_f32 v48, v48
    v_exp_f32 v49, v49
    s_waitcnt lgkmcnt(0)
    v_smfmac_f32_32x32x32_bf16 v[16:31], v[84:87], v[40:47], v209
    ds_read_b128 v[92:95], v208 offset:28160
    v_exp_f32 v50, v50
    v_exp_f32 v51, v51
    ds_read2st64_b64 v[68:71], v205 offset0:65 offset1:66
    v_exp_f32 v52, v52
    v_exp_f32 v53, v53
    v_mfma_f32_32x32x16_bf16 v[32:47], v[64:67], v[96:99], 0
    v_exp_f32 v54, v54
    v_exp_f32 v55, v55
    ds_read_b128 v[80:83], v207 offset:30720
    v_exp_f32 v56, v56
    v_exp_f32 v57, v57
    v_mfma_f32_32x32x8_bf16 v[32:47], v[76:77], v[100:101], v[32:47]
    v_exp_f32 v58, v58
    v_exp_f32 v59, v59
    v_exp_f32 v60, v60
    v_exp_f32 v61, v61
    v_smfmac_f32_32x32x32_bf16 v[16:31], v[88:91], v[48:55], v209
    v_exp_f32 v62, v62
    v_lshrrev_b32 v4, 1, v238
    buffer_load_dwordx2 v[180:181], v4, s[48:51], 0 offen
    global_load_dwordx2 v[186:187], v241, s[38:39]
    buffer_load_dword v191, v244, s[60:63], s13 offen sc1
    v_exp_f32 v63, v63
    s_setprio 2
    v_exp_f32 v32, v32
    v_exp_f32 v33, v33
    s_waitcnt lgkmcnt(0)
    v_smfmac_f32_32x32x32_bf16 v[16:31], v[92:95], v[56:63], v209
    ds_read_b128 v[84:87], v208 offset:30720
    v_exp_f32 v34, v34
    v_exp_f32 v35, v35
    ds_read2st64_b64 v[64:67], v205 offset0:70 offset1:71
    v_exp_f32 v36, v36
    v_exp_f32 v37, v37
    v_mfma_f32_32x32x16_bf16 v[48:63], v[68:71], v[96:99], 0
    v_exp_f32 v38, v38
    v_exp_f32 v39, v39
    ds_read_b128 v[88:91], v207 offset:33280
    v_exp_f32 v40, v40
    v_exp_f32 v41, v41
    v_mfma_f32_32x32x8_bf16 v[48:63], v[78:79], v[100:101], v[48:63]
    v_exp_f32 v42, v42
    v_exp_f32 v43, v43
    v_exp_f32 v44, v44
    v_exp_f32 v45, v45
    v_smfmac_f32_32x32x32_bf16 v[16:31], v[80:83], v[32:39], v209
    v_exp_f32 v46, v46
    v_lshrrev_b32 v4, 1, v239
    buffer_load_dwordx2 v[182:183], v4, s[48:51], 0 offen
    global_load_dwordx2 v[188:189], v242, s[38:39]
    buffer_load_dword v192, v245, s[60:63], s13 offen sc1
    v_exp_f32 v47, v47
    v_exp_f32 v48, v48
    v_exp_f32 v49, v49
    s_waitcnt lgkmcnt(0)
    v_smfmac_f32_32x32x32_bf16 v[16:31], v[84:87], v[40:47], v209
    ds_read_b128 v[92:95], v208 offset:33280
    v_exp_f32 v50, v50
    v_exp_f32 v51, v51
    ds_read2st64_b64 v[68:71], v205 offset0:75 offset1:76
    v_exp_f32 v52, v52
    v_exp_f32 v53, v53
    v_mfma_f32_32x32x16_bf16 v[32:47], v[64:67], v[96:99], 0
    v_exp_f32 v54, v54
    v_exp_f32 v55, v55
    ds_read_b128 v[80:83], v207 offset:35840
    v_exp_f32 v56, v56
    v_exp_f32 v57, v57
    v_mfma_f32_32x32x8_bf16 v[32:47], v[76:77], v[102:103], v[32:47]
    v_exp_f32 v58, v58
    v_exp_f32 v59, v59
    v_exp_f32 v60, v60
    v_exp_f32 v61, v61
    v_smfmac_f32_32x32x32_bf16 v[16:31], v[88:91], v[48:55], v209
    v_exp_f32 v62, v62
    v_exp_f32 v63, v63
    s_setprio 1
    v_exp_f32 v32, v32
    v_exp_f32 v33, v33
    s_waitcnt lgkmcnt(0)
    v_smfmac_f32_32x32x32_bf16 v[16:31], v[92:95], v[56:63], v209
    ds_read_b128 v[84:87], v208 offset:35840
    v_exp_f32 v34, v34
    v_exp_f32 v35, v35
    v_exp_f32 v36, v36
    v_exp_f32 v37, v37
    v_mfma_f32_32x32x16_bf16 v[48:63], v[68:71], v[96:99], 0
    v_exp_f32 v38, v38
    v_exp_f32 v39, v39
    ds_read_b128 v[88:91], v207 offset:38400
    v_exp_f32 v40, v40
    v_exp_f32 v41, v41
    v_mfma_f32_32x32x8_bf16 v[48:63], v[78:79], v[102:103], v[48:63]
    v_exp_f32 v42, v42
    v_exp_f32 v43, v43
    v_exp_f32 v44, v44
    v_exp_f32 v45, v45
    v_smfmac_f32_32x32x32_bf16 v[16:31], v[80:83], v[32:39], v209
    v_exp_f32 v46, v46
    v_exp_f32 v47, v47
    s_setprio 0
    v_exp_f32 v48, v48
    v_exp_f32 v49, v49
    s_waitcnt lgkmcnt(0)
    v_smfmac_f32_32x32x32_bf16 v[16:31], v[84:87], v[40:47], v209
    ds_read_b128 v[92:95], v208 offset:38400
    v_exp_f32 v50, v50
    v_exp_f32 v51, v51
    v_exp_f32 v52, v52
    v_exp_f32 v53, v53
    v_exp_f32 v54, v54
    v_exp_f32 v55, v55
    v_exp_f32 v56, v56
    v_exp_f32 v57, v57
    v_exp_f32 v58, v58
    v_exp_f32 v59, v59
    v_exp_f32 v60, v60
    v_exp_f32 v61, v61
    v_smfmac_f32_32x32x32_bf16 v[16:31], v[88:91], v[48:55], v209
    v_exp_f32 v62, v62
    v_exp_f32 v63, v63
    s_setprio 0
    s_waitcnt lgkmcnt(0)
    v_smfmac_f32_32x32x32_bf16 v[16:31], v[92:95], v[56:63], v209
L_aepi:
    ds_read_b128 v[64:67], v229 offset:0
    ds_read_b128 v[68:71], v229 offset:12288
    ds_read_b128 v[72:75], v229 offset:24576
    ds_read_b128 v[76:79], v230 offset:0
    ds_read_b128 v[80:83], v230 offset:12288
    ds_read_b128 v[84:87], v230 offset:24576
    s_lshl_b32 s10, s8, 3
    s_add_u32 s10, s10, s4
    s_lshl_b32 s10, s10, 5
    s_add_u32 s10, s10, s7
    s_lshl_b32 s12, s10, 10
    s_add_u32 s12, s12, 15728640
    s_lshl_b32 s14, s10, 7
    s_add_u32 s14, s14, 17825792
    v_lshlrev_b32 v8, 2, v2
    v_mov_b32 v9, s99
    s_mov_b64 s[10:11], 0xffffffff
    v_cndmask_b32 v8, v9, v8, s[10:11]
    s_nop 7
    v_mov_b32 v4, v26
    v_add_f32 v6, |v16|, |v17|
    v_add_f32 v6, |v18|, v6
    v_add_f32 v6, |v19|, v6
    v_add_f32 v6, |v20|, v6
    v_add_f32 v6, |v21|, v6
    v_add_f32 v6, |v22|, v6
    v_add_f32 v6, |v23|, v6
    v_add_f32 v6, |v24|, v6
    v_add_f32 v6, |v25|, v6
    v_rcp_f32 v5, v4
    s_mov_b32 s15, 0x21800000
    v_cmp_le_f32 vcc, s15, v4
    s_mov_b32 s15, 0x71800000
    v_cmp_ge_f32 s[10:11], s15, v4
    v_mul_f32 v5, v104, v5
    s_and_b64 vcc, vcc, s[10:11]
    s_mov_b32 s15, 0x7f800000
    v_cmp_gt_f32 s[10:11], s15, v6
    v_mul_f32 v16, v5, v16
    v_mul_f32 v17, v5, v17
    v_mul_f32 v18, v5, v18
    v_mul_f32 v19, v5, v19
    v_mul_f32 v20, v5, v20
    v_mul_f32 v21, v5, v21
    v_mul_f32 v22, v5, v22
    v_mul_f32 v23, v5, v23
    v_mul_f32 v24, v5, v24
    v_mul_f32 v25, v5, v25
    s_and_b64 vcc, vcc, s[10:11]
    v_cvt_pk_bf16_f32 v32, v16, v17
    v_cvt_pk_bf16_f32 v33, v18, v19
    v_cvt_pk_bf16_f32 v34, v20, v21
    v_cvt_pk_bf16_f32 v35, v22, v23
    v_cvt_pk_bf16_f32 v36, v24, v25
    buffer_store_dwordx4 v[32:35], v221, s[60:63], s12 offen sc1
    buffer_store_dword v36, v8, s[60:63], s14 offen sc1
    v_mov_b32 v4, 159744
    s_cmp_eq_u64 vcc, -1
    s_cbranch_scc1 L_ok_72
    v_mov_b32 v5, 1
    ds_write_b32 v4, v5
L_ok_72:
    s_waitcnt lgkmcnt(0)
    s_barrier
    ds_read_b32 v6, v4
    s_waitcnt lgkmcnt(0)
    v_readfirstlane_b32 s10, v6
    s_xor_b32 s12, s91, 1
    s_and_b32 s10, s10, s12
    s_cmp_lg_u32 s10, 0
    s_cbranch_scc1 L_slow
    s_cmp_ge_u32 s4, 4
    s_cbranch_scc0 L_hb_73
    s_and_b32 s12, s4, 3
    s_lshl_b32 s12, s12, 11
    s_add_u32 m0, s12, 0
    s_mov_b32 s14, 384
    buffer_load_dwordx4 v202, s[64:67], s14 offen lds
    s_add_u32 m0, s12, 1024
    s_mov_b32 s14, 384
    buffer_load_dwordx4 v203, s[64:67], s14 offen lds
    s_add_u32 m0, s12, 18432
    s_mov_b32 s14, 384
    buffer_load_dwordx4 v202, s[68:71], s14 offen lds
    s_add_u32 m0, s12, 19456
    s_mov_b32 s14, 384
    buffer_load_dwordx4 v203, s[68:71], s14 offen lds
    s_add_u32 m0, s12, 8192
    s_mov_b32 s14, 37248
    buffer_load_dwordx4 v202, s[64:67], s14 offen lds
    s_add_u32 m0, s12, 9216
    s_mov_b32 s14, 37248
    buffer_load_dwordx4 v203, s[64:67], s14 offen lds
    s_add_u32 m0, s12, 26624
    s_mov_b32 s14, 37248
    buffer_load_dwordx4 v202, s[68:71], s14 offen lds
    s_add_u32 m0, s12, 27648
    s_mov_b32 s14, 37248
    buffer_load_dwordx4 v203, s[68:71], s14 offen lds
    s_add_u32 m0, s28, 0
    s_mov_b32 s14, 384
    buffer_load_dwordx4 v204, s[32:35], s14 offen lds
    s_and_b32 s10, s4, 3
    s_mul_i32 s15, s10, 82944
    s_add_u32 s15, s15, 0
    s_lshl_b32 s10, s10, 10
    s_add_u32 m0, s10, 57344
    s_nop 0
    buffer_load_dwordx4 v219, s[76:79], s15 offen lds
    s_and_b32 s10, s4, 3
    s_mul_i32 s15, s10, 82944
    s_add_u32 s15, s15, 331776
    s_lshl_b32 s10, s10, 10
    s_add_u32 m0, s10, 36864
    s_nop 0
    buffer_load_dwordx4 v219, s[76:79], s15 offen lds
L_hb_73:
    s_waitcnt lgkmcnt(3)
    v_mfma_f32_32x32x16_bf16 v[16:31], v[64:67], v[106:109], 0
    ds_read_b128 v[88:91], v231 offset:0
    s_lshl_b32 s10, s8, 5
    s_add_u32 s10, s10, s7
    s_lshl_b32 s10, s10, 7
    s_add_u32 s10, s10, 65536
    s_cmp_eq_u32 s4, 4
    s_cselect_b32 s10, s10, s99
    v_mov_b32 v12, s10
    v_mov_b32 v13, s9
    v_mfma_f32_32x32x16_bf16 v[32:47], v[68:71], v[106:109], 0
    ds_read_b128 v[92:95], v231 offset:12288
    v_mfma_f32_32x32x16_bf16 v[48:63], v[72:75], v[106:109], 0
    ds_read_b128 v[96:99], v231 offset:24576
    s_waitcnt lgkmcnt(3)
    v_mfma_f32_32x32x16_bf16 v[16:31], v[76:79], v[110:113], v[16:31]
    ds_read_b128 v[64:67], v232 offset:0
    v_mfma_f32_32x32x16_bf16 v[32:47], v[80:83], v[110:113], v[32:47]
    ds_read_b128 v[68:71], v232 offset:12288
    v_mfma_f32_32x32x16_bf16 v[48:63], v[84:87], v[110:113], v[48:63]
    ds_read_b128 v[72:75], v232 offset:24576
    s_waitcnt lgkmcnt(3)
    v_mfma_f32_32x32x16_bf16 v[16:31], v[88:91], v[114:117], v[16:31]
    ds_read_b128 v[76:79], v233 offset:0
    v_mfma_f32_32x32x16_bf16 v[32:47], v[92:95], v[114:117], v[32:47]
    ds_read_b128 v[80:83], v233 offset:12288
    v_mfma_f32_32x32x16_bf16 v[48:63], v[96:99], v[114:117], v[48:63]
    ds_read_b128 v[84:87], v233 offset:24576
    s_waitcnt lgkmcnt(3)
    v_mfma_f32_32x32x16_bf16 v[16:31], v[64:67], v[118:121], v[16:31]
    ds_read_b128 v[88:91], v234 offset:0
    v_mfma_f32_32x32x16_bf16 v[32:47], v[68:71], v[118:121], v[32:47]
    ds_read_b128 v[92:95], v234 offset:12288
    v_mfma_f32_32x32x16_bf16 v[48:63], v[72:75], v[118:121], v[48:63]
    ds_read_b128 v[96:99], v234 offset:24576
    s_waitcnt lgkmcnt(3)
    v_mfma_f32_32x32x16_bf16 v[16:31], v[76:79], v[122:125], v[16:31]
    v_mfma_f32_32x32x16_bf16 v[32:47], v[80:83], v[122:125], v[32:47]
    v_mfma_f32_32x32x16_bf16 v[48:63], v[84:87], v[122:125], v[48:63]
    s_waitcnt lgkmcnt(0)
    v_mfma_f32_32x32x16_bf16 v[16:31], v[88:91], v[126:129], v[16:31]
    v_mfma_f32_32x32x16_bf16 v[32:47], v[92:95], v[126:129], v[32:47]
    v_mfma_f32_32x32x16_bf16 v[48:63], v[96:99], v[126:129], v[48:63]
    s_waitcnt vmcnt(0)
    s_barrier
    s_mov_b64 exec, 1
    buffer_store_dword v13, v12, s[60:63], 0 offen sc1
    s_mov_b64 exec, -1
    ds_read_b128 v[64:67], v247 offset:0
    ds_read_b128 v[68:71], v247 offset:8192
    ds_read_b128 v[72:75], v247 offset:16384
    ds_read_b128 v[76:79], v248 offset:0
    ds_read_b128 v[80:83], v248 offset:8192
    ds_read_b128 v[84:87], v248 offset:16384
    s_cmp_ge_u32 s4, 4
    s_cbranch_scc0 L_hb_74
    s_and_b32 s12, s4, 3
    s_lshl_b32 s12, s12, 11
    s_add_u32 m0, s12, 61440
    s_mov_b32 s14, 640
    buffer_load_dwordx4 v202, s[64:67], s14 offen lds
    s_add_u32 m0, s12, 62464
    s_mov_b32 s14, 640
    buffer_load_dwordx4 v203, s[64:67], s14 offen lds
    s_add_u32 m0, s12, 79872
    s_mov_b32 s14, 640
    buffer_load_dwordx4 v202, s[68:71], s14 offen lds
    s_add_u32 m0, s12, 80896
    s_mov_b32 s14, 640
    buffer_load_dwordx4 v203, s[68:71], s14 offen lds
    s_add_u32 m0, s12, 69632
    s_mov_b32 s14, 37504
    buffer_load_dwordx4 v202, s[64:67], s14 offen lds
    s_add_u32 m0, s12, 70656
    s_mov_b32 s14, 37504
    buffer_load_dwordx4 v203, s[64:67], s14 offen lds
    s_add_u32 m0, s12, 88064
    s_mov_b32 s14, 37504
    buffer_load_dwordx4 v202, s[68:71], s14 offen lds
    s_add_u32 m0, s12, 89088
    s_mov_b32 s14, 37504
    buffer_load_dwordx4 v203, s[68:71], s14 offen lds
    s_add_u32 m0, s28, 61440
    s_mov_b32 s14, 640
    buffer_load_dwordx4 v204, s[32:35], s14 offen lds
    s_lshl_b32 s10, s23, 3
    s_add_u32 s10, s10, s22
    s_mul_i32 s15, s10, 20736
    s_add_u32 s15, s15, 124416
    s_lshl_b32 s10, s4, 11
    s_add_u32 m0, s10, 98304
    s_nop 0
    buffer_load_dwordx4 v217, s[76:79], s15 offen lds
    s_lshl_b32 s10, s23, 3
    s_add_u32 s10, s10, s22
    s_mul_i32 s15, s10, 20736
    s_add_u32 s15, s15, 133632
    s_lshl_b32 s10, s4, 11
    s_add_u32 m0, s10, 99328
    s_nop 0
    buffer_load_dwordx4 v217, s[76:79], s15 offen lds
    s_lshl_b32 s10, s23, 3
    s_add_u32 s10, s10, s22
    s_mul_i32 s15, s10, 20736
    s_add_u32 s15, s15, 4294759936
    s_lshl_b32 s10, s4, 11
    s_add_u32 m0, s10, 90112
    s_nop 0
    buffer_load_dwordx4 v217, s[76:79], s15 offen lds
    s_lshl_b32 s10, s23, 3
    s_add_u32 s10, s10, s22
    s_mul_i32 s15, s10, 20736
    s_add_u32 s15, s15, 4294769152
    s_lshl_b32 s10, s4, 11
    s_add_u32 m0, s10, 91136
    s_nop 0
    buffer_load_dwordx4 v217, s[76:79], s15 offen lds
L_hb_74:
    s_waitcnt lgkmcnt(3)
    v_mfma_f32_32x32x16_bf16 v[16:31], v[64:67], v[130:133], v[16:31]
    ds_read_b128 v[88:91], v249 offset:0
    s_mov_b32 s12, 0xffff0000
    v_mfma_f32_32x32x16_bf16 v[32:47], v[68:71], v[130:133], v[32:47]
    ds_read_b128 v[92:95], v249 offset:8192
    v_lshlrev_b32 v4, 16, v178
    v_and_b32 v5, s12, v178
    v_lshlrev_b32 v6, 16, v179
    v_and_b32 v7, s12, v179
    v_lshlrev_b32 v8, 16, v184
    v_and_b32 v9, s12, v184
    v_lshlrev_b32 v10, 16, v185
    v_and_b32 v11, s12, v185
    v_pk_mul_f32 v[178:179], v[4:5], v[8:9]
    v_pk_mul_f32 v[184:185], v[6:7], v[10:11]
    v_mfma_f32_32x32x16_bf16 v[48:63], v[72:75], v[130:133], v[48:63]
    ds_read_b128 v[96:99], v249 offset:16384
    v_lshlrev_b32 v4, 16, v180
    v_and_b32 v5, s12, v180
    v_lshlrev_b32 v6, 16, v181
    v_and_b32 v7, s12, v181
    v_lshlrev_b32 v8, 16, v186
    v_and_b32 v9, s12, v186
    v_lshlrev_b32 v10, 16, v187
    v_and_b32 v11, s12, v187
    v_pk_mul_f32 v[180:181], v[4:5], v[8:9]
    v_pk_mul_f32 v[186:187], v[6:7], v[10:11]
    s_waitcnt lgkmcnt(3)
    v_mfma_f32_32x32x16_bf16 v[16:31], v[76:79], v[134:137], v[16:31]
    ds_read_b128 v[64:67], v250 offset:0
    v_lshlrev_b32 v4, 16, v182
    v_and_b32 v5, s12, v182
    v_lshlrev_b32 v6, 16, v183
    v_and_b32 v7, s12, v183
    v_lshlrev_b32 v8, 16, v188
    v_and_b32 v9, s12, v188
    v_lshlrev_b32 v10, 16, v189
    v_and_b32 v11, s12, v189
    v_pk_mul_f32 v[182:183], v[4:5], v[8:9]
    v_pk_mul_f32 v[188:189], v[6:7], v[10:11]
    v_mfma_f32_32x32x16_bf16 v[32:47], v[80:83], v[134:137], v[32:47]
    ds_read_b128 v[68:71], v250 offset:8192
    s_lshl_b32 s10, s7, 1
    s_add_u32 s10, s10, s22
    s_lshl_b32 s12, s10, 15
    s_lshl_b32 s14, s23, 13
    s_add_u32 s12, s12, s14
    s_add_u32 s24, s12, 15728640
    s_add_u32 s25, s24, 4096
    s_lshl_b32 s14, s10, 12
    s_lshl_b32 s10, s23, 10
    s_add_u32 s14, s14, s10
    s_add_u32 s26, s14, 17825792
    v_mfma_f32_32x32x16_bf16 v[48:63], v[84:87], v[134:137], v[48:63]
    ds_read_b128 v[72:75], v250 offset:16384
    s_mov_b32 s56, s42
    s_and_b32 s57, s43, 0xffff
    s_mov_b32 s58, 4718592
    s_mov_b32 s59, 0x20000
    v_readfirstlane_b32 s27, v246
    s_nop 1
    v_lshl_add_u32 v9, v2, 2, s27
    v_lshl_add_u32 v9, v3, 9, v9
    v_mov_b32 v4, s99
    v_cmp_gt_u32 vcc, 16, v0
    s_mul_i32 s10, s4, 2304
    s_add_u32 s10, s10, 0
    v_add_u32 v10, s10, v221
    v_add_u32 v11, 61440, v10
    v_cndmask_b32 v239, v4, v239, vcc
    s_waitcnt lgkmcnt(3)
    v_mfma_f32_32x32x16_bf16 v[16:31], v[88:91], v[138:141], v[16:31]
    v_mfma_f32_32x32x16_bf16 v[32:47], v[92:95], v[138:141], v[32:47]
    v_mfma_f32_32x32x16_bf16 v[48:63], v[96:99], v[138:141], v[48:63]
    s_waitcnt lgkmcnt(0)
    v_mfma_f32_32x32x16_bf16 v[16:31], v[64:67], v[142:145], v[16:31]
    v_mfma_f32_32x32x16_bf16 v[32:47], v[68:71], v[142:145], v[32:47]
    v_mfma_f32_32x32x16_bf16 v[48:63], v[72:75], v[142:145], v[48:63]
    v_add_u32 v247, 61440, v247
    v_add_u32 v248, 61440, v248
    v_add_u32 v249, 61440, v249
    v_add_u32 v250, 61440, v250
    s_waitcnt vmcnt(4)
    s_barrier
    ds_read_b128 v[64:67], v247 offset:0
    ds_read_b128 v[68:71], v247 offset:8192
    ds_read_b128 v[72:75], v247 offset:16384
    ds_read_b128 v[76:79], v248 offset:0
    ds_read_b128 v[80:83], v248 offset:8192
    ds_read_b128 v[84:87], v248 offset:16384
    s_cmp_ge_u32 s4, 4
    s_cbranch_scc0 L_hb_75
    s_and_b32 s12, s4, 3
    s_lshl_b32 s12, s12, 11
    s_add_u32 m0, s12, 0
    s_mov_b32 s14, 896
    buffer_load_dwordx4 v202, s[64:67], s14 offen lds
    s_add_u32 m0, s12, 1024
    s_mov_b32 s14, 896
    buffer_load_dwordx4 v203, s[64:67], s14 offen lds
    s_add_u32 m0, s12, 18432
    s_mov_b32 s14, 896
    buffer_load_dwordx4 v202, s[68:71], s14 offen lds
    s_add_u32 m0, s12, 19456
    s_mov_b32 s14, 896
    buffer_load_dwordx4 v203, s[68:71], s14 offen lds
    s_add_u32 m0, s12, 8192
    s_mov_b32 s14, 37760
    buffer_load_dwordx4 v202, s[64:67], s14 offen lds
    s_add_u32 m0, s12, 9216
    s_mov_b32 s14, 37760
    buffer_load_dwordx4 v203, s[64:67], s14 offen lds
    s_add_u32 m0, s12, 26624
    s_mov_b32 s14, 37760
    buffer_load_dwordx4 v202, s[68:71], s14 offen lds
    s_add_u32 m0, s12, 27648
    s_mov_b32 s14, 37760
    buffer_load_dwordx4 v203, s[68:71], s14 offen lds
    s_add_u32 m0, s28, 0
    s_mov_b32 s14, 896
    buffer_load_dwordx4 v204, s[32:35], s14 offen lds
    buffer_load_dword v227, v225, s[60:63], 0 offen sc1
L_hb_75:
    s_waitcnt lgkmcnt(3)
    v_mfma_f32_32x32x16_bf16 v[16:31], v[64:67], v[146:149], v[16:31]
    ds_read_b128 v[88:91], v249 offset:0
    v_mfma_f32_32x32x16_bf16 v[32:47], v[68:71], v[146:149], v[32:47]
    ds_read_b128 v[92:95], v249 offset:8192
    v_mfma_f32_32x32x16_bf16 v[48:63], v[72:75], v[146:149], v[48:63]
    ds_read_b128 v[96:99], v249 offset:16384
    s_waitcnt lgkmcnt(3)
    v_mfma_f32_32x32x16_bf16 v[16:31], v[76:79], v[150:153], v[16:31]
    ds_read_b128 v[64:67], v250 offset:0
    v_mfma_f32_32x32x16_bf16 v[32:47], v[80:83], v[150:153], v[32:47]
    ds_read_b128 v[68:71], v250 offset:8192
    v_mfma_f32_32x32x16_bf16 v[48:63], v[84:87], v[150:153], v[48:63]
    ds_read_b128 v[72:75], v250 offset:16384
    s_waitcnt lgkmcnt(3)
    v_mfma_f32_32x32x16_bf16 v[16:31], v[88:91], v[154:157], v[16:31]
    v_mfma_f32_32x32x16_bf16 v[32:47], v[92:95], v[154:157], v[32:47]
    v_mfma_f32_32x32x16_bf16 v[48:63], v[96:99], v[154:157], v[48:63]
    s_waitcnt lgkmcnt(0)
    v_mfma_f32_32x32x16_bf16 v[16:31], v[64:67], v[158:161], v[16:31]
    v_mfma_f32_32x32x16_bf16 v[32:47], v[68:71], v[158:161], v[32:47]
    v_mfma_f32_32x32x16_bf16 v[48:63], v[72:75], v[158:161], v[48:63]
    v_add_u32 v247, 4294905856, v247
    v_add_u32 v248, 4294905856, v248
    v_add_u32 v249, 4294905856, v249
    v_add_u32 v250, 4294905856, v250
    s_waitcnt vmcnt(0)
    s_cmp_lg_u32 s4, 4
    s_cbranch_scc1 L_chk_76
    v_cmp_ne_u32 vcc, s9, v227
    s_nop 0
    s_cmp_eq_u64 vcc, 0
    s_cbranch_scc1 L_chk_76
    s_mov_b32 s92, 0
L_poll_77:
    s_mov_b64 exec, 0xffffffff
    buffer_load_dword v227, v225, s[60:63], 0 offen sc1
    s_waitcnt vmcnt(0)
    s_mov_b64 s[10:11], 0
    s_mov_b64 exec, 0xffffffff
    v_cmp_ne_u32 vcc, s9, v227
    s_nop 0
    s_or_b64 s[10:11], s[10:11], vcc
    s_mov_b64 exec, -1
    s_cmp_eq_u64 s[10:11], 0
    s_cbranch_scc1 L_pollq_78
    s_add_u32 s92, s92, 1
    s_cmp_gt_u32 s92, 20000
    s_cbranch_scc1 L_pollq_78
    s_sleep 2
    s_branch L_poll_77
L_pollq_78:
L_chk_76:
    s_barrier
    ds_read_b128 v[64:67], v247 offset:0
    ds_read_b128 v[68:71], v247 offset:8192
    ds_read_b128 v[72:75], v247 offset:16384
    ds_read_b128 v[76:79], v248 offset:0
    ds_read_b128 v[80:83], v248 offset:8192
    ds_read_b128 v[84:87], v248 offset:16384
    buffer_load_dwordx4 v[106:109], v221, s[60:63], s24 offen offset:0 sc1
    buffer_load_dwordx4 v[110:113], v221, s[60:63], s24 offen offset:1024 sc1
    s_cmp_ge_u32 s4, 4
    s_cbranch_scc0 L_hb_79
    buffer_load_dwordx4 v[114:117], v221, s[60:63], s24 offen offset:2048 sc1
    buffer_load_dwordx4 v[118:121], v221, s[60:63], s24 offen offset:3072 sc1
    buffer_load_dwordx4 v[122:125], v221, s[60:63], s25 offen offset:0 sc1
    buffer_load_dwordx4 v[126:129], v221, s[60:63], s25 offen offset:1024 sc1
    buffer_load_dwordx4 v[130:133], v221, s[60:63], s25 offen offset:2048 sc1
    buffer_load_dwordx4 v[134:137], v221, s[60:63], s25 offen offset:3072 sc1
L_hb_79:
    s_waitcnt lgkmcnt(3)
    v_mfma_f32_32x32x16_bf16 v[16:31], v[64:67], v[162:165], v[16:31]
    ds_read_b128 v[88:91], v249 offset:0
    v_mfma_f32_32x32x16_bf16 v[32:47], v[68:71], v[162:165], v[32:47]
    ds_read_b128 v[92:95], v249 offset:8192
    v_mfma_f32_32x32x16_bf16 v[48:63], v[72:75], v[162:165], v[48:63]
    ds_read_b128 v[96:99], v249 offset:16384
    s_waitcnt lgkmcnt(3)
    v_mfma_f32_32x32x16_bf16 v[16:31], v[76:79], v[166:169], v[16:31]
    ds_read_b128 v[64:67], v250 offset:0
    v_mfma_f32_32x32x16_bf16 v[32:47], v[80:83], v[166:169], v[32:47]
    ds_read_b128 v[68:71], v250 offset:8192
    v_mfma_f32_32x32x16_bf16 v[48:63], v[84:87], v[166:169], v[48:63]
    ds_read_b128 v[72:75], v250 offset:16384
    s_waitcnt lgkmcnt(3)
    v_mfma_f32_32x32x16_bf16 v[16:31], v[88:91], v[170:173], v[16:31]
    v_mfma_f32_32x32x16_bf16 v[32:47], v[92:95], v[170:173], v[32:47]
    v_mfma_f32_32x32x16_bf16 v[48:63], v[96:99], v[170:173], v[48:63]
    s_waitcnt lgkmcnt(0)
    v_mfma_f32_32x32x16_bf16 v[16:31], v[64:67], v[174:177], v[16:31]
    v_mfma_f32_32x32x16_bf16 v[32:47], v[68:71], v[174:177], v[32:47]
    v_mfma_f32_32x32x16_bf16 v[48:63], v[72:75], v[174:177], v[48:63]
    s_cmp_ge_u32 s4, 4
    s_cbranch_scc1 L_hb_80
    buffer_load_dwordx4 v[114:117], v221, s[60:63], s24 offen offset:2048 sc1
    buffer_load_dwordx4 v[118:121], v221, s[60:63], s24 offen offset:3072 sc1
    buffer_load_dwordx4 v[122:125], v221, s[60:63], s25 offen offset:0 sc1
    buffer_load_dwordx4 v[126:129], v221, s[60:63], s25 offen offset:1024 sc1
    buffer_load_dwordx4 v[130:133], v221, s[60:63], s25 offen offset:2048 sc1
    buffer_load_dwordx4 v[134:137], v221, s[60:63], s25 offen offset:3072 sc1
L_hb_80:
    ds_read_b64_tr_b16 v[64:65], v193 offset:0
    ds_read_b64_tr_b16 v[66:67], v193 offset:512
    ds_read_b64_tr_b16 v[68:69], v193 offset:2048
    ds_read_b64_tr_b16 v[70:71], v193 offset:2560
    ds_read_b64_tr_b16 v[72:73], v193 offset:4096
    ds_read_b64_tr_b16 v[74:75], v193 offset:4608
    ds_read_b64_tr_b16 v[76:77], v193 offset:6144
    ds_read_b64_tr_b16 v[78:79], v193 offset:6656
    v_mul_f32 v16, v105, v16
    v_mul_f32 v17, v105, v17
    v_mul_f32 v18, v105, v18
    v_mul_f32 v19, v105, v19
    v_mul_f32 v20, v105, v20
    v_mul_f32 v21, v105, v21
    v_mul_f32 v22, v105, v22
    v_mul_f32 v23, v105, v23
    v_mul_f32 v24, v105, v24
    v_mul_f32 v25, v105, v25
    v_mul_f32 v26, v105, v26
    v_mul_f32 v27, v105, v27
    v_mul_f32 v28, v105, v28
    v_mul_f32 v29, v105, v29
    v_mul_f32 v30, v105, v30
    v_mul_f32 v31, v105, v31
    v_mul_f32 v32, v105, v32
    v_mul_f32 v33, v105, v33
    v_mul_f32 v34, v105, v34
    v_mul_f32 v35, v105, v35
    v_mul_f32 v36, v105, v36
    v_mul_f32 v37, v105, v37
    v_mul_f32 v38, v105, v38
    v_mul_f32 v39, v105, v39
    v_mul_f32 v40, v105, v40
    v_mul_f32 v41, v105, v41
    v_mul_f32 v42, v105, v42
    v_mul_f32 v43, v105, v43
    v_mul_f32 v44, v105, v44
    v_mul_f32 v45, v105, v45
    v_mul_f32 v46, v105, v46
    v_mul_f32 v47, v105, v47
    v_mul_f32 v48, v105, v48
    v_mul_f32 v49, v105, v49
    v_mul_f32 v50, v105, v50
    v_mul_f32 v51, v105, v51
    s_barrier
    s_mov_b32 m0, s27
    s_nop 0
    buffer_load_dwordx4 v221, s[60:63], s26 offen sc1 lds
    s_lshl_b32 s3, s2, 3
    s_add_u32 s3, s3, s4
    s_cmp_lg_u32 s3, 7
    s_cbranch_scc1 L_ep_81
    v_lshlrev_b32 v4, 7, v0
    v_add_u32 v4, 65536, v4
    v_add_u32 v5, 0x2000, v4
    v_add_u32 v6, 0x4000, v4
    v_add_u32 v7, 0x6000, v4
    buffer_load_dword v142, v4, s[60:63], 0 offen sc1
    buffer_load_dword v143, v5, s[60:63], 0 offen sc1
    buffer_load_dword v144, v6, s[60:63], 0 offen sc1
    buffer_load_dword v145, v7, s[60:63], 0 offen sc1
L_ep_81:
    s_setprio 3
    s_waitcnt vmcnt(8) lgkmcnt(6)
    v_mfma_f32_32x32x16_bf16 v[16:31], v[64:67], v[106:109], v[16:31]
    ds_read_b64_tr_b16 v[80:81], v196 offset:0
    ds_read_b64_tr_b16 v[82:83], v196 offset:512
    s_waitcnt vmcnt(7) lgkmcnt(6)
    v_mfma_f32_32x32x16_bf16 v[16:31], v[68:71], v[110:113], v[16:31]
    ds_read_b64_tr_b16 v[84:85], v196 offset:2048
    ds_read_b64_tr_b16 v[86:87], v196 offset:2560
    s_waitcnt vmcnt(6) lgkmcnt(6)
    v_mfma_f32_32x32x16_bf16 v[16:31], v[72:75], v[114:117], v[16:31]
    ds_read_b64_tr_b16 v[88:89], v196 offset:57344
    ds_read_b64_tr_b16 v[90:91], v196 offset:57856
    s_waitcnt vmcnt(5) lgkmcnt(6)
    v_mfma_f32_32x32x16_bf16 v[16:31], v[76:79], v[118:121], v[16:31]
    ds_read_b64_tr_b16 v[92:93], v196 offset:59392
    ds_read_b64_tr_b16 v[94:95], v196 offset:59904
    s_waitcnt vmcnt(4) lgkmcnt(6)
    v_mfma_f32_32x32x16_bf16 v[16:31], v[80:83], v[122:125], v[16:31]
    ds_read_b64_tr_b16 v[96:97], v199 offset:0
    ds_read_b64_tr_b16 v[98:99], v199 offset:512
    s_waitcnt vmcnt(3) lgkmcnt(6)
    v_mfma_f32_32x32x16_bf16 v[16:31], v[84:87], v[126:129], v[16:31]
    ds_read_b64_tr_b16 v[64:65], v194 offset:0
    ds_read_b64_tr_b16 v[66:67], v194 offset:512
    s_waitcnt vmcnt(2) lgkmcnt(6)
    v_mfma_f32_32x32x16_bf16 v[16:31], v[88:91], v[130:133], v[16:31]
    s_waitcnt vmcnt(0)
    ds_read_b32 v138, v9 offset:0
    ds_read_b32 v139, v9 offset:128
    ds_read_b32 v140, v9 offset:256
    ds_read_b32 v141, v9 offset:384
    ds_read_b64_tr_b16 v[68:69], v194 offset:2048
    ds_read_b64_tr_b16 v[70:71], v194 offset:2560
    s_waitcnt lgkmcnt(10)
    v_mfma_f32_32x32x16_bf16 v[16:31], v[92:95], v[134:137], v[16:31]
    ds_read_b64_tr_b16 v[72:73], v194 offset:4096
    ds_read_b64_tr_b16 v[74:75], v194 offset:4608
    s_setprio 2
    s_waitcnt lgkmcnt(4)
    v_mfma_f32_32x32x16_bf16 v[16:31], v[96:99], v[138:141], v[16:31]
    ds_read_b64_tr_b16 v[76:77], v194 offset:6144
    ds_read_b64_tr_b16 v[78:79], v194 offset:6656
    v_mfma_f32_32x32x16_bf16 v[32:47], v[64:67], v[106:109], v[32:47]
    ds_read_b64_tr_b16 v[80:81], v197 offset:0
    ds_read_b64_tr_b16 v[82:83], v197 offset:512
    s_waitcnt lgkmcnt(6)
    v_mfma_f32_32x32x16_bf16 v[32:47], v[68:71], v[110:113], v[32:47]
    ds_read_b64_tr_b16 v[84:85], v197 offset:2048
    ds_read_b64_tr_b16 v[86:87], v197 offset:2560
    s_waitcnt lgkmcnt(6)
    v_mfma_f32_32x32x16_bf16 v[32:47], v[72:75], v[114:117], v[32:47]
    ds_read_b64_tr_b16 v[88:89], v197 offset:57344
    ds_read_b64_tr_b16 v[90:91], v197 offset:57856
    ds_write_b128 v246, v[16:19] offset:0
    s_waitcnt lgkmcnt(7)
    v_mfma_f32_32x32x16_bf16 v[32:47], v[76:79], v[118:121], v[32:47]
    ds_read_b64_tr_b16 v[92:93], v197 offset:59392
    ds_read_b64_tr_b16 v[94:95], v197 offset:59904
    ds_write_b128 v246, v[20:23] offset:32
    s_waitcnt lgkmcnt(8)
    v_mfma_f32_32x32x16_bf16 v[32:47], v[80:83], v[122:125], v[32:47]
    ds_read_b64_tr_b16 v[96:97], v200 offset:0
    ds_read_b64_tr_b16 v[98:99], v200 offset:512
    ds_write_b128 v246, v[24:27] offset:64
    s_waitcnt lgkmcnt(9)
    v_mfma_f32_32x32x16_bf16 v[32:47], v[84:87], v[126:129], v[32:47]
    ds_read_b64_tr_b16 v[64:65], v195 offset:0
    ds_read_b64_tr_b16 v[66:67], v195 offset:64
    ds_write_b128 v246, v[28:31] offset:96
    s_setprio 1
    s_waitcnt lgkmcnt(10)
    v_mfma_f32_32x32x16_bf16 v[32:47], v[88:91], v[130:133], v[32:47]
    ds_read_b64_tr_b16 v[68:69], v195 offset:256
    ds_read_b64_tr_b16 v[70:71], v195 offset:320
    s_waitcnt lgkmcnt(9)
    v_mfma_f32_32x32x16_bf16 v[32:47], v[92:95], v[134:137], v[32:47]
    ds_read_b64_tr_b16 v[72:73], v195 offset:512
    ds_read_b64_tr_b16 v[74:75], v195 offset:576
    s_waitcnt lgkmcnt(8)
    v_mfma_f32_32x32x16_bf16 v[32:47], v[96:99], v[138:141], v[32:47]
    ds_read_b64_tr_b16 v[76:77], v195 offset:768
    ds_read_b64_tr_b16 v[78:79], v195 offset:832
    s_waitcnt lgkmcnt(7)
    v_mfma_f32_32x32x16_bf16 v[48:63], v[64:67], v[106:109], v[48:63]
    ds_read_b64_tr_b16 v[80:81], v198 offset:0
    ds_read_b64_tr_b16 v[82:83], v198 offset:64
    s_waitcnt lgkmcnt(6)
    v_mfma_f32_32x32x16_bf16 v[48:63], v[68:71], v[110:113], v[48:63]
    ds_read_b64_tr_b16 v[84:85], v198 offset:256
    ds_read_b64_tr_b16 v[86:87], v198 offset:320
    s_waitcnt lgkmcnt(6)
    v_mfma_f32_32x32x16_bf16 v[48:63], v[72:75], v[114:117], v[48:63]
    ds_read_b64_tr_b16 v[88:89], v198 offset:512
    ds_read_b64_tr_b16 v[90:91], v198 offset:576
    ds_write_b128 v246, v[32:35] offset:128
    s_waitcnt lgkmcnt(7)
    v_mfma_f32_32x32x16_bf16 v[48:63], v[76:79], v[118:121], v[48:63]
    ds_read_b64_tr_b16 v[92:93], v198 offset:768
    ds_read_b64_tr_b16 v[94:95], v198 offset:832
    ds_write_b128 v246, v[36:39] offset:160
    s_setprio 0
    s_waitcnt lgkmcnt(8)
    v_mfma_f32_32x32x16_bf16 v[48:63], v[80:83], v[122:125], v[48:63]
    ds_read_b64_tr_b16 v[96:97], v201 offset:0
    ds_read_b64_tr_b16 v[98:99], v201 offset:64
    ds_write_b128 v246, v[40:43] offset:192
    s_waitcnt lgkmcnt(9)
    v_mfma_f32_32x32x16_bf16 v[48:63], v[84:87], v[126:129], v[48:63]
    ds_write_b128 v246, v[44:47] offset:224
    s_waitcnt lgkmcnt(8)
    v_mfma_f32_32x32x16_bf16 v[48:63], v[88:91], v[130:133], v[48:63]
    s_waitcnt lgkmcnt(5)
    v_mfma_f32_32x32x16_bf16 v[48:63], v[92:95], v[134:137], v[48:63]
    s_waitcnt lgkmcnt(2)
    v_mfma_f32_32x32x16_bf16 v[48:63], v[96:99], v[138:141], v[48:63]
    s_nop 11
    ds_write_b128 v246, v[48:51] offset:256
    s_cmp_lg_u32 s3, 7
    s_cbranch_scc1 L_st_82
    s_mov_b64 s[10:11], 0
    v_cmp_ne_u32 vcc, s9, v142
    s_nop 0
    s_or_b64 s[10:11], s[10:11], vcc
    v_cmp_ne_u32 vcc, s9, v143
    s_nop 0
    s_or_b64 s[10:11], s[10:11], vcc
    v_cmp_ne_u32 vcc, s9, v144
    s_nop 0
    s_or_b64 s[10:11], s[10:11], vcc
    v_cmp_ne_u32 vcc, s9, v145
    s_nop 0
    s_or_b64 s[10:11], s[10:11], vcc
    s_cmp_eq_u64 s[10:11], 0
    s_cbranch_scc1 L_stok_83
    s_mov_b32 s92, 0
L_poll_84:
    s_mov_b64 exec, -1
    buffer_load_dword v142, v4, s[60:63], 0 offen sc1
    s_mov_b64 exec, -1
    buffer_load_dword v143, v5, s[60:63], 0 offen sc1
    s_mov_b64 exec, -1
    buffer_load_dword v144, v6, s[60:63], 0 offen sc1
    s_mov_b64 exec, -1
    buffer_load_dword v145, v7, s[60:63], 0 offen sc1
    s_waitcnt vmcnt(0)
    s_mov_b64 s[10:11], 0
    s_mov_b64 exec, -1
    v_cmp_ne_u32 vcc, s9, v142
    s_nop 0
    s_or_b64 s[10:11], s[10:11], vcc
    s_mov_b64 exec, -1
    v_cmp_ne_u32 vcc, s9, v143
    s_nop 0
    s_or_b64 s[10:11], s[10:11], vcc
    s_mov_b64 exec, -1
    v_cmp_ne_u32 vcc, s9, v144
    s_nop 0
    s_or_b64 s[10:11], s[10:11], vcc
    s_mov_b64 exec, -1
    v_cmp_ne_u32 vcc, s9, v145
    s_nop 0
    s_or_b64 s[10:11], s[10:11], vcc
    s_mov_b64 exec, -1
    s_cmp_eq_u64 s[10:11], 0
    s_cbranch_scc1 L_pollq_85
    s_add_u32 s92, s92, 1
    s_cmp_gt_u32 s92, 20000
    s_cbranch_scc1 L_pollq_85
    s_sleep 2
    s_branch L_poll_84
L_pollq_85:
L_stok_83:
    v_mov_b32 v4, 0
    v_mov_b32 v5, s9
    s_mov_b64 exec, 1
    buffer_store_dword v5, v4, s[60:63], 0 offen
    s_mov_b64 exec, -1
L_st_82:
    s_waitcnt lgkmcnt(0)
    s_barrier
    ds_read_b128 v[16:19], v10 offset:0
    ds_read_b128 v[20:23], v10 offset:18432
    ds_read_b128 v[24:27], v11 offset:0
    ds_read_b128 v[28:31], v11 offset:18432
    ds_read_b128 v[32:35], v10 offset:1024
    ds_read_b128 v[36:39], v10 offset:19456
    ds_read_b128 v[40:43], v11 offset:1024
    ds_read_b128 v[44:47], v11 offset:19456
    ds_read_b128 v[48:51], v10 offset:2048
    ds_read_b128 v[52:55], v10 offset:20480
    ds_read_b128 v[56:59], v11 offset:2048
    ds_read_b128 v[60:63], v11 offset:20480
    s_waitcnt lgkmcnt(8)
    v_add_f32 v16, v16, v20
    v_add_f32 v24, v24, v28
    v_fmac_f32 v16, v190, v178
    v_add_f32 v17, v17, v21
    v_add_f32 v25, v25, v29
    v_fmac_f32 v17, v190, v179
    v_add_f32 v18, v18, v22
    v_add_f32 v26, v26, v30
    v_fmac_f32 v18, v190, v184
    v_add_f32 v19, v19, v23
    v_add_f32 v27, v27, v31
    v_fmac_f32 v19, v190, v185
    v_add_f32 v16, v16, v24
    v_add_f32 v17, v17, v25
    v_add_f32 v18, v18, v26
    v_add_f32 v19, v19, v27
    buffer_store_dwordx4 v[16:19], v237, s[56:59], 0 offen sc1
    s_waitcnt lgkmcnt(4)
    v_add_f32 v32, v32, v36
    v_add_f32 v40, v40, v44
    v_fmac_f32 v32, v191, v180
    v_add_f32 v33, v33, v37
    v_add_f32 v41, v41, v45
    v_fmac_f32 v33, v191, v181
    v_add_f32 v34, v34, v38
    v_add_f32 v42, v42, v46
    v_fmac_f32 v34, v191, v186
    v_add_f32 v35, v35, v39
    v_add_f32 v43, v43, v47
    v_fmac_f32 v35, v191, v187
    v_add_f32 v32, v32, v40
    v_add_f32 v33, v33, v41
    v_add_f32 v34, v34, v42
    v_add_f32 v35, v35, v43
    buffer_store_dwordx4 v[32:35], v238, s[56:59], 0 offen sc1
    s_waitcnt lgkmcnt(0)
    v_add_f32 v48, v48, v52
    v_add_f32 v56, v56, v60
    v_fmac_f32 v48, v192, v182
    v_add_f32 v49, v49, v53
    v_add_f32 v57, v57, v61
    v_fmac_f32 v49, v192, v183
    v_add_f32 v50, v50, v54
    v_add_f32 v58, v58, v62
    v_fmac_f32 v50, v192, v188
    v_add_f32 v51, v51, v55
    v_add_f32 v59, v59, v63
    v_fmac_f32 v51, v192, v189
    v_add_f32 v48, v48, v56
    v_add_f32 v49, v49, v57
    v_add_f32 v50, v50, v58
    v_add_f32 v51, v51, v59
    buffer_store_dwordx4 v[48:51], v239, s[56:59], 0 offen sc1
L_end:
    s_endpgm
L_slow:
    s_waitcnt vmcnt(0) lgkmcnt(0)
    s_nop 15
    s_mov_b32 s91, 1
    v_mov_b32 v12, 0xff800000
    v_mov_b32 v16, 0
    v_mov_b32 v17, 0
    v_mov_b32 v18, 0
    v_mov_b32 v19, 0
    v_mov_b32 v20, 0
    v_mov_b32 v21, 0
    v_mov_b32 v22, 0
    v_mov_b32 v23, 0
    v_mov_b32 v24, 0
    v_mov_b32 v25, 0
    v_mov_b32 v26, 0
    v_mov_b32 v27, 0
    v_mov_b32 v28, 0
    v_mov_b32 v29, 0
    v_mov_b32 v30, 0
    v_mov_b32 v31, 0
    s_mov_b32 s14, 0
L_sb_86:
    s_barrier
    s_lshl_b32 s10, s14, 3
    s_add_u32 s10, s10, s4
    s_mul_i32 s94, s10, 36864
    s_mov_b32 m0, s93
    s_nop 0
    buffer_load_dwordx4 v210, s[60:63], s94 offen sc1 lds
    s_add_u32 m0, s93, 1024
    s_nop 0
    buffer_load_dwordx4 v211, s[60:63], s94 offen sc1 lds
    s_add_u32 m0, s93, 2048
    s_mov_b64 exec, 0xffffff
    buffer_load_dwordx4 v212, s[60:63], s94 offen sc1 lds
    s_mov_b64 exec, -1
    v_and_b32 v4, 7, v0
    v_lshl_add_u32 v4, v4, 4, s93
    v_bfe_u32 v5, v0, 2, 1
    v_mul_u32_u24 v8, 0x3f80, v5
    v_lshl_or_b32 v8, v8, 16, v8
    v_mov_b32 v9, v8
    v_mov_b32 v10, v8
    v_mov_b32 v11, v8
    ds_write_b128 v4, v[8:11] offset:2432
    s_waitcnt vmcnt(0) lgkmcnt(0)
    s_barrier
    s_mov_b32 s15, 0
L_stile_87:
    v_add_u32 v4, s15, v205
    v_lshl_add_u32 v5, v2, 3, s15
    v_add_u32 v6, s15, v207
    v_add_u32 v7, s15, v208
    ds_read2st64_b64 v[64:67], v4 offset0:0 offset1:1
    ds_read_b64 v[72:73], v5 offset:1024
    ds_read_b128 v[80:83], v6
    ds_read_b128 v[84:87], v7
    s_waitcnt lgkmcnt(0)
    v_mfma_f32_32x32x16_bf16 v[32:47], v[64:67], v[96:99], 0
    v_mfma_f32_32x32x8_bf16 v[32:47], v[72:73], v[100:101], v[32:47]
    s_nop 15
    v_max3_f32 v8, v32, v33, v12
    v_max3_f32 v8, v34, v35, v8
    v_max3_f32 v8, v36, v37, v8
    v_max3_f32 v8, v38, v39, v8
    v_max3_f32 v8, v40, v41, v8
    v_max3_f32 v8, v42, v43, v8
    v_max3_f32 v8, v44, v45, v8
    v_max3_f32 v8, v46, v47, v8
    v_mov_b32 v9, v8
    s_nop 1
    v_permlane32_swap_b32 v8, v9
    v_max_f32 v8, v8, v9
    v_sub_f32 v13, v12, v8
    v_exp_f32 v13, v13
    v_mov_b32 v12, v8
    v_sub_f32 v32, v32, v8
    v_exp_f32 v32, v32
    v_sub_f32 v33, v33, v8
    v_exp_f32 v33, v33
    v_sub_f32 v34, v34, v8
    v_exp_f32 v34, v34
    v_sub_f32 v35, v35, v8
    v_exp_f32 v35, v35
    v_sub_f32 v36, v36, v8
    v_exp_f32 v36, v36
    v_sub_f32 v37, v37, v8
    v_exp_f32 v37, v37
    v_sub_f32 v38, v38, v8
    v_exp_f32 v38, v38
    v_sub_f32 v39, v39, v8
    v_exp_f32 v39, v39
    v_sub_f32 v40, v40, v8
    v_exp_f32 v40, v40
    v_sub_f32 v41, v41, v8
    v_exp_f32 v41, v41
    v_sub_f32 v42, v42, v8
    v_exp_f32 v42, v42
    v_sub_f32 v43, v43, v8
    v_exp_f32 v43, v43
    v_sub_f32 v44, v44, v8
    v_exp_f32 v44, v44
    v_sub_f32 v45, v45, v8
    v_exp_f32 v45, v45
    v_sub_f32 v46, v46, v8
    v_exp_f32 v46, v46
    v_sub_f32 v47, v47, v8
    v_exp_f32 v47, v47
    v_mul_f32 v16, v13, v16
    v_mul_f32 v17, v13, v17
    v_mul_f32 v18, v13, v18
    v_mul_f32 v19, v13, v19
    v_mul_f32 v20, v13, v20
    v_mul_f32 v21, v13, v21
    v_mul_f32 v22, v13, v22
    v_mul_f32 v23, v13, v23
    v_mul_f32 v24, v13, v24
    v_mul_f32 v25, v13, v25
    v_mul_f32 v26, v13, v26
    v_mul_f32 v27, v13, v27
    v_mul_f32 v28, v13, v28
    v_mul_f32 v29, v13, v29
    v_mul_f32 v30, v13, v30
    v_mul_f32 v31, v13, v31
    s_nop 1
    v_smfmac_f32_32x32x32_bf16 v[16:31], v[80:83], v[32:39], v209
    v_smfmac_f32_32x32x32_bf16 v[16:31], v[84:87], v[40:47], v209
    s_nop 15
    s_add_u32 s15, s15, 2560
    s_cmp_lt_u32 s15, 20480
    s_cbranch_scc1 L_stile_87
    s_add_u32 s14, s14, 1
    s_cmp_lt_u32 s14, 8
    s_cbranch_scc1 L_sb_86
    s_branch L_aepi
L_codeend:
    s_endpgm
.section .rodata,"a"
.p2align 6
.amdhsa_kernel gated_mix__mha_block__ssm_conv_s5__prompt_kernel
  .amdhsa_next_free_vgpr 256
  .amdhsa_next_free_sgpr 102
  .amdhsa_accum_offset 256
  .amdhsa_group_segment_fixed_size 0
  .amdhsa_kernarg_size 128
  .amdhsa_user_sgpr_count 2
  .amdhsa_user_sgpr_kernarg_segment_ptr 1
  .amdhsa_system_sgpr_workgroup_id_x 1
  .amdhsa_float_denorm_mode_32 3
.end_amdhsa_kernel
```
